```python
import torch

def _softmax(x, axis=-1):
    return torch.softmax(x, dim=axis)
def _gelu(x):
    return torch.nn.functional.gelu(x, approximate="tanh")
def _silu(x):
    return torch.nn.functional.silu(x)
def _sigmoid(x):
    return torch.sigmoid(x)
def _layernorm(x, axis=-1, eps=1e-5):
    m = x.mean(dim=axis, keepdim=True)
    v = x.var(dim=axis, keepdim=True, unbiased=False)
    return (x - m) / torch.sqrt(v + eps)
def _scatter_add(tgt, idx, src, axis=0):
    return tgt.clone().index_add_(axis, idx, src)
def _segment_sum(src, seg, n):
    out = torch.zeros((n,) + src.shape[1:], dtype=src.dtype)
    return out.index_add_(0, seg, src)
def _pad(x, pw):
    flat = tuple(v for pair in reversed(pw) for v in pair)
    return torch.nn.functional.pad(x, flat)

kernel_name = 'concat_heads__gqa_block_cached__mha_block_cached__near_ridge'

def setup_inputs():

    _w = (lambda a: (lambda t: t.to(torch.bfloat16) if t.is_floating_point() else t)(torch.as_tensor(a)))
    def _A_setup():
        B, Sq, D = 16, 128, 640
        Hq, Hkv, Sk, Dh = 32, 32, 512, 192
        assert Hq % Hkv == 0, (Hq, Hkv)
        return {
            "x": _w((lambda *s: torch.randn(*s, dtype=torch.bfloat16) * 0.8)(B, Sq, D)),
            "k_cache": _w((lambda *s: torch.randn(*s, dtype=torch.bfloat16) * 0.8)(B, Hkv, Sk, Dh)),
            "v_cache": _w((lambda *s: torch.randn(*s, dtype=torch.bfloat16) * 0.05)(B, Hkv, Sk, Dh)),
            "wq": _w((lambda *s: torch.randn(*s, dtype=torch.bfloat16) * 0.8)(D, Hq * Dh) * (D ** -0.5)),
            "wo": _w((lambda *s: torch.randn(*s, dtype=torch.bfloat16) * 0.05)(Hq * Dh, D) * ((Hq * Dh) ** -0.5)),
        }
    _A_in = _A_setup()

    def _B_setup():
        B, Sq, D = 16, 128, 640
        H, Sk, Dh = 32, 512, 192
        return {
            "x": _w((lambda *s: torch.randn(*s, dtype=torch.bfloat16) * 0.8)(B, Sq, D)),
            "k_cache": _w((lambda *s: torch.randn(*s, dtype=torch.bfloat16) * 0.8)(B, H, Sk, Dh)),
            "v_cache": _w((lambda *s: torch.randn(*s, dtype=torch.bfloat16) * 0.05)(B, H, Sk, Dh)),
            "wq": _w((lambda *s: torch.randn(*s, dtype=torch.bfloat16) * 0.8)(D, H * Dh) * (D ** -0.5)),
            "wo": _w((lambda *s: torch.randn(*s, dtype=torch.bfloat16) * 0.05)(H * Dh, D) * ((H * Dh) ** -0.5)),
        }
    _B_in = _B_setup()

    return {
        "A_x": _A_in["x"],
        "A_k_cache": _A_in["k_cache"],
        "A_v_cache": _A_in["v_cache"],
        "A_wq": _A_in["wq"],
        "A_wo": _A_in["wo"],
        "B_x": _B_in["x"],
        "B_k_cache": _B_in["k_cache"],
        "B_v_cache": _B_in["v_cache"],
        "B_wq": _B_in["wq"],
        "B_wo": _B_in["wo"],
    }

def reference(A_x, A_k_cache, A_v_cache, A_wq, A_wo, B_x, B_k_cache, B_v_cache, B_wq, B_wo):
    def _A_ref(x, k_cache, v_cache, wq, wo):
        B, Sq, D = x.shape
        Hq, Dh = 32, 192
        Hkv = k_cache.shape[1]
        rep = Hq // Hkv
        q = (lambda x, *d: x.permute(*d))((x @ wq).reshape(B, Sq, Hq, Dh), 0, 2, 1, 3)
        k = (lambda x, n, axis: torch.repeat_interleave(x, n, dim=axis))(k_cache, rep, axis=1)
        v = (lambda x, n, axis: torch.repeat_interleave(x, n, dim=axis))(v_cache, rep, axis=1)
        scores = torch.einsum("bhqd,bhkd->bhqk", q, k) * (Dh ** -0.5)
        p = _softmax(scores, axis=-1)
        o = torch.einsum("bhqk,bhkd->bhqd", p, v)
        return (lambda x, *d: x.permute(*d))(o, 0, 2, 1, 3).reshape(B, Sq, Hq * Dh) @ wo

    def _B_ref(x, k_cache, v_cache, wq, wo):
        B, Sq, D = x.shape
        H, Dh = 32, 192
        q = (lambda x, *d: x.permute(*d))((x @ wq).reshape(B, Sq, H, Dh), 0, 2, 1, 3)
        scores = torch.einsum("bhqd,bhkd->bhqk", q, k_cache) * (Dh ** -0.5)
        p = _softmax(scores, axis=-1)
        o = torch.einsum("bhqk,bhkd->bhqd", p, v_cache)
        return (lambda x, *d: x.permute(*d))(o, 0, 2, 1, 3).reshape(B, Sq, H * Dh) @ wo

    a = _A_ref(A_x, A_k_cache, A_v_cache, A_wq, A_wo)
    b = _B_ref(B_x, B_k_cache, B_v_cache, B_wq, B_wo)
    return torch.concatenate([a, b], axis=-1)
```

```asm
; @launch grid=(256,1,1) block=(256,1,1) lds=161664
.amdgcn_target "amdgcn-amd-amdhsa--gfx950"
.macro cv d,a
 v_cvt_pk_bf16_f32 v\d, v\a, v[\a+1]
.endm
.macro cvaa d,a,b,c
 v_mfma_f32_16x16x32_bf16 v[\d:\d+3], a[\a:\a+3], a[\b:\b+3], v[\c:\c+3]
.endm
.macro ex d
 v_exp_f32 v\d, v\d
.endm
.macro maaa d,a,b
 v_mfma_f32_16x16x32_bf16 a[\d:\d+3], a[\a:\a+3], a[\b:\b+3], a[\d:\d+3]
.endm
.macro maav d,a,b
 v_mfma_f32_16x16x32_bf16 a[\d:\d+3], a[\a:\a+3], v[\b:\b+3], a[\d:\d+3]
.endm
.macro mvaa d,a,b
 v_mfma_f32_16x16x32_bf16 v[\d:\d+3], a[\a:\a+3], a[\b:\b+3], v[\d:\d+3]
.endm
.macro mvav d,a,b
 v_mfma_f32_16x16x32_bf16 v[\d:\d+3], a[\a:\a+3], v[\b:\b+3], v[\d:\d+3]
.endm
.macro rqa d,a,f
 ds_read_b128 a[\d:\d+3], v\a offset:\f
.endm
.macro rqv d,a,f
 ds_read_b128 v[\d:\d+3], v\a offset:\f
.endm
.macro tra d,a,f
 ds_read_b64_tr_b16 a[\d:\d+1], v\a offset:\f
.endm
.macro wl n
 s_waitcnt lgkmcnt(\n)
.endm
.macro zaaa d,a,b
 v_mfma_f32_16x16x32_bf16 a[\d:\d+3], a[\a:\a+3], a[\b:\b+3], 0
.endm
.macro zaav d,a,b
 v_mfma_f32_16x16x32_bf16 a[\d:\d+3], a[\a:\a+3], v[\b:\b+3], 0
.endm
.macro zvaa d,a,b
 v_mfma_f32_16x16x32_bf16 v[\d:\d+3], a[\a:\a+3], a[\b:\b+3], 0
.endm
.macro zvav d,a,b
 v_mfma_f32_16x16x32_bf16 v[\d:\d+3], a[\a:\a+3], v[\b:\b+3], 0
.endm
.text
.globl concat_heads__gqa_block_cached__mha_block_cached__near_ridge_kernel
.p2align 12
.type concat_heads__gqa_block_cached__mha_block_cached__near_ridge_kernel,@function
concat_heads__gqa_block_cached__mha_block_cached__near_ridge_kernel:
s_cmp_ge_u32 s2, 0x100
s_cbranch_scc1 L_k1_done
s_load_dwordx16 s[16:31], s[0:1], 0
s_load_dwordx8 s[32:39], s[0:1], 64
s_load_dwordx2 s[40:41], s[0:1], 0x60
s_getpc_b64 s[90:91]
L_k1_pc:
s_lshr_b32 s88, s2, 3
s_mul_i32 s88, s88, 0x1000
s_and_b32 s88, s88, 0x1ffff
v_lshrrev_b32 v24, 3, v0
v_lshl_add_u32 v24, v24, 7, s88
v_min_u32 v24, L_k1_codeend-L_k1_pc-4, v24
global_load_dword v150, v24, s[90:91]
v_and_b32 v1, 63, v0
v_lshrrev_b32 v2, 6, v0
s_nop 0
v_readfirstlane_b32 s68, v2
s_and_b32 s88, s2, 7
s_lshr_b32 s89, s2, 3
s_lshr_b32 s69, s88, 2
s_and_b32 s88, s88, 3
s_lshl_b32 s88, s88, 1
s_and_b32 s70, s89, 1
s_add_u32 s70, s70, s88
s_lshr_b32 s71, s89, 1
s_mul_i32 s73, s68, 0xc00
s_mul_i32 s74, s68, 0xc20
s_mov_b32 s82, 0x3dd53b95
s_mov_b32 s43, 0x41000000
s_mov_b32 s83, 0
s_sub_u32 s89, s71, 10
s_cmp_ge_u32 s71, 10
s_cselect_b32 s72, s89, s71
s_and_b32 s89, s70, 1
s_cmp_lg_u32 s89, 0
s_movk_i32 s88, 0x80
s_cselect_b32 s94, 0x100, s88
s_cselect_b32 s95, 0x180, s88
s_cselect_b32 s81, 0x480, s88
s_and_b32 s97, s71, 1
s_mul_i32 s97, s97, 5
s_add_u32 s8, s70, 1
s_and_b32 s8, s8, 7
s_sub_u32 s8, s8, 10
s_add_u32 s9, s97, 8
s_lshl_b32 s88, s68, 1
s_and_b32 s89, s68, 1
s_lshl_b32 s84, s89, 1
s_lshr_b32 s89, s68, 1
s_lshl_b32 s85, s89, 3
s_add_u32 s84, s84, s85
s_lshl_b32 s85, s68, 5
v_lshrrev_b32 v2, 3, v1
v_add_u32 v2, s85, v2
v_mul_u32_u24 v2, 0x500, v2
v_bfe_u32 v3, v1, 4, 1
v_and_b32 v4, 7, v1
v_xor_b32 v3, v3, v4
v_xor_b32 v4, 0, v3
v_lshl_add_u32 v4, v4, 4, v2
v_add_u32 v208, 0, v4
v_xor_b32 v4, 2, v3
v_lshl_add_u32 v4, v4, 4, v2
v_add_u32 v209, 0x2400, v4
v_xor_b32 v4, 4, v3
v_lshl_add_u32 v4, v4, 4, v2
v_add_u32 v210, 0x4800, v4
v_xor_b32 v4, 6, v3
v_lshl_add_u32 v4, v4, 4, v2
v_add_u32 v211, 0x6c00, v4
s_lshl_b32 s96, s68, 12
s_add_u32 s96, s96, 0x17680
s_lshl_b32 s42, s72, 7
s_mov_b32 s78, s84
s_movk_i32 s86, 0x3000
v_add_u32 v2, 0, v1
v_mul_u32_u24 v12, 0xab, v2
v_lshrrev_b32 v12, 12, v12
v_mul_u32_u24 v4, 24, v12
v_sub_u32 v16, v2, v4
v_and_b32 v5, 1, v12
v_add_u32 v5, s78, v5
v_bfe_u32 v6, v12, 1, 1
v_lshl_add_u32 v2, v6, 2, v5
v_lshrrev_b32 v6, 2, v12
v_lshl_add_u32 v8, v6, 4, v2
v_lshlrev_b32 v6, 4, v16
v_subrev_u32 v20, 0, v6
v_mad_u32_u24 v238, v8, s86, v20
v_add_u32 v2, 64, v1
v_mul_u32_u24 v13, 0xab, v2
v_lshrrev_b32 v13, 12, v13
v_mul_u32_u24 v4, 24, v13
v_sub_u32 v17, v2, v4
v_and_b32 v5, 1, v13
v_add_u32 v5, s78, v5
v_bfe_u32 v6, v13, 1, 1
v_lshl_add_u32 v2, v6, 2, v5
v_lshrrev_b32 v6, 2, v13
v_lshl_add_u32 v9, v6, 4, v2
v_lshlrev_b32 v6, 4, v17
v_subrev_u32 v21, 0x400, v6
v_mad_u32_u24 v239, v9, s86, v21
v_add_u32 v2, 0x80, v1
v_mul_u32_u24 v14, 0xab, v2
v_lshrrev_b32 v14, 12, v14
v_mul_u32_u24 v4, 24, v14
v_sub_u32 v18, v2, v4
v_and_b32 v5, 1, v14
v_add_u32 v5, s78, v5
v_bfe_u32 v6, v14, 1, 1
v_lshl_add_u32 v2, v6, 2, v5
v_lshrrev_b32 v6, 2, v14
v_lshl_add_u32 v10, v6, 4, v2
v_lshlrev_b32 v6, 4, v18
v_subrev_u32 v22, 0x800, v6
v_mad_u32_u24 v240, v10, s86, v22
wl 0
s_cmp_lg_u32 s69, 0
s_cselect_b32 s44, s26, s16
s_cselect_b32 s45, s27, s17
s_cselect_b32 s48, s28, s18
s_cselect_b32 s49, s29, s19
s_cselect_b32 s52, s30, s20
s_cselect_b32 s53, s31, s21
s_cselect_b32 s56, s32, s22
s_cselect_b32 s57, s33, s23
s_cselect_b32 s92, s34, s24
s_cselect_b32 s93, s35, s25
s_mul_i32 s88, s71, 0x28000
s_add_u32 s44, s44, s88
s_addc_u32 s45, s45, 0
s_and_b32 s45, s45, 0xffff
s_mov_b32 s46, 0x28000
s_mov_b32 s47, 0x20000
s_mul_i32 s88, s70, 0x600
s_sub_u32 s89, 0x780000, s88
s_add_u32 s56, s56, s88
s_addc_u32 s57, s57, 0
s_and_b32 s57, s57, 0xffff
s_mov_b32 s58, 0
s_mov_b32 s59, 0x20000
s_mov_b32 s58, s89
s_mul_i32 s77, s72, 0xc0000
s_mov_b32 s79, 0x780000
s_mov_b32 s80, 0x60000
s_bitcmp1_b32 s70, 0
s_cselect_b32 s16, 0x120000, s80
s_cselect_b32 s17, 0x1e0000, s80
s_cselect_b32 s18, 0x660000, s80
s_add_u32 m0, s96, 0x8000
s_nop 0
buffer_load_dwordx4 v208, s[44:47], s42 offen offset:0 lds
buffer_load_dwordx4 v209, s[44:47], s42 offen offset:1024 lds
buffer_load_dwordx4 v210, s[44:47], s42 offen offset:2048 lds
buffer_load_dwordx4 v211, s[44:47], s42 offen offset:3072 lds
s_add_u32 s42, s42, s94
s_sub_u32 s24, s42, 0x500
s_min_u32 s42, s42, s24
s_add_u32 m0, s74, 0x12300
s_nop 0
buffer_load_dwordx4 v238, s[56:59], s77 offen lds
buffer_load_dwordx4 v239, s[56:59], s77 offen offset:1024 lds
buffer_load_dwordx4 v240, s[56:59], s77 offen offset:2048 lds
s_add_u32 s77, s77, s80
s_add_u32 m0, s74, 0
s_nop 0
buffer_load_dwordx4 v238, s[56:59], s77 offen lds
buffer_load_dwordx4 v239, s[56:59], s77 offen offset:1024 lds
buffer_load_dwordx4 v240, s[56:59], s77 offen offset:2048 lds
s_add_u32 s77, s77, s16
s_sub_u32 s23, s77, s79
s_min_u32 s77, s77, s23
v_bfe_u32 v6, v12, 1, 1
v_lshl_add_u32 v5, s68, 1, v6
v_xor_b32 v5, v5, v1
v_lshl_add_u32 v232, v5, 4, s73
v_and_b32 v5, 1, v12
v_add_u32 v5, s78, v5
v_lshl_add_u32 v5, v6, 4, v5
v_lshrrev_b32 v6, 2, v12
v_lshl_add_u32 v5, v6, 2, v5
v_mul_u32_u24 v3, 0x180, v8
v_add_u32 v235, v3, v20
v_lshrrev_b32 v3, 3, v16
v_lshrrev_b32 v2, 1, v3
v_mad_i32_i24 v3, v2, s8, v3
v_add_u32 v3, s9, v3
v_subrev_u32 v2, 10, v3
v_min_u32 v3, v2, v3
v_lshlrev_b32 v3, 7, v3
v_and_b32 v2, 7, v16
v_lshl_add_u32 v3, v2, 4, v3
v_mul_u32_u24 v5, 0x500, v5
v_add_u32 v3, v3, v5
v_subrev_u32 v3, 0, v3
v_accvgpr_write_b32 a252, v3
v_bfe_u32 v6, v13, 1, 1
v_lshl_add_u32 v5, s68, 1, v6
v_xor_b32 v5, v5, v1
v_lshl_add_u32 v233, v5, 4, s73
v_and_b32 v5, 1, v13
v_add_u32 v5, s78, v5
v_lshl_add_u32 v5, v6, 4, v5
v_lshrrev_b32 v6, 2, v13
v_lshl_add_u32 v5, v6, 2, v5
v_mul_u32_u24 v3, 0x180, v9
v_add_u32 v236, v3, v21
v_lshrrev_b32 v3, 3, v17
v_lshrrev_b32 v2, 1, v3
v_mad_i32_i24 v3, v2, s8, v3
v_add_u32 v3, s9, v3
v_subrev_u32 v2, 10, v3
v_min_u32 v3, v2, v3
v_lshlrev_b32 v3, 7, v3
v_and_b32 v2, 7, v17
v_lshl_add_u32 v3, v2, 4, v3
v_mul_u32_u24 v5, 0x500, v5
v_add_u32 v3, v3, v5
v_subrev_u32 v3, 0x400, v3
v_accvgpr_write_b32 a253, v3
v_bfe_u32 v6, v14, 1, 1
v_lshl_add_u32 v5, s68, 1, v6
v_xor_b32 v5, v5, v1
v_lshl_add_u32 v234, v5, 4, s73
v_and_b32 v5, 1, v14
v_add_u32 v5, s78, v5
v_lshl_add_u32 v5, v6, 4, v5
v_lshrrev_b32 v6, 2, v14
v_lshl_add_u32 v5, v6, 2, v5
v_mul_u32_u24 v3, 0x180, v10
v_add_u32 v237, v3, v22
v_lshrrev_b32 v3, 3, v18
v_lshrrev_b32 v2, 1, v3
v_mad_i32_i24 v3, v2, s8, v3
v_add_u32 v3, s9, v3
v_subrev_u32 v2, 10, v3
v_min_u32 v3, v2, v3
v_lshlrev_b32 v3, 7, v3
v_and_b32 v2, 7, v18
v_lshl_add_u32 v3, v2, 4, v3
v_mul_u32_u24 v5, 0x500, v5
v_add_u32 v3, v3, v5
v_subrev_u32 v3, 0x800, v3
v_accvgpr_write_b32 a254, v3
s_lshl_b32 s88, s71, 3
s_add_u32 s88, s88, s70
s_mul_i32 s88, s88, 0xc0000
s_add_u32 s48, s48, s88
s_addc_u32 s49, s49, 0
s_and_b32 s49, s49, 0xffff
s_mov_b32 s50, 0xc0000
s_mov_b32 s51, 0x20000
s_add_u32 s52, s52, s88
s_addc_u32 s53, s53, 0
s_and_b32 s53, s53, 0xffff
s_mov_b32 s54, 0xc0000
s_mov_b32 s55, 0x20000
s_mul_i32 s88, s70, 0xf0000
s_add_u32 s92, s92, s88
s_addc_u32 s93, s93, 0
s_and_b32 s93, s93, 0xffff
s_lshl_b32 s88, s69, 4
s_add_u32 s88, s88, s71
s_lshl_b32 s14, s88, 3
s_mul_i32 s89, s88, 0x128000
s_mul_i32 s88, s68, 0x9400
s_add_u32 s89, s89, s88
s_add_u32 s60, s40, s89
s_addc_u32 s61, s41, 0
s_and_b32 s61, s61, 0xffff
s_mov_b32 s62, 0x10c400
s_mov_b32 s63, 0x20000
s_add_u32 s4, s38, 0
s_addc_u32 s5, s39, 0
s_and_b32 s5, s5, 0xffff
s_mov_b32 s6, 0x100
s_mov_b32 s7, 0x20000
s_lshl_b32 s10, s70, 10
s_mul_i32 s11, s70, 0x25000
s_add_u32 s12, s11, 0x9000
s_mov_b32 s15, 0
s_lshl_b32 s88, s71, 2
s_add_u32 s88, s88, s68
s_mul_i32 s88, s88, 0x14000
s_mul_i32 s89, s69, 0x500
s_add_u32 s88, s88, s89
s_add_u32 s64, s36, s88
s_addc_u32 s65, s37, 0
s_and_b32 s65, s65, 0xffff
s_mov_b32 s66, 0x13b00
s_mov_b32 s67, 0x20000
s_mov_b32 s75, 0
s_mov_b32 s76, 0
s_mov_b32 s26, s82
s_mov_b32 s27, s82
v_lshlrev_b32 v250, 4, v1
v_and_b32 v2, 3, v1
v_bfe_u32 v3, v1, 2, 2
v_lshl_add_u32 v2, v3, 3, v2
v_lshl_add_u32 v6, v2, 7, s96
v_mul_u32_u24 v2, 0x180, v2
v_bfe_u32 v3, v1, 1, 3
v_lshrrev_b32 v4, 4, v1
v_add_u32 v5, 0, v4
v_xor_b32 v5, v5, v3
v_lshl_add_u32 v241, v5, 4, v2
v_lshl_add_u32 v212, v5, 4, v6
v_add_u32 v243, 0xf280, v241
v_add_u32 v245, 0x1e500, v241
v_add_u32 v5, 4, v4
v_xor_b32 v5, v5, v3
v_lshl_add_u32 v242, v5, 4, v2
v_lshl_add_u32 v213, v5, 4, v6
v_add_u32 v244, 0xf280, v242
v_add_u32 v246, 0x1e500, v242
v_bfe_u32 v2, v1, 3, 2
v_mul_u32_u24 v2, 0xc20, v2
v_bfe_u32 v3, v1, 2, 1
v_lshrrev_b32 v4, 5, v1
v_lshl_add_u32 v3, v4, 2, v3
v_mul_u32_u24 v3, 0x180, v3
v_add_u32 v2, v2, v3
v_and_b32 v3, 1, v1
v_lshl_add_u32 v2, v3, 4, v2
v_bfe_u32 v3, v1, 1, 1
v_lshl_add_u32 v247, v3, 3, v2
v_add_u32 v248, 0xf280, v247
v_add_u32 v249, 0x1e500, v247
v_mov_b32 v2, 0x3f803f80
v_and_b32 v3, 3, v1
v_cmp_eq_u32 vcc, 0, v3
s_nop 1
v_cndmask_b32 v2, 0, v2, vcc
v_accvgpr_write_b32 a248, v2
v_accvgpr_write_b32 a249, v2
v_accvgpr_write_b32 a250, v2
v_accvgpr_write_b32 a251, v2
s_add_u32 m0, s96, 0xc000
s_nop 0
buffer_load_dwordx4 v208, s[44:47], s42 offen offset:0 lds
buffer_load_dwordx4 v209, s[44:47], s42 offen offset:1024 lds
buffer_load_dwordx4 v210, s[44:47], s42 offen offset:2048 lds
buffer_load_dwordx4 v211, s[44:47], s42 offen offset:3072 lds
s_add_u32 s42, s42, s81
s_sub_u32 s24, s42, 0x500
s_min_u32 s42, s42, s24
s_mov_b64 exec, 0
s_cmp_eq_u32 s68, 1
s_cbranch_scc1 L_k1_ps2
s_cmp_eq_u32 s68, 2
s_cbranch_scc1 L_k1_ps3
s_cmp_eq_u32 s68, 3
s_cbranch_scc1 L_k1_ps11
s_branch L_k1_ps1
L_k1_pr0:
s_mov_b64 exec, -1
s_add_u32 m0, s74, 0x3080
s_nop 0
buffer_load_dwordx4 v238, s[56:59], s77 offen lds
buffer_load_dwordx4 v239, s[56:59], s77 offen offset:1024 lds
buffer_load_dwordx4 v240, s[56:59], s77 offen offset:2048 lds
s_add_u32 s77, s77, s80
s_add_u32 m0, s74, 0x6100
s_nop 0
buffer_load_dwordx4 v238, s[56:59], s77 offen lds
buffer_load_dwordx4 v239, s[56:59], s77 offen offset:1024 lds
buffer_load_dwordx4 v240, s[56:59], s77 offen offset:2048 lds
s_add_u32 s77, s77, s18
s_sub_u32 s23, s77, s79
s_min_u32 s77, s77, s23
s_waitcnt vmcnt(10)
rqa 0,212,32768
rqa 4,212,33280
rqa 8,213,32768
rqa 12,213,33280
s_barrier
tra 208,248,12416
tra 210,248,13184
tra 212,248,12448
tra 214,248,13216
tra 216,248,12480
tra 218,248,13248
tra 220,248,12512
tra 222,248,13280
tra 224,248,12544
tra 226,248,13312
tra 228,248,12576
tra 230,248,13344
tra 232,248,12608
tra 234,248,13376
wl 12
zvaa 0,208,0
s_add_u32 m0, s96, 0
tra 236,248,12640
tra 238,248,13408
zvaa 8,208,4
wl 12
tra 208,248,12672
tra 210,248,13440
zvaa 4,212,0
buffer_load_dwordx4 v208, s[44:47], s42 offen offset:0 lds
zvaa 12,212,4
wl 12
tra 212,248,12704
zvaa 16,216,0
tra 214,248,13472
zvaa 24,216,4
wl 12
tra 216,248,12736
tra 218,248,13504
zvaa 20,220,0
buffer_load_dwordx4 v209, s[44:47], s42 offen offset:1024 lds
zvaa 28,220,4
wl 12
tra 220,248,12768
zvaa 32,224,0
tra 222,248,13536
zvaa 40,224,4
wl 12
tra 224,247,0
tra 226,247,768
zvaa 36,228,0
buffer_load_dwordx4 v210, s[44:47], s42 offen offset:2048 lds
zvaa 44,228,4
wl 12
tra 228,247,32
zvaa 48,232,0
tra 230,247,800
zvaa 56,232,4
wl 12
tra 232,247,64
tra 234,247,832
zvaa 52,236,0
buffer_load_dwordx4 v211, s[44:47], s42 offen offset:3072 lds
zvaa 60,236,4
wl 12
s_add_u32 s42, s42, s95
tra 236,247,96
zvaa 64,208,0
s_sub_u32 s24, s42, 0x500
s_min_u32 s42, s42, s24
tra 238,247,864
zvaa 72,208,4
wl 12
tra 208,247,128
tra 210,247,896
zvaa 68,212,0
s_add_u32 m0, s74, 0x9180
s_nop 0
buffer_load_dwordx4 v238, s[56:59], s77 offen lds
zvaa 76,212,4
wl 12
tra 212,247,160
zvaa 80,216,0
tra 214,247,928
zvaa 88,216,4
wl 12
tra 216,247,192
buffer_load_dwordx4 v239, s[56:59], s77 offen offset:1024 lds
zvaa 84,220,0
tra 218,247,960
zvaa 92,220,4
wl 12
tra 220,247,224
mvaa 0,224,8
tra 222,247,992
mvaa 8,224,12
wl 12
buffer_load_dwordx4 v240, s[56:59], s77 offen offset:2048 lds
mvaa 4,228,8
s_add_u32 s77, s77, s80
tra 224,247,256
mvaa 12,228,12
wl 11
tra 226,247,1024
mvaa 16,232,8
s_add_u32 m0, s74, 0xc200
tra 228,247,288
mvaa 24,232,12
wl 11
buffer_load_dwordx4 v238, s[56:59], s77 offen lds
mvaa 20,236,8
tra 230,247,1056
mvaa 28,236,12
wl 10
tra 232,247,320
mvaa 32,208,8
tra 234,247,1088
mvaa 40,208,12
wl 10
tra 236,247,352
mvaa 36,212,8
buffer_load_dwordx4 v239, s[56:59], s77 offen offset:1024 lds
mvaa 44,212,12
wl 9
tra 238,247,1120
mvaa 48,216,8
mvaa 56,216,12
wl 8
buffer_load_dwordx4 v240, s[56:59], s77 offen offset:2048 lds
mvaa 52,220,8
s_mov_b64 exec, 0
s_cmp_eq_u32 s68, 1
s_cbranch_scc1 L_k1_ps13
s_cmp_eq_u32 s68, 2
s_cbranch_scc1 L_k1_ps14
s_cmp_eq_u32 s68, 3
s_cbranch_scc1 L_k1_ps15
s_branch L_k1_ps12
L_k1_pr1:
s_mov_b64 exec, -1
s_waitcnt vmcnt(10) lgkmcnt(0)
mvaa 60,220,12
s_barrier
mvaa 64,224,8
s_add_u32 s77, s77, s17
s_sub_u32 s23, s77, s79
rqa 16,212,49152
mvaa 72,224,12
tra 208,247,12416
rqa 20,212,49664
mvaa 68,228,8
s_add_u32 m0, s96, 0x4000
tra 210,247,13184
buffer_load_dwordx4 v208, s[44:47], s42 offen offset:0 lds
mvaa 76,228,12
tra 212,247,12448
tra 214,247,13216
mvaa 80,232,8
s_min_u32 s77, s77, s23
rqa 24,213,49152
mvaa 88,232,12
rqa 28,213,49664
mvaa 84,236,8
tra 216,247,12480
buffer_load_dwordx4 v209, s[44:47], s42 offen offset:1024 lds
mvaa 92,236,12
wl 5
tra 218,247,13248
tra 220,247,12512
mvaa 0,208,16
tra 222,247,13280
tra 224,247,12544
mvaa 8,208,20
wl 7
tra 226,247,13312
tra 228,247,12576
mvaa 4,212,16
tra 230,247,13344
tra 232,247,12608
mvaa 12,212,20
wl 7
tra 234,247,13376
tra 236,247,12640
mvaa 16,216,16
tra 238,247,13408
buffer_load_dwordx4 v210, s[44:47], s42 offen offset:2048 lds
mvaa 24,216,20
wl 8
tra 208,247,12672
tra 210,247,13440
mvaa 20,220,16
tra 212,247,12704
tra 214,247,13472
mvaa 28,220,20
wl 10
tra 216,247,12736
tra 218,247,13504
mvaa 32,224,16
tra 220,247,12768
buffer_load_dwordx4 v211, s[44:47], s42 offen offset:3072 lds
mvaa 40,224,20
wl 11
s_add_u32 s42, s42, s81
tra 222,247,13536
mvaa 36,228,16
s_sub_u32 s24, s42, 0x500
s_min_u32 s42, s42, s24
tra 224,247,24832
mvaa 44,228,20
wl 11
tra 226,247,25600
tra 228,247,24864
mvaa 48,232,16
s_add_u32 m0, s74, 0xf280
tra 230,247,25632
mvaa 56,232,20
wl 12
tra 232,247,24896
buffer_load_dwordx4 v238, s[56:59], s77 offen lds
mvaa 52,236,16
tra 234,247,25664
mvaa 60,236,20
wl 12
tra 236,247,24928
mvaa 64,208,16
tra 238,247,25696
mvaa 72,208,20
wl 12
tra 208,247,24960
tra 210,247,25728
mvaa 68,212,16
buffer_load_dwordx4 v239, s[56:59], s77 offen offset:1024 lds
mvaa 76,212,20
wl 12
tra 212,247,24992
mvaa 80,216,16
tra 214,247,25760
mvaa 88,216,20
wl 12
tra 216,247,25024
mvaa 84,220,16
tra 218,247,25792
mvaa 92,220,20
wl 12
buffer_load_dwordx4 v240, s[56:59], s77 offen offset:2048 lds
mvaa 0,224,24
s_add_u32 s77, s77, s80
tra 220,247,25056
mvaa 8,224,28
wl 11
tra 222,247,25824
mvaa 4,228,24
s_add_u32 m0, s74, 0x12300
tra 224,247,25088
mvaa 12,228,28
wl 11
buffer_load_dwordx4 v238, s[56:59], s77 offen lds
mvaa 16,232,24
tra 226,247,25856
mvaa 24,232,28
wl 10
tra 228,247,25120
mvaa 20,236,24
tra 230,247,25888
mvaa 28,236,28
wl 10
tra 232,247,25152
mvaa 32,208,24
buffer_load_dwordx4 v239, s[56:59], s77 offen offset:1024 lds
mvaa 40,208,28
wl 9
tra 234,247,25920
mvaa 36,212,24
tra 236,247,25184
mvaa 44,212,28
wl 9
tra 238,247,25952
mvaa 48,216,24
L_k1_ps1:
s_cbranch_execz L_k1_pr0
mvaa 56,216,28
wl 8
buffer_load_dwordx4 v240, s[56:59], s77 offen offset:2048 lds
mvaa 52,220,24
s_waitcnt vmcnt(10) lgkmcnt(0)
s_add_u32 s77, s77, s18
mvaa 60,220,28
s_barrier
mvaa 64,224,24
s_sub_u32 s23, s77, s79
s_min_u32 s77, s77, s23
rqa 32,212,0
mvaa 72,224,28
tra 208,247,37248
rqa 36,212,512
mvaa 68,228,24
s_add_u32 m0, s96, 0x8000
tra 210,247,38016
buffer_load_dwordx4 v208, s[44:47], s42 offen offset:0 lds
mvaa 76,228,28
tra 212,247,37280
tra 214,247,38048
mvaa 80,232,24
rqa 40,213,0
mvaa 88,232,28
rqa 44,213,512
mvaa 84,236,24
tra 216,247,37312
buffer_load_dwordx4 v209, s[44:47], s42 offen offset:1024 lds
mvaa 92,236,28
wl 5
tra 218,247,38080
tra 220,247,37344
mvaa 0,208,32
tra 222,247,38112
tra 224,247,37376
mvaa 8,208,36
wl 7
tra 226,247,38144
tra 228,247,37408
mvaa 4,212,32
tra 230,247,38176
tra 232,247,37440
mvaa 12,212,36
wl 7
tra 234,247,38208
tra 236,247,37472
mvaa 16,216,32
tra 238,247,38240
buffer_load_dwordx4 v210, s[44:47], s42 offen offset:2048 lds
mvaa 24,216,36
wl 8
tra 208,247,37504
tra 210,247,38272
mvaa 20,220,32
tra 212,247,37536
tra 214,247,38304
mvaa 28,220,36
wl 10
tra 216,247,37568
tra 218,247,38336
mvaa 32,224,32
tra 220,247,37600
buffer_load_dwordx4 v211, s[44:47], s42 offen offset:3072 lds
mvaa 40,224,36
wl 11
s_add_u32 s42, s42, s95
tra 222,247,38368
mvaa 36,228,32
s_sub_u32 s24, s42, 0x500
s_min_u32 s42, s42, s24
tra 224,247,49664
mvaa 44,228,36
wl 11
tra 226,247,50432
tra 228,247,49696
mvaa 48,232,32
s_add_u32 m0, s74, 0
tra 230,247,50464
mvaa 56,232,36
wl 12
tra 232,247,49728
buffer_load_dwordx4 v238, s[56:59], s77 offen lds
mvaa 52,236,32
tra 234,247,50496
mvaa 60,236,36
wl 12
tra 236,247,49760
mvaa 64,208,32
tra 238,247,50528
mvaa 72,208,36
wl 12
tra 208,247,49792
tra 210,247,50560
mvaa 68,212,32
buffer_load_dwordx4 v239, s[56:59], s77 offen offset:1024 lds
mvaa 76,212,36
wl 12
tra 212,247,49824
mvaa 80,216,32
tra 214,247,50592
mvaa 88,216,36
wl 12
tra 216,247,49856
mvaa 84,220,32
tra 218,247,50624
mvaa 92,220,36
wl 12
buffer_load_dwordx4 v240, s[56:59], s77 offen offset:2048 lds
mvaa 0,224,40
s_add_u32 s77, s77, s80
tra 220,247,49888
mvaa 8,224,44
wl 11
tra 222,247,50656
mvaa 4,228,40
s_add_u32 m0, s74, 0x3080
tra 224,247,49920
mvaa 12,228,44
wl 11
buffer_load_dwordx4 v238, s[56:59], s77 offen lds
mvaa 16,232,40
tra 226,247,50688
mvaa 24,232,44
wl 10
tra 228,247,49952
mvaa 20,236,40
tra 230,247,50720
mvaa 28,236,44
wl 10
tra 232,247,49984
mvaa 32,208,40
buffer_load_dwordx4 v239, s[56:59], s77 offen offset:1024 lds
mvaa 40,208,44
wl 9
tra 234,247,50752
mvaa 36,212,40
tra 236,247,50016
mvaa 44,212,44
wl 9
tra 238,247,50784
mvaa 48,216,40
mvaa 56,216,44
wl 8
buffer_load_dwordx4 v240, s[56:59], s77 offen offset:2048 lds
mvaa 52,220,40
s_waitcnt vmcnt(10) lgkmcnt(0)
s_add_u32 s77, s77, s17
mvaa 60,220,44
s_barrier
mvaa 64,224,40
s_sub_u32 s23, s77, s79
s_min_u32 s77, s77, s23
rqa 48,212,16384
mvaa 72,224,44
tra 208,248,0
rqa 52,212,16896
mvaa 68,228,40
s_add_u32 m0, s96, 0xc000
tra 210,248,768
buffer_load_dwordx4 v208, s[44:47], s42 offen offset:0 lds
mvaa 76,228,44
tra 212,248,32
tra 214,248,800
mvaa 80,232,40
rqa 56,213,16384
mvaa 88,232,44
rqa 60,213,16896
mvaa 84,236,40
tra 216,248,64
buffer_load_dwordx4 v209, s[44:47], s42 offen offset:1024 lds
mvaa 92,236,44
wl 5
tra 218,248,832
tra 220,248,96
mvaa 0,208,48
tra 222,248,864
tra 224,248,128
mvaa 8,208,52
wl 7
tra 226,248,896
tra 228,248,160
mvaa 4,212,48
tra 230,248,928
tra 232,248,192
mvaa 12,212,52
wl 7
tra 234,248,960
tra 236,248,224
mvaa 16,216,48
tra 238,248,992
buffer_load_dwordx4 v210, s[44:47], s42 offen offset:2048 lds
mvaa 24,216,52
wl 8
tra 208,248,256
tra 210,248,1024
mvaa 20,220,48
tra 212,248,288
tra 214,248,1056
mvaa 28,220,52
wl 10
tra 216,248,320
tra 218,248,1088
mvaa 32,224,48
tra 220,248,352
buffer_load_dwordx4 v211, s[44:47], s42 offen offset:3072 lds
mvaa 40,224,52
wl 11
s_add_u32 s42, s42, s81
tra 222,248,1120
mvaa 36,228,48
s_sub_u32 s24, s42, 0x500
s_min_u32 s42, s42, s24
tra 224,248,12416
mvaa 44,228,52
wl 11
tra 226,248,13184
tra 228,248,12448
mvaa 48,232,48
s_add_u32 m0, s74, 0x6100
tra 230,248,13216
mvaa 56,232,52
wl 12
tra 232,248,12480
buffer_load_dwordx4 v238, s[56:59], s77 offen lds
mvaa 52,236,48
tra 234,248,13248
mvaa 60,236,52
wl 12
tra 236,248,12512
mvaa 64,208,48
tra 238,248,13280
mvaa 72,208,52
wl 12
tra 208,248,12544
tra 210,248,13312
mvaa 68,212,48
buffer_load_dwordx4 v239, s[56:59], s77 offen offset:1024 lds
mvaa 76,212,52
wl 12
tra 212,248,12576
mvaa 80,216,48
tra 214,248,13344
mvaa 88,216,52
wl 12
tra 216,248,12608
mvaa 84,220,48
tra 218,248,13376
mvaa 92,220,52
wl 12
buffer_load_dwordx4 v240, s[56:59], s77 offen offset:2048 lds
mvaa 0,224,56
s_add_u32 s77, s77, s80
tra 220,248,12640
mvaa 8,224,60
wl 11
tra 222,248,13408
mvaa 4,228,56
s_add_u32 m0, s74, 0x9180
tra 224,248,12672
mvaa 12,228,60
wl 11
buffer_load_dwordx4 v238, s[56:59], s77 offen lds
mvaa 16,232,56
tra 226,248,13440
mvaa 24,232,60
wl 10
tra 228,248,12704
mvaa 20,236,56
tra 230,248,13472
mvaa 28,236,60
wl 10
tra 232,248,12736
mvaa 32,208,56
buffer_load_dwordx4 v239, s[56:59], s77 offen offset:1024 lds
mvaa 40,208,60
wl 9
tra 234,248,13504
mvaa 36,212,56
tra 236,248,12768
mvaa 44,212,60
wl 9
tra 238,248,13536
mvaa 48,216,56
mvaa 56,216,60
wl 8
buffer_load_dwordx4 v240, s[56:59], s77 offen offset:2048 lds
mvaa 52,220,56
s_waitcnt vmcnt(10) lgkmcnt(0)
s_add_u32 s77, s77, s18
mvaa 60,220,60
s_barrier
mvaa 64,224,56
s_sub_u32 s23, s77, s79
s_min_u32 s77, s77, s23
rqa 64,212,32768
mvaa 72,224,60
tra 208,247,0
rqa 68,212,33280
mvaa 68,228,56
s_add_u32 m0, s96, 0
tra 210,247,768
buffer_load_dwordx4 v208, s[44:47], s42 offen offset:0 lds
mvaa 76,228,60
tra 212,247,32
tra 214,247,800
mvaa 80,232,56
rqa 72,213,32768
mvaa 88,232,60
rqa 76,213,33280
mvaa 84,236,56
tra 216,247,64
buffer_load_dwordx4 v209, s[44:47], s42 offen offset:1024 lds
mvaa 92,236,60
wl 5
tra 218,247,832
tra 220,247,96
mvaa 0,208,64
tra 222,247,864
tra 224,247,128
mvaa 8,208,68
wl 7
tra 226,247,896
tra 228,247,160
mvaa 4,212,64
tra 230,247,928
tra 232,247,192
mvaa 12,212,68
wl 7
tra 234,247,960
tra 236,247,224
mvaa 16,216,64
tra 238,247,992
buffer_load_dwordx4 v210, s[44:47], s42 offen offset:2048 lds
mvaa 24,216,68
wl 8
tra 208,247,256
tra 210,247,1024
mvaa 20,220,64
tra 212,247,288
tra 214,247,1056
mvaa 28,220,68
wl 10
tra 216,247,320
tra 218,247,1088
mvaa 32,224,64
tra 220,247,352
buffer_load_dwordx4 v211, s[44:47], s42 offen offset:3072 lds
mvaa 40,224,68
wl 11
s_add_u32 s42, s42, s95
tra 222,247,1120
mvaa 36,228,64
s_sub_u32 s24, s42, 0x500
s_min_u32 s42, s42, s24
tra 224,247,12416
mvaa 44,228,68
wl 11
tra 226,247,13184
tra 228,247,12448
mvaa 48,232,64
s_add_u32 m0, s74, 0xc200
tra 230,247,13216
mvaa 56,232,68
wl 12
tra 232,247,12480
buffer_load_dwordx4 v238, s[56:59], s77 offen lds
mvaa 52,236,64
tra 234,247,13248
mvaa 60,236,68
wl 12
tra 236,247,12512
mvaa 64,208,64
tra 238,247,13280
mvaa 72,208,68
wl 12
tra 208,247,12544
tra 210,247,13312
mvaa 68,212,64
buffer_load_dwordx4 v239, s[56:59], s77 offen offset:1024 lds
mvaa 76,212,68
wl 12
tra 212,247,12576
mvaa 80,216,64
tra 214,247,13344
mvaa 88,216,68
wl 12
tra 216,247,12608
mvaa 84,220,64
tra 218,247,13376
mvaa 92,220,68
wl 12
buffer_load_dwordx4 v240, s[56:59], s77 offen offset:2048 lds
mvaa 0,224,72
s_add_u32 s77, s77, s80
tra 220,247,12640
mvaa 8,224,76
wl 11
tra 222,247,13408
mvaa 4,228,72
s_add_u32 m0, s74, 0xf280
tra 224,247,12672
mvaa 12,228,76
wl 11
buffer_load_dwordx4 v238, s[56:59], s77 offen lds
mvaa 16,232,72
tra 226,247,13440
mvaa 24,232,76
wl 10
tra 228,247,12704
mvaa 20,236,72
tra 230,247,13472
mvaa 28,236,76
wl 10
tra 232,247,12736
mvaa 32,208,72
buffer_load_dwordx4 v239, s[56:59], s77 offen offset:1024 lds
mvaa 40,208,76
wl 9
tra 234,247,13504
mvaa 36,212,72
tra 236,247,12768
mvaa 44,212,76
wl 9
tra 238,247,13536
mvaa 48,216,72
mvaa 56,216,76
wl 8
buffer_load_dwordx4 v240, s[56:59], s77 offen offset:2048 lds
mvaa 52,220,72
s_waitcnt vmcnt(10) lgkmcnt(0)
s_add_u32 s77, s77, s17
mvaa 60,220,76
s_barrier
mvaa 64,224,72
s_sub_u32 s23, s77, s79
s_min_u32 s77, s77, s23
rqa 80,212,49152
mvaa 72,224,76
tra 208,247,24832
rqa 84,212,49664
mvaa 68,228,72
s_add_u32 m0, s96, 0x4000
tra 210,247,25600
buffer_load_dwordx4 v208, s[44:47], s42 offen offset:0 lds
mvaa 76,228,76
tra 212,247,24864
tra 214,247,25632
mvaa 80,232,72
rqa 88,213,49152
mvaa 88,232,76
rqa 92,213,49664
mvaa 84,236,72
tra 216,247,24896
buffer_load_dwordx4 v209, s[44:47], s42 offen offset:1024 lds
mvaa 92,236,76
wl 5
tra 218,247,25664
tra 220,247,24928
mvaa 0,208,80
tra 222,247,25696
tra 224,247,24960
mvaa 8,208,84
wl 7
tra 226,247,25728
tra 228,247,24992
mvaa 4,212,80
tra 230,247,25760
tra 232,247,25024
mvaa 12,212,84
wl 7
tra 234,247,25792
tra 236,247,25056
mvaa 16,216,80
tra 238,247,25824
buffer_load_dwordx4 v210, s[44:47], s42 offen offset:2048 lds
mvaa 24,216,84
wl 8
tra 208,247,25088
tra 210,247,25856
mvaa 20,220,80
tra 212,247,25120
tra 214,247,25888
mvaa 28,220,84
wl 10
tra 216,247,25152
tra 218,247,25920
mvaa 32,224,80
tra 220,247,25184
buffer_load_dwordx4 v211, s[44:47], s42 offen offset:3072 lds
mvaa 40,224,84
wl 11
s_add_u32 s42, s42, s81
tra 222,247,25952
mvaa 36,228,80
s_sub_u32 s24, s42, 0x500
s_min_u32 s42, s42, s24
tra 224,247,37248
mvaa 44,228,84
wl 11
tra 226,247,38016
tra 228,247,37280
mvaa 48,232,80
s_add_u32 m0, s74, 0x12300
tra 230,247,38048
mvaa 56,232,84
wl 12
tra 232,247,37312
buffer_load_dwordx4 v238, s[56:59], s77 offen lds
mvaa 52,236,80
tra 234,247,38080
mvaa 60,236,84
wl 12
tra 236,247,37344
mvaa 64,208,80
tra 238,247,38112
mvaa 72,208,84
wl 12
tra 208,247,37376
tra 210,247,38144
mvaa 68,212,80
buffer_load_dwordx4 v239, s[56:59], s77 offen offset:1024 lds
mvaa 76,212,84
wl 12
tra 212,247,37408
mvaa 80,216,80
tra 214,247,38176
mvaa 88,216,84
wl 12
tra 216,247,37440
mvaa 84,220,80
tra 218,247,38208
mvaa 92,220,84
wl 12
buffer_load_dwordx4 v240, s[56:59], s77 offen offset:2048 lds
mvaa 0,224,88
s_add_u32 s77, s77, s80
tra 220,247,37472
mvaa 8,224,92
wl 11
tra 222,247,38240
mvaa 4,228,88
s_add_u32 m0, s74, 0
tra 224,247,37504
mvaa 12,228,92
wl 11
buffer_load_dwordx4 v238, s[56:59], s77 offen lds
mvaa 16,232,88
tra 226,247,38272
mvaa 24,232,92
wl 10
tra 228,247,37536
mvaa 20,236,88
tra 230,247,38304
mvaa 28,236,92
wl 10
tra 232,247,37568
mvaa 32,208,88
buffer_load_dwordx4 v239, s[56:59], s77 offen offset:1024 lds
mvaa 40,208,92
wl 9
tra 234,247,38336
mvaa 36,212,88
tra 236,247,37600
mvaa 44,212,92
wl 9
tra 238,247,38368
mvaa 48,216,88
L_k1_ps2:
s_cbranch_execz L_k1_pr0
mvaa 56,216,92
wl 8
buffer_load_dwordx4 v240, s[56:59], s77 offen offset:2048 lds
mvaa 52,220,88
s_waitcnt vmcnt(10) lgkmcnt(0)
s_add_u32 s77, s77, s18
mvaa 60,220,92
s_barrier
mvaa 64,224,88
s_sub_u32 s23, s77, s79
s_min_u32 s77, s77, s23
rqa 96,212,0
mvaa 72,224,92
tra 208,247,49664
rqa 100,212,512
mvaa 68,228,88
s_add_u32 m0, s96, 0x8000
tra 210,247,50432
buffer_load_dwordx4 v208, s[44:47], s42 offen offset:0 lds
mvaa 76,228,92
tra 212,247,49696
tra 214,247,50464
mvaa 80,232,88
rqa 104,213,0
mvaa 88,232,92
rqa 108,213,512
mvaa 84,236,88
tra 216,247,49728
buffer_load_dwordx4 v209, s[44:47], s42 offen offset:1024 lds
mvaa 92,236,92
wl 5
tra 218,247,50496
tra 220,247,49760
mvaa 0,208,96
tra 222,247,50528
tra 224,247,49792
mvaa 8,208,100
wl 7
tra 226,247,50560
tra 228,247,49824
mvaa 4,212,96
tra 230,247,50592
tra 232,247,49856
mvaa 12,212,100
wl 7
tra 234,247,50624
tra 236,247,49888
mvaa 16,216,96
tra 238,247,50656
buffer_load_dwordx4 v210, s[44:47], s42 offen offset:2048 lds
mvaa 24,216,100
wl 8
tra 208,247,49920
tra 210,247,50688
mvaa 20,220,96
tra 212,247,49952
tra 214,247,50720
mvaa 28,220,100
wl 10
tra 216,247,49984
tra 218,247,50752
mvaa 32,224,96
tra 220,247,50016
buffer_load_dwordx4 v211, s[44:47], s42 offen offset:3072 lds
mvaa 40,224,100
wl 11
s_add_u32 s42, s42, s94
tra 222,247,50784
mvaa 36,228,96
s_sub_u32 s24, s42, 0x500
s_min_u32 s42, s42, s24
tra 224,248,0
mvaa 44,228,100
wl 11
tra 226,248,768
tra 228,248,32
mvaa 48,232,96
s_add_u32 m0, s74, 0x3080
tra 230,248,800
mvaa 56,232,100
wl 12
tra 232,248,64
buffer_load_dwordx4 v238, s[56:59], s77 offen lds
mvaa 52,236,96
tra 234,248,832
mvaa 60,236,100
wl 12
tra 236,248,96
mvaa 64,208,96
tra 238,248,864
mvaa 72,208,100
wl 12
tra 208,248,128
tra 210,248,896
mvaa 68,212,96
buffer_load_dwordx4 v239, s[56:59], s77 offen offset:1024 lds
mvaa 76,212,100
wl 12
tra 212,248,160
mvaa 80,216,96
tra 214,248,928
mvaa 88,216,100
wl 12
tra 216,248,192
mvaa 84,220,96
tra 218,248,960
mvaa 92,220,100
wl 12
buffer_load_dwordx4 v240, s[56:59], s77 offen offset:2048 lds
mvaa 0,224,104
s_add_u32 s77, s77, s80
tra 220,248,224
mvaa 8,224,108
wl 11
tra 222,248,992
mvaa 4,228,104
s_add_u32 m0, s74, 0x6100
tra 224,248,256
mvaa 12,228,108
wl 11
buffer_load_dwordx4 v238, s[56:59], s77 offen lds
mvaa 16,232,104
tra 226,248,1024
mvaa 24,232,108
wl 10
tra 228,248,288
mvaa 20,236,104
tra 230,248,1056
mvaa 28,236,108
wl 10
tra 232,248,320
mvaa 32,208,104
buffer_load_dwordx4 v239, s[56:59], s77 offen offset:1024 lds
mvaa 40,208,108
wl 9
tra 234,248,1088
mvaa 36,212,104
tra 236,248,352
mvaa 44,212,108
wl 9
tra 238,248,1120
mvaa 48,216,104
mvaa 56,216,108
wl 8
buffer_load_dwordx4 v240, s[56:59], s77 offen offset:2048 lds
mvaa 52,220,104
s_waitcnt vmcnt(10) lgkmcnt(0)
s_add_u32 s77, s77, s16
mvaa 60,220,108
s_barrier
mvaa 64,224,104
s_sub_u32 s23, s77, s79
s_min_u32 s77, s77, s23
rqa 112,212,16384
mvaa 72,224,108
tra 208,248,12416
rqa 116,212,16896
mvaa 68,228,104
s_add_u32 m0, s96, 0xc000
tra 210,248,13184
buffer_load_dwordx4 v208, s[44:47], s42 offen offset:0 lds
mvaa 76,228,108
tra 212,248,12448
tra 214,248,13216
mvaa 80,232,104
rqa 120,213,16384
mvaa 88,232,108
rqa 124,213,16896
mvaa 84,236,104
tra 216,248,12480
buffer_load_dwordx4 v209, s[44:47], s42 offen offset:1024 lds
mvaa 92,236,108
wl 5
tra 218,248,13248
tra 220,248,12512
mvaa 0,208,112
tra 222,248,13280
tra 224,248,12544
mvaa 8,208,116
wl 7
tra 226,248,13312
tra 228,248,12576
mvaa 4,212,112
tra 230,248,13344
tra 232,248,12608
mvaa 12,212,116
wl 7
tra 234,248,13376
tra 236,248,12640
mvaa 16,216,112
tra 238,248,13408
buffer_load_dwordx4 v210, s[44:47], s42 offen offset:2048 lds
mvaa 24,216,116
wl 8
tra 208,248,12672
tra 210,248,13440
mvaa 20,220,112
tra 212,248,12704
tra 214,248,13472
mvaa 28,220,116
wl 10
tra 216,248,12736
tra 218,248,13504
mvaa 32,224,112
tra 220,248,12768
buffer_load_dwordx4 v211, s[44:47], s42 offen offset:3072 lds
mvaa 40,224,116
wl 11
tra 222,248,13536
tra 224,247,0
mvaa 36,228,112
tra 226,247,768
mvaa 44,228,116
wl 12
tra 228,247,32
mvaa 48,232,112
s_add_u32 m0, s74, 0x9180
tra 230,247,800
mvaa 56,232,116
wl 12
tra 232,247,64
buffer_load_dwordx4 v238, s[56:59], s77 offen lds
mvaa 52,236,112
tra 234,247,832
mvaa 60,236,116
wl 12
tra 236,247,96
mvaa 64,208,112
tra 238,247,864
mvaa 72,208,116
wl 12
tra 208,247,128
tra 210,247,896
mvaa 68,212,112
buffer_load_dwordx4 v239, s[56:59], s77 offen offset:1024 lds
mvaa 76,212,116
wl 12
tra 212,247,160
mvaa 80,216,112
tra 214,247,928
mvaa 88,216,116
wl 12
tra 216,247,192
mvaa 84,220,112
tra 218,247,960
mvaa 92,220,116
wl 12
buffer_load_dwordx4 v240, s[56:59], s77 offen offset:2048 lds
mvaa 0,224,120
s_add_u32 s77, s77, s80
tra 220,247,224
mvaa 8,224,124
wl 11
tra 222,247,992
mvaa 4,228,120
s_add_u32 m0, s74, 0xc200
tra 224,247,256
mvaa 12,228,124
wl 11
buffer_load_dwordx4 v238, s[56:59], s77 offen lds
mvaa 16,232,120
tra 226,247,1024
mvaa 24,232,124
wl 10
tra 228,247,288
mvaa 20,236,120
tra 230,247,1056
mvaa 28,236,124
wl 10
tra 232,247,320
mvaa 32,208,120
buffer_load_dwordx4 v239, s[56:59], s77 offen offset:1024 lds
mvaa 40,208,124
wl 9
tra 234,247,1088
mvaa 36,212,120
tra 236,247,352
mvaa 44,212,124
wl 9
tra 238,247,1120
mvaa 48,216,120
mvaa 56,216,124
wl 8
buffer_load_dwordx4 v240, s[56:59], s77 offen offset:2048 lds
mvaa 52,220,120
s_waitcnt vmcnt(10) lgkmcnt(0)
s_add_u32 s77, s77, s80
mvaa 60,220,124
s_barrier
mvaa 64,224,120
s_sub_u32 s23, s77, s79
s_min_u32 s77, s77, s23
rqa 128,212,32768
mvaa 72,224,124
s_add_u32 s77, s77, 0x180
s_add_u32 m0, s74, 0xf280
rqa 132,212,33280
buffer_load_dwordx4 v238, s[56:59], s77 offen lds
mvaa 68,228,120
tra 208,247,12416
tra 210,247,13184
mvaa 76,228,124
tra 212,247,12448
tra 214,247,13216
mvaa 80,232,120
tra 216,247,12480
rqa 136,213,32768
mvaa 88,232,124
rqa 140,213,33280
mvaa 84,236,120
tra 218,247,13248
tra 220,247,12512
mvaa 92,236,124
wl 7
tra 222,247,13280
tra 224,247,12544
mvaa 0,208,128
tra 226,247,13312
tra 228,247,12576
mvaa 8,208,132
wl 9
tra 230,247,13344
buffer_load_dwordx4 v239, s[56:59], s77 offen offset:1024 lds
mvaa 4,212,128
tra 232,247,12608
tra 234,247,13376
mvaa 12,212,132
wl 8
tra 236,247,12640
tra 238,247,13408
mvaa 16,216,128
tra 208,247,12672
tra 210,247,13440
mvaa 24,216,132
wl 10
tra 212,247,12704
buffer_load_dwordx4 v240, s[56:59], s77 offen offset:2048 lds
mvaa 20,220,128
s_add_u32 s77, s77, s80
tra 214,247,13472
tra 216,247,12736
mvaa 28,220,132
wl 11
tra 218,247,13504
tra 220,247,12768
mvaa 32,224,128
s_add_u32 m0, s74, 0x12300
tra 222,247,13536
mvaa 40,224,132
wl 12
tra 224,247,24832
tra 226,247,25600
mvaa 36,228,128
buffer_load_dwordx4 v238, s[56:59], s77 offen lds
mvaa 44,228,132
wl 12
tra 228,247,24864
mvaa 48,232,128
tra 230,247,25632
mvaa 56,232,132
wl 12
tra 232,247,24896
mvaa 52,236,128
tra 234,247,25664
mvaa 60,236,132
wl 12
tra 236,247,24928
buffer_load_dwordx4 v239, s[56:59], s77 offen offset:1024 lds
mvaa 64,208,128
tra 238,247,25696
mvaa 72,208,132
wl 12
tra 208,247,24960
mvaa 68,212,128
tra 210,247,25728
mvaa 76,212,132
wl 12
tra 212,247,24992
mvaa 80,216,128
tra 214,247,25760
mvaa 88,216,132
wl 12
buffer_load_dwordx4 v240, s[56:59], s77 offen offset:2048 lds
mvaa 84,220,128
s_add_u32 s77, s77, s16
s_sub_u32 s23, s77, s79
tra 216,247,25024
mvaa 92,220,132
wl 11
s_min_u32 s77, s77, s23
tra 218,247,25792
mvaa 0,224,136
tra 220,247,25056
mvaa 8,224,140
wl 11
s_add_u32 m0, s73, 0x15380
tra 222,247,25824
mvaa 4,228,136
buffer_load_dwordx4 v232, s[48:51], s75 offen nt lds
mvaa 12,228,140
wl 10
tra 224,247,25088
mvaa 16,232,136
tra 226,247,25856
mvaa 24,232,140
wl 10
tra 228,247,25120
mvaa 20,236,136
tra 230,247,25888
mvaa 28,236,140
wl 10
buffer_load_dwordx4 v233, s[48:51], s75 offen offset:1024 nt lds
mvaa 32,208,136
tra 232,247,25152
mvaa 40,208,140
wl 9
tra 234,247,25920
mvaa 36,212,136
tra 236,247,25184
mvaa 44,212,140
wl 9
tra 238,247,25952
mvaa 48,216,136
buffer_load_dwordx4 v234, s[48:51], s75 offen offset:2048 nt lds
mvaa 56,216,140
wl 8
s_add_u32 s75, s75, 0x3000
mvaa 52,220,136
s_waitcnt vmcnt(9) lgkmcnt(0)
mvaa 60,220,140
s_barrier
mvaa 64,224,136
rqa 144,212,49152
mvaa 72,224,140
rqa 148,212,49664
mvaa 68,228,136
tra 208,247,37248
tra 210,247,38016
mvaa 76,228,140
tra 212,247,37280
tra 214,247,38048
mvaa 80,232,136
s_add_u32 m0, s74, 0
tra 216,247,37312
rqa 152,213,49152
mvaa 88,232,140
rqa 156,213,49664
buffer_load_dwordx4 v238, s[56:59], s77 offen lds
mvaa 84,236,136
tra 218,247,38080
tra 220,247,37344
mvaa 92,236,140
wl 7
tra 222,247,38112
tra 224,247,37376
mvaa 0,208,144
tra 226,247,38144
tra 228,247,37408
mvaa 8,208,148
wl 9
tra 230,247,38176
tra 232,247,37440
mvaa 4,212,144
tra 234,247,38208
tra 236,247,37472
mvaa 12,212,148
wl 9
tra 238,247,38240
tra 208,247,37504
mvaa 16,216,144
tra 210,247,38272
buffer_load_dwordx4 v239, s[56:59], s77 offen offset:1024 lds
mvaa 24,216,148
wl 10
tra 212,247,37536
tra 214,247,38304
mvaa 20,220,144
tra 216,247,37568
mvaa 28,220,148
wl 11
tra 218,247,38336
mvaa 32,224,144
tra 220,247,37600
mvaa 40,224,148
wl 11
tra 222,247,38368
mvaa 36,228,144
tra 224,247,49664
mvaa 44,228,148
wl 11
tra 226,247,50432
mvaa 48,232,144
buffer_load_dwordx4 v240, s[56:59], s77 offen offset:2048 lds
mvaa 56,232,148
wl 10
s_add_u32 s77, s77, s80
tra 228,247,49696
mvaa 52,236,144
tra 230,247,50464
mvaa 60,236,148
wl 10
tra 232,247,49728
mvaa 64,208,144
tra 234,247,50496
mvaa 72,208,148
wl 10
tra 236,247,49760
mvaa 68,212,144
s_add_u32 m0, s73, 0x3080
tra 238,247,50528
mvaa 76,212,148
wl 10
buffer_load_dwordx4 v232, s[48:51], s75 offen nt lds
mvaa 80,216,144
tra 208,247,49792
mvaa 88,216,148
wl 9
tra 210,247,50560
mvaa 84,220,144
tra 212,247,49824
mvaa 92,220,148
wl 9
tra 214,247,50592
mvaa 0,224,152
tra 216,247,49856
mvaa 8,224,156
wl 9
tra 218,247,50624
mvaa 4,228,152
tra 220,247,49888
mvaa 12,228,156
wl 9
buffer_load_dwordx4 v233, s[48:51], s75 offen offset:1024 nt lds
mvaa 16,232,152
tra 222,247,50656
mvaa 24,232,156
wl 8
tra 224,247,49920
mvaa 20,236,152
tra 226,247,50688
mvaa 28,236,156
wl 8
tra 228,247,49952
buffer_load_dwordx4 v234, s[48:51], s75 offen offset:2048 nt lds
mvaa 32,208,152
s_add_u32 s75, s75, 0x3000
tra 230,247,50720
tra 232,247,49984
tra 234,247,50752
v_pk_mul_f32 v[0:1], v[0:1], s[26:27]
v_pk_mul_f32 v[2:3], v[2:3], s[26:27]
v_pk_mul_f32 v[4:5], v[4:5], s[26:27]
v_pk_mul_f32 v[6:7], v[6:7], s[26:27]
v_pk_mul_f32 v[8:9], v[8:9], s[26:27]
v_pk_mul_f32 v[10:11], v[10:11], s[26:27]
v_pk_mul_f32 v[12:13], v[12:13], s[26:27]
v_pk_mul_f32 v[14:15], v[14:15], s[26:27]
cv 0,0
cv 1,2
cv 2,4
mvaa 40,208,156
wl 10
tra 236,247,50016
cv 3,6
mvaa 36,212,152
L_k1_ps3:
s_cbranch_execz L_k1_pr0
cv 8,8
mvaa 44,212,156
wl 9
tra 238,247,50784
cv 9,10
mvaa 48,216,152
wl 8
cv 10,12
cv 11,14
mvaa 56,216,156
v_permlane32_swap_b32 v0, v2
mvaa 52,220,152
s_waitcnt vmcnt(9) lgkmcnt(0)
v_permlane32_swap_b32 v1, v3
mvaa 60,220,156
s_barrier
v_pk_mul_f32 v[16:17], v[16:17], s[26:27]
v_accvgpr_write_b32 a160, v0
v_accvgpr_write_b32 a161, v1
v_accvgpr_write_b32 a162, v2
v_accvgpr_write_b32 a163, v3
mvaa 64,224,152
tra 208,248,0
tra 210,248,768
tra 212,248,32
v_pk_mul_f32 v[18:19], v[18:19], s[26:27]
v_pk_mul_f32 v[20:21], v[20:21], s[26:27]
mvaa 72,224,156
tra 214,248,800
tra 216,248,64
mvaa 68,228,152
tra 218,248,832
tra 220,248,96
tra 222,248,864
v_pk_mul_f32 v[22:23], v[22:23], s[26:27]
v_pk_mul_f32 v[24:25], v[24:25], s[26:27]
v_pk_mul_f32 v[26:27], v[26:27], s[26:27]
v_pk_mul_f32 v[28:29], v[28:29], s[26:27]
v_pk_mul_f32 v[30:31], v[30:31], s[26:27]
mvaa 76,228,156
tra 224,248,128
tra 226,248,896
mvaa 80,232,152
s_add_u32 m0, s74, 0x6100
tra 228,248,160
buffer_load_dwordx4 v238, s[56:59], s77 offen lds
mvaa 88,232,156
tra 230,248,928
v_permlane32_swap_b32 v8, v10
mvaa 84,236,152
tra 232,248,192
v_permlane32_swap_b32 v9, v11
mvaa 92,236,156
wl 11
tra 234,248,960
cv 16,16
v_accvgpr_write_b32 a164, v8
v_accvgpr_write_b32 a165, v9
v_accvgpr_write_b32 a166, v10
zvaa 96,208,0
tra 236,248,224
cv 17,18
cv 18,20
zvaa 104,208,4
wl 11
tra 238,248,992
cv 19,22
zvaa 100,212,0
tra 208,248,256
v_accvgpr_write_b32 a167, v11
zvaa 108,212,4
wl 11
tra 210,248,1024
cv 24,24
zvaa 112,216,0
tra 212,248,288
buffer_load_dwordx4 v239, s[56:59], s77 offen offset:1024 lds
zvaa 120,216,4
wl 11
tra 214,248,1056
cv 25,26
zvaa 116,220,0
tra 216,248,320
cv 26,28
zvaa 124,220,4
wl 11
tra 218,248,1088
cv 27,30
zvaa 128,224,0
tra 220,248,352
v_permlane32_swap_b32 v16, v18
zvaa 136,224,4
wl 11
v_permlane32_swap_b32 v17, v19
zvaa 132,228,0
tra 222,248,1120
tra 224,248,12416
tra 226,248,13184
v_pk_mul_f32 v[32:33], v[32:33], s[26:27]
v_pk_mul_f32 v[34:35], v[34:35], s[26:27]
v_pk_mul_f32 v[36:37], v[36:37], s[26:27]
v_pk_mul_f32 v[38:39], v[38:39], s[26:27]
v_pk_mul_f32 v[40:41], v[40:41], s[26:27]
v_pk_mul_f32 v[42:43], v[42:43], s[26:27]
v_pk_mul_f32 v[44:45], v[44:45], s[26:27]
v_pk_mul_f32 v[46:47], v[46:47], s[26:27]
v_accvgpr_write_b32 a168, v16
v_accvgpr_write_b32 a169, v17
v_accvgpr_write_b32 a170, v18
v_accvgpr_write_b32 a171, v19
zvaa 140,228,4
wl 12
tra 228,248,12448
v_permlane32_swap_b32 v24, v26
zvaa 144,232,0
tra 230,248,13216
buffer_load_dwordx4 v240, s[56:59], s77 offen offset:2048 lds
zvaa 152,232,4
wl 12
s_add_u32 s77, s77, s18
tra 232,248,12480
zvaa 148,236,0
s_sub_u32 s23, s77, s79
tra 234,248,13248
v_permlane32_swap_b32 v25, v27
zvaa 156,236,4
wl 12
tra 236,248,12512
cv 32,32
v_accvgpr_write_b32 a172, v24
v_accvgpr_write_b32 a173, v25
v_accvgpr_write_b32 a174, v26
zvaa 160,208,0
s_min_u32 s77, s77, s23
tra 238,248,13280
cv 33,34
zvaa 168,208,4
wl 12
tra 208,248,12544
v_accvgpr_write_b32 a175, v27
zvaa 164,212,0
s_add_u32 m0, s74, 0x9180
tra 210,248,13312
cv 34,36
zvaa 172,212,4
wl 12
tra 212,248,12576
buffer_load_dwordx4 v235, s[52:55], s76 offen nt lds
zvaa 176,216,0
tra 214,248,13344
cv 35,38
zvaa 184,216,4
wl 12
tra 216,248,12608
cv 40,40
zvaa 180,220,0
tra 218,248,13376
cv 41,42
zvaa 188,220,4
wl 12
tra 220,248,12640
cv 42,44
mvaa 96,224,8
tra 222,248,13408
cv 43,46
mvaa 104,224,12
wl 12
tra 224,248,12672
v_permlane32_swap_b32 v32, v34
mvaa 100,228,8
tra 226,248,13440
v_permlane32_swap_b32 v33, v35
mvaa 108,228,12
wl 12
tra 228,248,12704
tra 230,248,13472
buffer_load_dwordx4 v236, s[52:55], s76 offen offset:1024 nt lds
v_pk_mul_f32 v[48:49], v[48:49], s[26:27]
v_pk_mul_f32 v[50:51], v[50:51], s[26:27]
v_pk_mul_f32 v[52:53], v[52:53], s[26:27]
v_pk_mul_f32 v[54:55], v[54:55], s[26:27]
v_pk_mul_f32 v[56:57], v[56:57], s[26:27]
v_pk_mul_f32 v[58:59], v[58:59], s[26:27]
v_pk_mul_f32 v[60:61], v[60:61], s[26:27]
v_pk_mul_f32 v[62:63], v[62:63], s[26:27]
v_accvgpr_write_b32 a176, v32
v_accvgpr_write_b32 a177, v33
v_accvgpr_write_b32 a178, v34
v_accvgpr_write_b32 a179, v35
mvaa 112,232,8
v_permlane32_swap_b32 v40, v42
mvaa 120,232,12
wl 12
v_permlane32_swap_b32 v41, v43
mvaa 116,236,8
v_accvgpr_write_b32 a180, v40
v_accvgpr_write_b32 a181, v41
v_accvgpr_write_b32 a182, v42
v_accvgpr_write_b32 a183, v43
mvaa 124,236,12
wl 10
tra 232,248,12736
cv 48,48
mvaa 128,208,8
cv 49,50
cv 50,52
mvaa 136,208,12
wl 9
tra 234,248,13504
cv 51,54
mvaa 132,212,8
tra 236,248,12768
cv 56,56
mvaa 140,212,12
wl 9
tra 238,248,13536
cv 57,58
mvaa 144,216,8
buffer_load_dwordx4 v237, s[52:55], s76 offen offset:2048 nt lds
cv 58,60
mvaa 152,216,12
wl 8
s_add_u32 s76, s76, 0x3000
cv 59,62
mvaa 148,220,8
s_waitcnt vmcnt(9) lgkmcnt(0)
v_permlane32_swap_b32 v48, v50
mvaa 156,220,12
s_barrier
mvaa 160,224,8
s_add_u32 m0, s73, 0xc200
rqa 208,243,24832
v_permlane32_swap_b32 v49, v51
mvaa 168,224,12
rqa 212,243,26368
rqa 216,244,24832
buffer_load_dwordx4 v232, s[48:51], s75 offen nt lds
v_pk_mul_f32 v[64:65], v[64:65], s[26:27]
v_pk_mul_f32 v[66:67], v[66:67], s[26:27]
v_pk_mul_f32 v[68:69], v[68:69], s[26:27]
v_pk_mul_f32 v[70:71], v[70:71], s[26:27]
v_pk_mul_f32 v[72:73], v[72:73], s[26:27]
v_pk_mul_f32 v[74:75], v[74:75], s[26:27]
v_pk_mul_f32 v[76:77], v[76:77], s[26:27]
v_pk_mul_f32 v[78:79], v[78:79], s[26:27]
v_accvgpr_write_b32 a184, v48
v_accvgpr_write_b32 a185, v49
v_accvgpr_write_b32 a186, v50
mvaa 164,228,8
rqa 220,244,26368
v_permlane32_swap_b32 v56, v58
mvaa 172,228,12
rqa 224,243,24960
v_accvgpr_write_b32 a187, v51
mvaa 176,232,8
rqa 228,243,26496
v_permlane32_swap_b32 v57, v59
mvaa 184,232,12
v_accvgpr_write_b32 a188, v56
v_accvgpr_write_b32 a189, v57
mvaa 180,236,8
rqa 232,244,24960
cv 64,64
mvaa 188,236,12
wl 6
rqa 236,244,26496
cv 65,66
zvaa 192,208,160
cv 66,68
cv 67,70
zvaa 200,208,164
wl 6
rqa 208,243,25088
cv 72,72
zvaa 196,212,160
cv 73,74
cv 74,76
zvaa 204,212,164
wl 6
rqa 212,243,26624
cv 75,78
mvaa 192,216,168
buffer_load_dwordx4 v233, s[48:51], s75 offen offset:1024 nt lds
mvaa 200,216,172
wl 6
rqa 216,244,25088
v_permlane32_swap_b32 v64, v66
mvaa 196,220,168
v_accvgpr_write_b32 a190, v58
v_accvgpr_write_b32 a191, v59
mvaa 204,220,172
wl 6
rqa 220,244,26624
v_permlane32_swap_b32 v65, v67
mvaa 192,224,176
v_accvgpr_write_b32 a192, v64
v_accvgpr_write_b32 a193, v65
v_accvgpr_write_b32 a194, v66
v_accvgpr_write_b32 a195, v67
mvaa 200,224,180
wl 6
tra 224,247,0
tra 226,247,768
buffer_load_dwordx4 v234, s[48:51], s75 offen offset:2048 nt lds
v_pk_mul_f32 v[80:81], v[80:81], s[26:27]
v_pk_mul_f32 v[82:83], v[82:83], s[26:27]
v_pk_mul_f32 v[84:85], v[84:85], s[26:27]
v_pk_mul_f32 v[86:87], v[86:87], s[26:27]
v_pk_mul_f32 v[88:89], v[88:89], s[26:27]
v_pk_mul_f32 v[90:91], v[90:91], s[26:27]
v_pk_mul_f32 v[92:93], v[92:93], s[26:27]
v_pk_mul_f32 v[94:95], v[94:95], s[26:27]
v_permlane32_swap_b32 v72, v74
v_permlane32_swap_b32 v73, v75
mvaa 196,228,176
s_add_u32 s75, s75, 0x3000
v_accvgpr_write_b32 a196, v72
v_accvgpr_write_b32 a197, v73
v_accvgpr_write_b32 a198, v74
v_accvgpr_write_b32 a199, v75
mvaa 204,228,180
wl 7
tra 228,247,32
cv 80,80
cv 81,82
cv 82,84
cv 83,86
cv 88,88
cv 89,90
cv 90,92
cv 91,94
v_permlane32_swap_b32 v80, v82
v_permlane32_swap_b32 v81, v83
mvaa 192,232,184
tra 230,247,800
v_accvgpr_write_b32 a200, v80
v_accvgpr_write_b32 a201, v81
mvaa 200,232,188
wl 8
tra 232,247,64
v_permlane32_swap_b32 v88, v90
v_permlane32_swap_b32 v89, v91
mvaa 196,236,184
tra 234,247,832
v_accvgpr_write_b32 a202, v82
mvaa 204,236,188
wl 9
tra 236,247,96
v_accvgpr_write_b32 a203, v83
mvaa 192,208,192
tra 238,247,864
v_accvgpr_write_b32 a204, v88
mvaa 200,208,196
wl 10
tra 208,247,128
v_accvgpr_write_b32 a205, v89
v_accvgpr_write_b32 a206, v90
v_accvgpr_write_b32 a207, v91
mvaa 196,212,192
s_add_u32 m0, s74, 0xf280
tra 210,247,896
mvaa 204,212,196
wl 11
tra 212,247,160
tra 214,247,928
mvaa 192,216,200
buffer_load_dwordx4 v235, s[52:55], s76 offen nt lds
mvaa 200,216,204
wl 12
tra 216,247,192
mvaa 196,220,200
tra 218,247,960
mvaa 204,220,204
wl 12
tra 220,247,224
mvaa 96,224,16
tra 222,247,992
mvaa 104,224,20
wl 12
tra 224,247,256
mvaa 100,228,16
tra 226,247,1024
mvaa 108,228,20
wl 12
tra 228,247,288
mvaa 112,232,16
tra 230,247,1056
v_max3_f32 v252, v192, v193, v194
mvaa 120,232,20
wl 12
tra 232,247,320
v_max3_f32 v253, v200, v201, v202
v_max3_f32 v252, v252, v195, v196
mvaa 116,236,16
tra 234,247,1088
v_max3_f32 v253, v253, v203, v204
v_max3_f32 v252, v252, v197, v198
mvaa 124,236,20
wl 12
tra 236,247,352
v_max3_f32 v253, v253, v205, v206
v_max_f32 v252, v252, v199
mvaa 128,208,16
tra 238,247,1120
v_max_f32 v253, v253, v207
mvaa 136,208,20
wl 12
buffer_load_dwordx4 v236, s[52:55], s76 offen offset:1024 nt lds
mvaa 132,212,16
v_permlane32_swap_b32 v252, v253
mvaa 140,212,20
wl 10
v_max_f32 v252, v252, v253
v_mov_b32 v253, v252
mvaa 144,216,16
wl 8
buffer_load_dwordx4 v237, s[52:55], s76 offen offset:2048 nt lds
mvaa 152,216,20
s_add_u32 s76, s76, 0x3000
v_permlane16_swap_b32 v252, v253
v_max_f32 v252, v252, v253
mvaa 148,220,16
s_waitcnt vmcnt(9) lgkmcnt(0)
v_mov_b32 v253, v252
mvaa 156,220,20
s_barrier
mvaa 160,224,16
rqa 208,241,12416
v_permlane32_swap_b32 v252, v253
v_sub_f32 v224, 0, v252
v_sub_f32 v225, 0, v252
v_sub_f32 v228, 0, v253
v_sub_f32 v229, 0, v253
v_mov_b64 v[226:227], v[224:225]
v_mov_b64 v[230:231], v[228:229]
v_sub_f32 v192, v192, v252
v_sub_f32 v193, v193, v252
v_sub_f32 v194, v194, v252
v_sub_f32 v195, v195, v252
v_sub_f32 v196, v196, v252
mvaa 168,224,20
rqa 212,241,13952
v_sub_f32 v197, v197, v252
v_sub_f32 v198, v198, v252
mvaa 164,228,16
rqa 216,242,12416
v_sub_f32 v199, v199, v252
v_sub_f32 v200, v200, v253
mvaa 172,228,20
rqa 220,242,13952
v_sub_f32 v201, v201, v253
v_sub_f32 v202, v202, v253
mvaa 176,232,16
rqa 224,241,12544
v_sub_f32 v203, v203, v253
v_sub_f32 v204, v204, v253
mvaa 184,232,20
rqa 228,241,14080
v_sub_f32 v205, v205, v253
v_sub_f32 v206, v206, v253
v_sub_f32 v207, v207, v253
mvaa 180,236,16
rqa 232,242,12544
mvaa 188,236,20
wl 6
s_add_u32 m0, s73, 0x15380
rqa 236,242,14080
cvaa 208,208,160,224
buffer_load_dwordx4 v232, s[48:51], s75 offen nt lds
cvaa 216,208,164,228
wl 6
rqa 208,241,12672
ex 192
cvaa 212,212,160,224
ex 193
cvaa 220,212,164,228
wl 6
rqa 212,241,14208
mvaa 208,216,168
buffer_load_dwordx4 v233, s[48:51], s75 offen offset:1024 nt lds
mvaa 216,216,172
wl 6
rqa 216,242,12672
mvaa 212,220,168
ex 194
mvaa 220,220,172
wl 6
rqa 220,242,14208
cv 192,192
mvaa 208,224,176
buffer_load_dwordx4 v234, s[48:51], s75 offen offset:2048 nt lds
mvaa 216,224,180
wl 6
s_add_u32 s75, s75, 0x3000
tra 224,247,24832
mvaa 212,228,176
tra 226,247,25600
ex 195
mvaa 220,228,180
wl 7
tra 228,247,24864
ex 196
mvaa 208,232,184
tra 230,247,25632
cv 193,194
mvaa 216,232,188
wl 8
tra 232,247,24896
tra 234,247,25664
mvaa 212,236,184
ex 197
mvaa 220,236,188
wl 9
tra 236,247,24928
tra 238,247,25696
mvaa 208,208,192
ex 198
mvaa 216,208,196
wl 10
tra 208,247,24960
mvaa 212,212,192
s_add_u32 m0, s74, 0
tra 210,247,25728
cv 194,196
mvaa 220,212,196
wl 11
tra 212,247,24992
buffer_load_dwordx4 v238, s[56:59], s77 offen lds
mvaa 208,216,200
tra 214,247,25760
ex 199
mvaa 216,216,204
wl 12
tra 216,247,25024
tra 218,247,25792
mvaa 212,220,200
ex 200
mvaa 220,220,204
wl 12
tra 220,247,25056
mvaa 96,224,24
tra 222,247,25824
cv 195,198
mvaa 104,224,28
wl 12
tra 224,247,25088
tra 226,247,25856
mvaa 100,228,24
ex 201
mvaa 108,228,28
wl 12
tra 228,247,25120
tra 230,247,25888
mvaa 112,232,24
ex 202
mvaa 120,232,28
wl 12
tra 232,247,25152
mvaa 116,236,24
tra 234,247,25920
cv 200,200
mvaa 124,236,28
wl 12
tra 236,247,25184
mvaa 128,208,24
tra 238,247,25952
mvaa 136,208,28
wl 12
buffer_load_dwordx4 v239, s[56:59], s77 offen offset:1024 lds
mvaa 132,212,24
ex 203
mvaa 140,212,28
wl 10
ex 204
mvaa 144,216,24
buffer_load_dwordx4 v240, s[56:59], s77 offen offset:2048 lds
mvaa 152,216,28
wl 8
s_add_u32 s77, s77, s80
cv 201,202
mvaa 148,220,24
s_waitcnt vmcnt(9) lgkmcnt(0)
ex 205
mvaa 156,220,28
s_barrier
mvaa 160,224,24
tra 208,247,37248
ex 206
mvaa 168,224,28
tra 210,247,38016
cv 202,204
mvaa 164,228,24
tra 212,247,37280
tra 214,247,38048
mvaa 172,228,28
tra 216,247,37312
ex 207
mvaa 176,232,24
s_add_u32 m0, s74, 0x3080
tra 218,247,38080
buffer_load_dwordx4 v238, s[56:59], s77 offen lds
mvaa 184,232,28
tra 220,247,37344
cv 203,206
mvaa 180,236,24
tra 222,247,38112
mvaa 188,236,28
tra 224,247,37376
L_k1_loop:
zaav 240,248,192
tra 226,247,38144
zaav 244,248,200
wl 8
tra 228,247,37408
zvav 0,208,192
tra 230,247,38176
zvav 8,208,200
wl 8
tra 232,247,37440
zvav 4,212,192
buffer_load_dwordx4 v239, s[56:59], s77 offen offset:1024 lds
zvav 12,212,200
wl 7
tra 234,247,38208
v_max3_f32 v251, v208, v209, v210
zvav 16,216,192
tra 236,247,37472
zvav 24,216,200
wl 7
tra 238,247,38240
v_max3_f32 v251, v251, v211, v212
zvav 20,220,192
tra 208,247,37504
zvav 28,220,200
wl 7
tra 210,247,38272
v_max3_f32 v251, v251, v213, v214
zvav 32,224,192
tra 212,247,37536
zvav 40,224,200
wl 7
tra 214,247,38304
v_max3_f32 v251, v251, v215, v216
zvav 36,228,192
buffer_load_dwordx4 v240, s[56:59], s77 offen offset:2048 lds
zvav 44,228,200
wl 6
s_add_u32 s77, s77, s17
tra 216,247,37568
zvav 48,232,192
s_sub_u32 s23, s77, s79
s_min_u32 s77, s77, s23
tra 218,247,38336
zvav 56,232,200
wl 6
tra 220,247,37600
v_max3_f32 v251, v251, v217, v218
zvav 52,236,192
tra 222,247,38368
v_max3_f32 v251, v251, v219, v220
zvav 60,236,200
wl 6
rqa 224,241,49664
zvav 64,208,192
rqa 228,241,51200
v_max3_f32 v251, v251, v221, v222
zvav 72,208,200
wl 6
rqa 232,242,49664
v_max_f32 v251, v251, v223
zvav 68,212,192
rqa 236,242,51200
v_cmp_lt_f32 vcc, s43, v251
zvav 76,212,200
wl 6
s_add_u32 m0, s74, 0x6100
rqa 208,241,49792
zvav 80,216,192
buffer_load_dwordx4 v235, s[52:55], s76 offen nt lds
zvav 88,216,200
wl 5
rqa 212,241,51328
zvav 84,220,192
wl 5
rqa 216,242,49792
zvav 92,220,200
s_cbranch_vccnz L_k1_rr_u1
L_k1_rb_u2:
rqa 220,242,51328
cvaa 192,224,160,224
ex 208
cvaa 200,224,164,228
wl 6
rqa 224,241,49920
ex 209
cvaa 196,228,160,224
ex 210
cvaa 204,228,164,228
wl 6
rqa 228,241,51456
buffer_load_dwordx4 v236, s[52:55], s76 offen offset:1024 nt lds
cv 208,208
mvaa 192,232,168
ex 211
mvaa 200,232,172
wl 6
rqa 232,242,49920
ex 212
mvaa 196,236,168
cv 209,210
ex 213
mvaa 204,236,172
wl 6
rqa 236,242,51456
ex 214
mvaa 192,208,176
cv 210,212
ex 215
mvaa 200,208,180
wl 6
ex 216
mvaa 196,212,176
cv 211,214
ex 217
mvaa 204,212,180
wl 5
buffer_load_dwordx4 v237, s[52:55], s76 offen offset:2048 nt lds
mvaa 192,216,184
s_add_u32 s76, s76, 0x3000
ex 218
mvaa 200,216,188
wl 4
cv 216,216
ex 219
mvaa 196,220,184
s_cmp_le_u32 s83, 2
s_cbranch_scc1 L_k1_tw_u3
L_k1_hb_u4:
s_waitcnt vmcnt(9) lgkmcnt(0)
mvaa 204,220,188
s_barrier
mvaa 192,224,192
tra 208,248,0
ex 220
mvaa 200,224,196
tra 210,248,768
cv 217,218
mvaa 196,228,192
tra 212,248,32
ex 221
mvaa 204,228,196
tra 214,248,800
ex 222
mvaa 192,232,200
tra 216,248,64
cv 218,220
ex 223
mvaa 200,232,204
tra 218,248,832
cv 219,222
mvaa 196,236,200
tra 220,248,96
tra 222,248,864
mvaa 204,236,204
s_add_u32 m0, s73, 0x9180
tra 224,248,128
buffer_load_dwordx4 v232, s[48:51], s75 offen nt lds
maav 240,248,208
tra 226,248,896
maav 244,248,216
wl 8
tra 228,248,160
mvav 0,208,208
tra 230,248,928
mvav 8,208,216
wl 8
tra 232,248,192
mvav 4,212,208
buffer_load_dwordx4 v233, s[48:51], s75 offen offset:1024 nt lds
mvav 12,212,216
wl 7
tra 234,248,960
v_max3_f32 v251, v192, v193, v194
mvav 16,216,208
tra 236,248,224
mvav 24,216,216
wl 7
tra 238,248,992
v_max3_f32 v251, v251, v195, v196
mvav 20,220,208
tra 208,248,256
mvav 28,220,216
wl 7
tra 210,248,1024
v_max3_f32 v251, v251, v197, v198
mvav 32,224,208
tra 212,248,288
mvav 40,224,216
wl 7
tra 214,248,1056
v_max3_f32 v251, v251, v199, v200
mvav 36,228,208
buffer_load_dwordx4 v234, s[48:51], s75 offen offset:2048 nt lds
mvav 44,228,216
wl 6
s_add_u32 s75, s75, 0x3000
tra 216,248,320
mvav 48,232,208
tra 218,248,1088
v_max3_f32 v251, v251, v201, v202
mvav 56,232,216
wl 6
tra 220,248,352
mvav 52,236,208
tra 222,248,1120
v_max3_f32 v251, v251, v203, v204
mvav 60,236,216
wl 6
rqa 224,243,24832
mvav 64,208,208
rqa 228,243,26368
v_max3_f32 v251, v251, v205, v206
mvav 72,208,216
wl 6
rqa 232,244,24832
v_max_f32 v251, v251, v207
mvav 68,212,208
rqa 236,244,26368
v_cmp_lt_f32 vcc, s43, v251
mvav 76,212,216
wl 6
s_add_u32 m0, s74, 0xc200
rqa 208,243,24960
mvav 80,216,208
buffer_load_dwordx4 v235, s[52:55], s76 offen nt lds
mvav 88,216,216
wl 5
rqa 212,243,26496
mvav 84,220,208
wl 5
rqa 216,244,24960
mvav 92,220,216
s_cbranch_vccnz L_k1_rr_u6
L_k1_rb_u7:
cvaa 208,224,160,224
ex 192
cvaa 216,224,164,228
wl 5
rqa 220,244,26496
cvaa 212,228,160,224
buffer_load_dwordx4 v236, s[52:55], s76 offen offset:1024 nt lds
cvaa 220,228,164,228
wl 5
rqa 224,243,25088
mvaa 208,232,168
ex 193
mvaa 216,232,172
wl 5
rqa 228,243,26624
mvaa 212,236,168
ex 194
mvaa 220,236,172
wl 5
rqa 232,244,25088
cv 192,192
mvaa 208,208,176
ex 195
mvaa 216,208,180
wl 5
ex 196
mvaa 212,212,176
rqa 236,244,26624
cv 193,194
mvaa 220,212,180
wl 5
buffer_load_dwordx4 v237, s[52:55], s76 offen offset:2048 nt lds
mvaa 208,216,184
s_add_u32 s76, s76, 0x3000
ex 197
mvaa 216,216,188
wl 4
ex 198
mvaa 212,220,184
s_cmp_le_u32 s83, 2
s_cbranch_scc1 L_k1_tw_u8
L_k1_hb_u9:
s_waitcnt vmcnt(9) lgkmcnt(0)
mvaa 220,220,188
s_barrier
mvaa 208,224,192
tra 208,247,0
tra 210,247,768
mvaa 216,224,196
tra 212,247,32
tra 214,247,800
mvaa 212,228,192
tra 216,247,64
tra 218,247,832
mvaa 220,228,196
tra 220,247,96
tra 222,247,864
mvaa 208,232,200
s_add_u32 m0, s73, 0xf280
tra 224,247,128
buffer_load_dwordx4 v232, s[48:51], s75 offen nt lds
mvaa 216,232,204
tra 226,247,896
tra 228,247,160
mvaa 212,236,200
tra 230,247,928
tra 232,247,192
mvaa 220,236,204
wl 11
tra 234,247,960
tra 236,247,224
mvaa 96,208,32
tra 238,247,992
mvaa 104,208,36
wl 12
tra 208,247,256
mvaa 100,212,32
tra 210,247,1024
mvaa 108,212,36
wl 12
tra 212,247,288
cv 194,196
mvaa 112,216,32
tra 214,247,1056
buffer_load_dwordx4 v233, s[48:51], s75 offen offset:1024 nt lds
mvaa 120,216,36
wl 12
tra 216,247,320
mvaa 116,220,32
tra 218,247,1088
mvaa 124,220,36
wl 12
tra 220,247,352
ex 199
mvaa 128,224,32
tra 222,247,1120
mvaa 136,224,36
wl 12
tra 224,247,12416
tra 226,247,13184
mvaa 132,228,32
ex 200
mvaa 140,228,36
wl 12
tra 228,247,12448
cv 195,198
mvaa 144,232,32
tra 230,247,13216
buffer_load_dwordx4 v234, s[48:51], s75 offen offset:2048 nt lds
mvaa 152,232,36
wl 12
s_add_u32 s75, s75, 0x3000
tra 232,247,12480
mvaa 148,236,32
tra 234,247,13248
mvaa 156,236,36
wl 12
tra 236,247,12512
ex 201
mvaa 160,208,32
tra 238,247,13280
mvaa 168,208,36
wl 12
tra 208,247,12544
tra 210,247,13312
mvaa 164,212,32
s_add_u32 m0, s74, 0x12300
ex 202
mvaa 172,212,36
wl 12
tra 212,247,12576
buffer_load_dwordx4 v238, s[56:59], s77 offen lds
mvaa 176,216,32
tra 214,247,13344
mvaa 184,216,36
wl 12
tra 216,247,12608
cv 200,200
mvaa 180,220,32
tra 218,247,13376
mvaa 188,220,36
wl 12
tra 220,247,12640
tra 222,247,13408
mvaa 96,224,40
ex 203
mvaa 104,224,44
wl 12
tra 224,247,12672
mvaa 100,228,40
tra 226,247,13440
mvaa 108,228,44
wl 12
tra 228,247,12704
buffer_load_dwordx4 v239, s[56:59], s77 offen offset:1024 lds
mvaa 112,232,40
ex 204
mvaa 120,232,44
wl 11
tra 230,247,13472
mvaa 116,236,40
tra 232,247,12736
cv 201,202
mvaa 124,236,44
wl 11
tra 234,247,13504
mvaa 128,208,40
tra 236,247,12768
mvaa 136,208,44
wl 11
ex 205
mvaa 132,212,40
tra 238,247,13536
mvaa 140,212,44
wl 10
ex 206
mvaa 144,216,40
buffer_load_dwordx4 v240, s[56:59], s77 offen offset:2048 lds
mvaa 152,216,44
wl 8
s_add_u32 s77, s77, s80
mvaa 148,220,40
s_cmp_le_u32 s83, 2
s_cbranch_scc1 L_k1_tw_u11
L_k1_hb_u12:
s_waitcnt vmcnt(9) lgkmcnt(0)
mvaa 156,220,44
s_barrier
mvaa 160,224,40
tra 208,247,24832
cv 202,204
mvaa 168,224,44
tra 210,247,25600
tra 212,247,24864
mvaa 164,228,40
tra 214,247,25632
ex 207
mvaa 172,228,44
tra 216,247,24896
tra 218,247,25664
mvaa 176,232,40
s_add_u32 m0, s74, 0x15380
tra 220,247,24928
buffer_load_dwordx4 v238, s[56:59], s77 offen lds
mvaa 184,232,44
tra 222,247,25696
cv 203,206
mvaa 180,236,40
tra 224,247,24960
mvaa 188,236,44
tra 226,247,25728
maav 240,248,192
wl 8
tra 228,247,24992
maav 244,248,200
s_cmp_eq_u32 s83, 2
s_cbranch_scc1 L_k1_hk_u14
L_k1_hb_u15:
mvav 0,208,192
tra 230,247,25760
mvav 8,208,200
wl 8
tra 232,247,25024
mvav 4,212,192
buffer_load_dwordx4 v239, s[56:59], s77 offen offset:1024 lds
mvav 12,212,200
wl 7
tra 234,247,25792
v_max3_f32 v251, v208, v209, v210
mvav 16,216,192
tra 236,247,25056
mvav 24,216,200
wl 7
tra 238,247,25824
v_max3_f32 v251, v251, v211, v212
mvav 20,220,192
tra 208,247,25088
mvav 28,220,200
wl 7
tra 210,247,25856
v_max3_f32 v251, v251, v213, v214
mvav 32,224,192
tra 212,247,25120
mvav 40,224,200
wl 7
tra 214,247,25888
v_max3_f32 v251, v251, v215, v216
mvav 36,228,192
buffer_load_dwordx4 v240, s[56:59], s77 offen offset:2048 lds
mvav 44,228,200
wl 6
s_add_u32 s77, s77, s18
tra 216,247,25152
mvav 48,232,192
s_sub_u32 s23, s77, s79
s_min_u32 s77, s77, s23
tra 218,247,25920
mvav 56,232,200
wl 6
tra 220,247,25184
v_max3_f32 v251, v251, v217, v218
mvav 52,236,192
tra 222,247,25952
v_max3_f32 v251, v251, v219, v220
mvav 60,236,200
wl 6
rqa 224,241,37248
mvav 64,208,192
rqa 228,241,38784
v_max3_f32 v251, v251, v221, v222
mvav 72,208,200
wl 6
rqa 232,242,37248
v_max_f32 v251, v251, v223
mvav 68,212,192
rqa 236,242,38784
v_cmp_lt_f32 vcc, s43, v251
mvav 76,212,200
wl 6
s_add_u32 m0, s74, 0
rqa 208,241,37376
mvav 80,216,192
buffer_load_dwordx4 v235, s[52:55], s76 offen nt lds
mvav 88,216,200
wl 5
rqa 212,241,38912
mvav 84,220,192
wl 5
rqa 216,242,37376
mvav 92,220,200
s_cbranch_vccnz L_k1_rr_u16
L_k1_rb_u17:
rqa 220,242,38912
cvaa 192,224,160,224
ex 208
cvaa 200,224,164,228
wl 6
rqa 224,241,37504
ex 209
cvaa 196,228,160,224
ex 210
cvaa 204,228,164,228
wl 6
rqa 228,241,39040
buffer_load_dwordx4 v236, s[52:55], s76 offen offset:1024 nt lds
cv 208,208
mvaa 192,232,168
ex 211
mvaa 200,232,172
wl 6
rqa 232,242,37504
ex 212
mvaa 196,236,168
cv 209,210
ex 213
mvaa 204,236,172
wl 6
rqa 236,242,39040
ex 214
mvaa 192,208,176
cv 210,212
ex 215
mvaa 200,208,180
wl 6
ex 216
mvaa 196,212,176
cv 211,214
ex 217
mvaa 204,212,180
wl 5
buffer_load_dwordx4 v237, s[52:55], s76 offen offset:2048 nt lds
mvaa 192,216,184
s_add_u32 s76, s76, 0x3000
ex 218
mvaa 200,216,188
wl 4
cv 216,216
ex 219
mvaa 196,220,184
s_cmp_le_u32 s83, 2
s_cbranch_scc1 L_k1_tw_u18
L_k1_hb_u19:
s_waitcnt vmcnt(9) lgkmcnt(0)
mvaa 204,220,188
s_barrier
mvaa 192,224,192
tra 208,247,49664
ex 220
mvaa 200,224,196
tra 210,247,50432
cv 217,218
mvaa 196,228,192
tra 212,247,49696
ex 221
mvaa 204,228,196
tra 214,247,50464
ex 222
mvaa 192,232,200
tra 216,247,49728
cv 218,220
ex 223
mvaa 200,232,204
tra 218,247,50496
cv 219,222
mvaa 196,236,200
tra 220,247,49760
tra 222,247,50528
mvaa 204,236,204
s_add_u32 m0, s73, 0x3080
tra 224,247,49792
buffer_load_dwordx4 v232, s[48:51], s75 offen nt lds
maav 240,248,208
tra 226,247,50560
maav 244,248,216
wl 8
tra 228,247,49824
mvav 0,208,208
tra 230,247,50592
mvav 8,208,216
wl 8
tra 232,247,49856
mvav 4,212,208
buffer_load_dwordx4 v233, s[48:51], s75 offen offset:1024 nt lds
mvav 12,212,216
wl 7
tra 234,247,50624
v_max3_f32 v251, v192, v193, v194
mvav 16,216,208
tra 236,247,49888
mvav 24,216,216
wl 7
tra 238,247,50656
v_max3_f32 v251, v251, v195, v196
mvav 20,220,208
tra 208,247,49920
mvav 28,220,216
wl 7
tra 210,247,50688
v_max3_f32 v251, v251, v197, v198
mvav 32,224,208
tra 212,247,49952
mvav 40,224,216
wl 7
tra 214,247,50720
v_max3_f32 v251, v251, v199, v200
mvav 36,228,208
buffer_load_dwordx4 v234, s[48:51], s75 offen offset:2048 nt lds
mvav 44,228,216
wl 6
s_add_u32 s75, s75, 0x3000
tra 216,247,49984
mvav 48,232,208
tra 218,247,50752
v_max3_f32 v251, v251, v201, v202
mvav 56,232,216
wl 6
tra 220,247,50016
mvav 52,236,208
tra 222,247,50784
v_max3_f32 v251, v251, v203, v204
mvav 60,236,216
wl 6
rqa 224,243,0
mvav 64,208,208
rqa 228,243,1536
v_max3_f32 v251, v251, v205, v206
mvav 72,208,216
wl 6
rqa 232,244,0
v_max_f32 v251, v251, v207
mvav 68,212,208
rqa 236,244,1536
v_cmp_lt_f32 vcc, s43, v251
mvav 76,212,216
wl 6
s_add_u32 m0, s74, 0x6100
rqa 208,243,128
mvav 80,216,208
buffer_load_dwordx4 v238, s[56:59], s77 offen lds
mvav 88,216,216
wl 5
rqa 212,243,1664
mvav 84,220,208
wl 5
rqa 216,244,128
mvav 92,220,216
s_cbranch_vccnz L_k1_rr_u21
L_k1_rb_u22:
cvaa 208,224,160,224
ex 192
cvaa 216,224,164,228
wl 5
rqa 220,244,1664
cvaa 212,228,160,224
buffer_load_dwordx4 v239, s[56:59], s77 offen offset:1024 lds
cvaa 220,228,164,228
wl 5
rqa 224,243,256
mvaa 208,232,168
ex 193
mvaa 216,232,172
wl 5
rqa 228,243,1792
mvaa 212,236,168
ex 194
mvaa 220,236,172
wl 5
rqa 232,244,256
cv 192,192
mvaa 208,208,176
ex 195
mvaa 216,208,180
wl 5
ex 196
mvaa 212,212,176
rqa 236,244,1792
cv 193,194
mvaa 220,212,180
wl 5
buffer_load_dwordx4 v240, s[56:59], s77 offen offset:2048 lds
mvaa 208,216,184
s_add_u32 s77, s77, s80
ex 197
mvaa 216,216,188
wl 4
ex 198
mvaa 212,220,184
s_cmp_le_u32 s83, 2
s_cbranch_scc1 L_k1_tw_u23
L_k1_hb_u24:
s_waitcnt vmcnt(9) lgkmcnt(0)
mvaa 220,220,188
s_barrier
mvaa 208,224,192
tra 208,248,12416
tra 210,248,13184
mvaa 216,224,196
tra 212,248,12448
tra 214,248,13216
mvaa 212,228,192
tra 216,248,12480
tra 218,248,13248
mvaa 220,228,196
tra 220,248,12512
tra 222,248,13280
mvaa 208,232,200
s_add_u32 m0, s74, 0x9180
tra 224,248,12544
buffer_load_dwordx4 v238, s[56:59], s77 offen lds
mvaa 216,232,204
tra 226,248,13312
tra 228,248,12576
mvaa 212,236,200
tra 230,248,13344
tra 232,248,12608
mvaa 220,236,204
wl 11
tra 234,248,13376
tra 236,248,12640
mvaa 96,208,48
tra 238,248,13408
mvaa 104,208,52
wl 12
tra 208,248,12672
mvaa 100,212,48
tra 210,248,13440
mvaa 108,212,52
wl 12
tra 212,248,12704
cv 194,196
mvaa 112,216,48
tra 214,248,13472
buffer_load_dwordx4 v239, s[56:59], s77 offen offset:1024 lds
mvaa 120,216,52
wl 12
tra 216,248,12736
mvaa 116,220,48
tra 218,248,13504
mvaa 124,220,52
wl 12
tra 220,248,12768
ex 199
mvaa 128,224,48
tra 222,248,13536
mvaa 136,224,52
wl 12
tra 224,248,24832
tra 226,248,25600
mvaa 132,228,48
ex 200
mvaa 140,228,52
wl 12
tra 228,248,24864
cv 195,198
mvaa 144,232,48
tra 230,248,25632
buffer_load_dwordx4 v240, s[56:59], s77 offen offset:2048 lds
mvaa 152,232,52
wl 12
s_add_u32 s77, s77, s17
tra 232,248,24896
mvaa 148,236,48
s_sub_u32 s23, s77, s79
s_min_u32 s77, s77, s23
tra 234,248,25664
mvaa 156,236,52
wl 12
tra 236,248,24928
ex 201
mvaa 160,208,48
tra 238,248,25696
mvaa 168,208,52
wl 12
tra 208,248,24960
tra 210,248,25728
mvaa 164,212,48
s_add_u32 m0, s74, 0xf280
ex 202
mvaa 172,212,52
wl 12
tra 212,248,24992
buffer_load_dwordx4 v235, s[52:55], s76 offen nt lds
mvaa 176,216,48
tra 214,248,25760
mvaa 184,216,52
wl 12
tra 216,248,25024
cv 200,200
mvaa 180,220,48
tra 218,248,25792
mvaa 188,220,52
wl 12
tra 220,248,25056
tra 222,248,25824
mvaa 96,224,56
ex 203
mvaa 104,224,60
wl 12
tra 224,248,25088
mvaa 100,228,56
tra 226,248,25856
mvaa 108,228,60
wl 12
tra 228,248,25120
buffer_load_dwordx4 v236, s[52:55], s76 offen offset:1024 nt lds
mvaa 112,232,56
ex 204
mvaa 120,232,60
wl 11
tra 230,248,25888
mvaa 116,236,56
tra 232,248,25152
cv 201,202
mvaa 124,236,60
wl 11
tra 234,248,25920
mvaa 128,208,56
tra 236,248,25184
mvaa 136,208,60
wl 11
ex 205
mvaa 132,212,56
tra 238,248,25952
mvaa 140,212,60
wl 10
ex 206
mvaa 144,216,56
buffer_load_dwordx4 v237, s[52:55], s76 offen offset:2048 nt lds
mvaa 152,216,60
wl 8
s_add_u32 s76, s76, 0x3000
mvaa 148,220,56
s_cmp_le_u32 s83, 2
s_cbranch_scc1 L_k1_tw_u26
L_k1_hb_u27:
s_waitcnt vmcnt(9) lgkmcnt(0)
mvaa 156,220,60
s_barrier
mvaa 160,224,56
tra 208,247,0
cv 202,204
mvaa 168,224,60
tra 210,247,768
tra 212,247,32
mvaa 164,228,56
s_add_u32 m0, s73, 0x12300
tra 214,247,800
ex 207
mvaa 172,228,60
tra 216,247,64
tra 218,247,832
mvaa 176,232,56
buffer_load_dwordx4 v232, s[48:51], s75 offen nt lds
mvaa 184,232,60
tra 220,247,96
cv 203,206
mvaa 180,236,56
tra 222,247,864
mvaa 188,236,60
tra 224,247,128
maav 240,248,192
tra 226,247,896
maav 244,248,200
wl 8
tra 228,247,160
mvav 0,208,192
tra 230,247,928
mvav 8,208,200
wl 8
tra 232,247,192
mvav 4,212,192
buffer_load_dwordx4 v233, s[48:51], s75 offen offset:1024 nt lds
mvav 12,212,200
wl 7
tra 234,247,960
v_max3_f32 v251, v208, v209, v210
mvav 16,216,192
tra 236,247,224
mvav 24,216,200
wl 7
tra 238,247,992
v_max3_f32 v251, v251, v211, v212
mvav 20,220,192
tra 208,247,256
mvav 28,220,200
wl 7
tra 210,247,1024
v_max3_f32 v251, v251, v213, v214
mvav 32,224,192
tra 212,247,288
mvav 40,224,200
wl 7
tra 214,247,1056
v_max3_f32 v251, v251, v215, v216
mvav 36,228,192
buffer_load_dwordx4 v234, s[48:51], s75 offen offset:2048 nt lds
mvav 44,228,200
wl 6
s_add_u32 s75, s75, 0x3000
tra 216,247,320
mvav 48,232,192
tra 218,247,1088
v_max3_f32 v251, v251, v217, v218
mvav 56,232,200
wl 6
tra 220,247,352
mvav 52,236,192
tra 222,247,1120
v_max3_f32 v251, v251, v219, v220
mvav 60,236,200
wl 6
rqa 224,241,12416
mvav 64,208,192
rqa 228,241,13952
v_max3_f32 v251, v251, v221, v222
mvav 72,208,200
wl 6
rqa 232,242,12416
v_max_f32 v251, v251, v223
mvav 68,212,192
rqa 236,242,13952
v_cmp_lt_f32 vcc, s43, v251
mvav 76,212,200
wl 6
s_add_u32 m0, s74, 0x15380
rqa 208,241,12544
mvav 80,216,192
buffer_load_dwordx4 v235, s[52:55], s76 offen nt lds
mvav 88,216,200
wl 5
rqa 212,241,14080
mvav 84,220,192
wl 5
rqa 216,242,12544
mvav 92,220,200
s_cbranch_vccnz L_k1_rr_u29
L_k1_rb_u30:
cvaa 192,224,160,224
ex 208
cvaa 200,224,164,228
wl 5
rqa 220,242,14080
cvaa 196,228,160,224
buffer_load_dwordx4 v236, s[52:55], s76 offen offset:1024 nt lds
cvaa 204,228,164,228
wl 5
rqa 224,241,12672
mvaa 192,232,168
ex 209
mvaa 200,232,172
wl 5
rqa 228,241,14208
mvaa 196,236,168
ex 210
mvaa 204,236,172
wl 5
rqa 232,242,12672
cv 208,208
mvaa 192,208,176
ex 211
mvaa 200,208,180
wl 5
ex 212
mvaa 196,212,176
rqa 236,242,14208
cv 209,210
mvaa 204,212,180
wl 5
buffer_load_dwordx4 v237, s[52:55], s76 offen offset:2048 nt lds
mvaa 192,216,184
s_add_u32 s76, s76, 0x3000
ex 213
mvaa 200,216,188
wl 4
ex 214
mvaa 196,220,184
s_cmp_le_u32 s83, 2
s_cbranch_scc1 L_k1_tw_u31
L_k1_hb_u32:
s_waitcnt vmcnt(9) lgkmcnt(0)
mvaa 204,220,188
s_barrier
mvaa 192,224,192
tra 208,247,24832
tra 210,247,25600
mvaa 200,224,196
tra 212,247,24864
tra 214,247,25632
mvaa 196,228,192
tra 216,247,24896
tra 218,247,25664
mvaa 204,228,196
tra 220,247,24928
tra 222,247,25696
mvaa 192,232,200
s_add_u32 m0, s73, 0
tra 224,247,24960
buffer_load_dwordx4 v232, s[48:51], s75 offen nt lds
mvaa 200,232,204
tra 226,247,25728
tra 228,247,24992
mvaa 196,236,200
tra 230,247,25760
tra 232,247,25024
mvaa 204,236,204
wl 11
tra 234,247,25792
tra 236,247,25056
mvaa 96,208,64
tra 238,247,25824
mvaa 104,208,68
wl 12
tra 208,247,25088
mvaa 100,212,64
tra 210,247,25856
mvaa 108,212,68
wl 12
tra 212,247,25120
cv 210,212
mvaa 112,216,64
tra 214,247,25888
buffer_load_dwordx4 v233, s[48:51], s75 offen offset:1024 nt lds
mvaa 120,216,68
wl 12
tra 216,247,25152
mvaa 116,220,64
tra 218,247,25920
mvaa 124,220,68
wl 12
tra 220,247,25184
ex 215
mvaa 128,224,64
tra 222,247,25952
mvaa 136,224,68
wl 12
tra 224,247,37248
tra 226,247,38016
mvaa 132,228,64
ex 216
mvaa 140,228,68
wl 12
tra 228,247,37280
cv 211,214
mvaa 144,232,64
tra 230,247,38048
buffer_load_dwordx4 v234, s[48:51], s75 offen offset:2048 nt lds
mvaa 152,232,68
wl 12
s_add_u32 s75, s75, 0x3000
tra 232,247,37312
mvaa 148,236,64
tra 234,247,38080
mvaa 156,236,68
wl 12
tra 236,247,37344
ex 217
mvaa 160,208,64
tra 238,247,38112
mvaa 168,208,68
wl 12
tra 208,247,37376
tra 210,247,38144
mvaa 164,212,64
s_add_u32 m0, s74, 0x3080
ex 218
mvaa 172,212,68
wl 12
tra 212,247,37408
buffer_load_dwordx4 v238, s[56:59], s77 offen lds
mvaa 176,216,64
tra 214,247,38176
mvaa 184,216,68
wl 12
tra 216,247,37440
cv 216,216
mvaa 180,220,64
tra 218,247,38208
mvaa 188,220,68
wl 12
tra 220,247,37472
tra 222,247,38240
mvaa 96,224,72
ex 219
mvaa 104,224,76
wl 12
tra 224,247,37504
mvaa 100,228,72
tra 226,247,38272
mvaa 108,228,76
wl 12
tra 228,247,37536
buffer_load_dwordx4 v239, s[56:59], s77 offen offset:1024 lds
mvaa 112,232,72
ex 220
mvaa 120,232,76
wl 11
tra 230,247,38304
mvaa 116,236,72
tra 232,247,37568
cv 217,218
mvaa 124,236,76
wl 11
tra 234,247,38336
mvaa 128,208,72
tra 236,247,37600
mvaa 136,208,76
wl 11
ex 221
mvaa 132,212,72
tra 238,247,38368
mvaa 140,212,76
wl 10
ex 222
mvaa 144,216,72
buffer_load_dwordx4 v240, s[56:59], s77 offen offset:2048 lds
mvaa 152,216,76
wl 8
s_add_u32 s77, s77, s80
mvaa 148,220,72
s_cmp_le_u32 s83, 2
s_cbranch_scc1 L_k1_tw_u34
L_k1_hb_u35:
s_waitcnt vmcnt(9) lgkmcnt(0)
mvaa 156,220,76
s_barrier
mvaa 160,224,72
tra 208,248,0
cv 218,220
mvaa 168,224,76
tra 210,248,768
tra 212,248,32
mvaa 164,228,72
s_add_u32 m0, s74, 0x6100
tra 214,248,800
ex 223
mvaa 172,228,76
tra 216,248,64
tra 218,248,832
mvaa 176,232,72
buffer_load_dwordx4 v238, s[56:59], s77 offen lds
mvaa 184,232,76
tra 220,248,96
cv 219,222
mvaa 180,236,72
tra 222,248,864
mvaa 188,236,76
tra 224,248,128
maav 240,248,208
tra 226,248,896
maav 244,248,216
wl 8
tra 228,248,160
mvav 0,208,208
tra 230,248,928
mvav 8,208,216
wl 8
tra 232,248,192
mvav 4,212,208
buffer_load_dwordx4 v239, s[56:59], s77 offen offset:1024 lds
mvav 12,212,216
wl 7
tra 234,248,960
v_max3_f32 v251, v192, v193, v194
mvav 16,216,208
tra 236,248,224
mvav 24,216,216
wl 7
tra 238,248,992
v_max3_f32 v251, v251, v195, v196
mvav 20,220,208
tra 208,248,256
mvav 28,220,216
wl 7
tra 210,248,1024
v_max3_f32 v251, v251, v197, v198
mvav 32,224,208
tra 212,248,288
mvav 40,224,216
wl 7
tra 214,248,1056
v_max3_f32 v251, v251, v199, v200
mvav 36,228,208
buffer_load_dwordx4 v240, s[56:59], s77 offen offset:2048 lds
mvav 44,228,216
wl 6
s_add_u32 s77, s77, s18
tra 216,248,320
mvav 48,232,208
s_sub_u32 s23, s77, s79
s_min_u32 s77, s77, s23
tra 218,248,1088
mvav 56,232,216
wl 6
tra 220,248,352
v_max3_f32 v251, v251, v201, v202
mvav 52,236,208
tra 222,248,1120
v_max3_f32 v251, v251, v203, v204
mvav 60,236,216
wl 6
rqa 224,243,12416
mvav 64,208,208
rqa 228,243,13952
v_max3_f32 v251, v251, v205, v206
mvav 72,208,216
wl 6
rqa 232,244,12416
v_max_f32 v251, v251, v207
mvav 68,212,208
rqa 236,244,13952
v_cmp_lt_f32 vcc, s43, v251
mvav 76,212,216
wl 6
s_add_u32 m0, s74, 0x9180
rqa 208,243,12544
mvav 80,216,208
buffer_load_dwordx4 v235, s[52:55], s76 offen nt lds
mvav 88,216,216
wl 5
rqa 212,243,14080
mvav 84,220,208
wl 5
rqa 216,244,12544
mvav 92,220,216
s_cbranch_vccnz L_k1_rr_u37
L_k1_rb_u38:
rqa 220,244,14080
cvaa 208,224,160,224
ex 192
cvaa 216,224,164,228
wl 6
rqa 224,243,12672
ex 193
cvaa 212,228,160,224
ex 194
cvaa 220,228,164,228
wl 6
rqa 228,243,14208
buffer_load_dwordx4 v236, s[52:55], s76 offen offset:1024 nt lds
cv 192,192
mvaa 208,232,168
ex 195
mvaa 216,232,172
wl 6
rqa 232,244,12672
ex 196
mvaa 212,236,168
cv 193,194
ex 197
mvaa 220,236,172
wl 6
rqa 236,244,14208
ex 198
mvaa 208,208,176
cv 194,196
ex 199
mvaa 216,208,180
wl 6
ex 200
mvaa 212,212,176
cv 195,198
ex 201
mvaa 220,212,180
wl 5
buffer_load_dwordx4 v237, s[52:55], s76 offen offset:2048 nt lds
mvaa 208,216,184
s_add_u32 s76, s76, 0x3000
ex 202
mvaa 216,216,188
wl 4
cv 200,200
ex 203
mvaa 212,220,184
s_cmp_le_u32 s83, 2
s_cbranch_scc1 L_k1_tw_u39
L_k1_hb_u40:
s_waitcnt vmcnt(9) lgkmcnt(0)
mvaa 220,220,188
s_barrier
mvaa 208,224,192
tra 208,248,24832
ex 204
mvaa 216,224,196
tra 210,248,25600
cv 201,202
mvaa 212,228,192
tra 212,248,24864
ex 205
mvaa 220,228,196
tra 214,248,25632
ex 206
mvaa 208,232,200
tra 216,248,24896
cv 202,204
ex 207
mvaa 216,232,204
tra 218,248,25664
cv 203,206
mvaa 212,236,200
tra 220,248,24928
tra 222,248,25696
mvaa 220,236,204
s_add_u32 m0, s73, 0xc200
tra 224,248,24960
buffer_load_dwordx4 v232, s[48:51], s75 offen nt lds
maav 240,248,192
tra 226,248,25728
maav 244,248,200
wl 8
tra 228,248,24992
mvav 0,208,192
tra 230,248,25760
mvav 8,208,200
wl 8
tra 232,248,25024
mvav 4,212,192
buffer_load_dwordx4 v233, s[48:51], s75 offen offset:1024 nt lds
mvav 12,212,200
wl 7
tra 234,248,25792
v_max3_f32 v251, v208, v209, v210
mvav 16,216,192
tra 236,248,25056
mvav 24,216,200
wl 7
tra 238,248,25824
v_max3_f32 v251, v251, v211, v212
mvav 20,220,192
tra 208,248,25088
mvav 28,220,200
wl 7
tra 210,248,25856
v_max3_f32 v251, v251, v213, v214
mvav 32,224,192
tra 212,248,25120
mvav 40,224,200
wl 7
tra 214,248,25888
v_max3_f32 v251, v251, v215, v216
mvav 36,228,192
buffer_load_dwordx4 v234, s[48:51], s75 offen offset:2048 nt lds
mvav 44,228,200
wl 6
s_add_u32 s75, s75, 0x3000
tra 216,248,25152
mvav 48,232,192
tra 218,248,25920
v_max3_f32 v251, v251, v217, v218
mvav 56,232,200
wl 6
tra 220,248,25184
mvav 52,236,192
tra 222,248,25952
v_max3_f32 v251, v251, v219, v220
mvav 60,236,200
wl 6
rqa 224,241,0
mvav 64,208,192
rqa 228,241,1536
v_max3_f32 v251, v251, v221, v222
mvav 72,208,200
wl 6
rqa 232,242,0
v_max_f32 v251, v251, v223
mvav 68,212,192
rqa 236,242,1536
v_cmp_lt_f32 vcc, s43, v251
mvav 76,212,200
wl 6
s_add_u32 m0, s74, 0xf280
rqa 208,241,128
mvav 80,216,192
buffer_load_dwordx4 v238, s[56:59], s77 offen lds
mvav 88,216,200
wl 5
rqa 212,241,1664
mvav 84,220,192
wl 5
rqa 216,242,128
mvav 92,220,200
s_cbranch_vccnz L_k1_rr_u42
L_k1_rb_u43:
s_cmp_eq_u32 s83, 3
s_cbranch_scc1 L_k1_exit
cvaa 192,224,160,224
ex 208
cvaa 200,224,164,228
wl 5
rqa 220,242,1664
cvaa 196,228,160,224
buffer_load_dwordx4 v239, s[56:59], s77 offen offset:1024 lds
cvaa 204,228,164,228
wl 5
rqa 224,241,256
mvaa 192,232,168
ex 209
mvaa 200,232,172
wl 5
rqa 228,241,1792
mvaa 196,236,168
ex 210
mvaa 204,236,172
wl 5
rqa 232,242,256
cv 208,208
mvaa 192,208,176
ex 211
mvaa 200,208,180
wl 5
ex 212
mvaa 196,212,176
rqa 236,242,1792
cv 209,210
mvaa 204,212,180
wl 5
buffer_load_dwordx4 v240, s[56:59], s77 offen offset:2048 lds
mvaa 192,216,184
s_add_u32 s77, s77, s80
ex 213
mvaa 200,216,188
wl 4
ex 214
mvaa 196,220,184
s_cmp_le_u32 s83, 1
s_cbranch_scc1 L_k1_tw_u44
L_k1_hb_u45:
s_waitcnt vmcnt(9) lgkmcnt(0)
mvaa 204,220,188
s_barrier
mvaa 192,224,192
tra 208,247,12416
tra 210,247,13184
mvaa 200,224,196
tra 212,247,12448
tra 214,247,13216
mvaa 196,228,192
tra 216,247,12480
tra 218,247,13248
mvaa 204,228,196
tra 220,247,12512
tra 222,247,13280
mvaa 192,232,200
s_add_u32 m0, s74, 0x12300
tra 224,247,12544
buffer_load_dwordx4 v238, s[56:59], s77 offen lds
mvaa 200,232,204
tra 226,247,13312
tra 228,247,12576
mvaa 196,236,200
tra 230,247,13344
tra 232,247,12608
mvaa 204,236,204
wl 11
tra 234,247,13376
tra 236,247,12640
mvaa 96,208,80
tra 238,247,13408
mvaa 104,208,84
wl 12
tra 208,247,12672
mvaa 100,212,80
tra 210,247,13440
mvaa 108,212,84
wl 12
tra 212,247,12704
cv 210,212
mvaa 112,216,80
tra 214,247,13472
buffer_load_dwordx4 v239, s[56:59], s77 offen offset:1024 lds
mvaa 120,216,84
wl 12
tra 216,247,12736
mvaa 116,220,80
tra 218,247,13504
mvaa 124,220,84
wl 12
tra 220,247,12768
ex 215
mvaa 128,224,80
tra 222,247,13536
mvaa 136,224,84
wl 12
tra 224,247,24832
tra 226,247,25600
mvaa 132,228,80
ex 216
mvaa 140,228,84
wl 12
tra 228,247,24864
cv 211,214
mvaa 144,232,80
tra 230,247,25632
buffer_load_dwordx4 v240, s[56:59], s77 offen offset:2048 lds
mvaa 152,232,84
wl 12
s_add_u32 s77, s77, s17
tra 232,247,24896
mvaa 148,236,80
s_sub_u32 s23, s77, s79
s_min_u32 s77, s77, s23
tra 234,247,25664
mvaa 156,236,84
wl 12
tra 236,247,24928
ex 217
mvaa 160,208,80
tra 238,247,25696
mvaa 168,208,84
wl 12
tra 208,247,24960
tra 210,247,25728
mvaa 164,212,80
s_add_u32 m0, s74, 0x15380
ex 218
mvaa 172,212,84
wl 12
tra 212,247,24992
buffer_load_dwordx4 v235, s[52:55], s76 offen nt lds
mvaa 176,216,80
tra 214,247,25760
mvaa 184,216,84
wl 12
tra 216,247,25024
cv 216,216
mvaa 180,220,80
tra 218,247,25792
mvaa 188,220,84
wl 12
tra 220,247,25056
tra 222,247,25824
mvaa 96,224,88
ex 219
mvaa 104,224,92
wl 12
tra 224,247,25088
mvaa 100,228,88
tra 226,247,25856
mvaa 108,228,92
wl 12
tra 228,247,25120
buffer_load_dwordx4 v236, s[52:55], s76 offen offset:1024 nt lds
mvaa 112,232,88
ex 220
mvaa 120,232,92
wl 11
tra 230,247,25888
mvaa 116,236,88
tra 232,247,25152
cv 217,218
mvaa 124,236,92
wl 11
tra 234,247,25920
mvaa 128,208,88
tra 236,247,25184
mvaa 136,208,92
wl 11
ex 221
mvaa 132,212,88
tra 238,247,25952
mvaa 140,212,92
wl 10
ex 222
mvaa 144,216,88
buffer_load_dwordx4 v237, s[52:55], s76 offen offset:2048 nt lds
mvaa 152,216,92
wl 8
s_add_u32 s76, s76, 0x3000
mvaa 148,220,88
s_cmp_le_u32 s83, 1
s_cbranch_scc1 L_k1_tw_u47
L_k1_hb_u48:
s_waitcnt vmcnt(9) lgkmcnt(0)
mvaa 156,220,92
s_barrier
mvaa 160,224,88
tra 208,247,37248
cv 218,220
mvaa 168,224,92
tra 210,247,38016
tra 212,247,37280
mvaa 164,228,88
s_add_u32 m0, s73, 0
tra 214,247,38048
ex 223
mvaa 172,228,92
tra 216,247,37312
tra 218,247,38080
mvaa 176,232,88
buffer_load_dwordx4 v232, s[48:51], s75 offen nt lds
mvaa 184,232,92
tra 220,247,37344
cv 219,222
mvaa 180,236,88
tra 222,247,38112
mvaa 188,236,92
tra 224,247,37376
maav 240,248,208
tra 226,247,38144
maav 244,248,216
wl 8
tra 228,247,37408
mvav 0,208,208
tra 230,247,38176
mvav 8,208,216
wl 8
tra 232,247,37440
mvav 4,212,208
buffer_load_dwordx4 v233, s[48:51], s75 offen offset:1024 nt lds
mvav 12,212,216
wl 7
tra 234,247,38208
v_max3_f32 v251, v192, v193, v194
mvav 16,216,208
tra 236,247,37472
mvav 24,216,216
wl 7
tra 238,247,38240
v_max3_f32 v251, v251, v195, v196
mvav 20,220,208
tra 208,247,37504
mvav 28,220,216
wl 7
tra 210,247,38272
v_max3_f32 v251, v251, v197, v198
mvav 32,224,208
tra 212,247,37536
mvav 40,224,216
wl 7
tra 214,247,38304
v_max3_f32 v251, v251, v199, v200
mvav 36,228,208
buffer_load_dwordx4 v234, s[48:51], s75 offen offset:2048 nt lds
mvav 44,228,216
wl 6
s_add_u32 s75, s75, 0x3000
tra 216,247,37568
mvav 48,232,208
tra 218,247,38336
v_max3_f32 v251, v251, v201, v202
mvav 56,232,216
wl 6
tra 220,247,37600
mvav 52,236,208
tra 222,247,38368
v_max3_f32 v251, v251, v203, v204
mvav 60,236,216
wl 6
rqa 224,241,49664
mvav 64,208,208
rqa 228,241,51200
v_max3_f32 v251, v251, v205, v206
mvav 72,208,216
wl 6
rqa 232,242,49664
v_max_f32 v251, v251, v207
mvav 68,212,208
rqa 236,242,51200
v_cmp_lt_f32 vcc, s43, v251
mvav 76,212,216
wl 6
s_add_u32 m0, s74, 0x3080
rqa 208,241,49792
mvav 80,216,208
buffer_load_dwordx4 v235, s[52:55], s76 offen nt lds
mvav 88,216,216
wl 5
rqa 212,241,51328
mvav 84,220,208
wl 5
rqa 216,242,49792
mvav 92,220,216
s_cbranch_vccnz L_k1_rr_u50
L_k1_rb_u51:
cvaa 208,224,160,224
ex 192
cvaa 216,224,164,228
wl 5
rqa 220,242,51328
cvaa 212,228,160,224
buffer_load_dwordx4 v236, s[52:55], s76 offen offset:1024 nt lds
cvaa 220,228,164,228
wl 5
rqa 224,241,49920
mvaa 208,232,168
ex 193
mvaa 216,232,172
wl 5
rqa 228,241,51456
mvaa 212,236,168
ex 194
mvaa 220,236,172
wl 5
rqa 232,242,49920
cv 192,192
mvaa 208,208,176
ex 195
mvaa 216,208,180
wl 5
ex 196
mvaa 212,212,176
rqa 236,242,51456
cv 193,194
mvaa 220,212,180
wl 5
buffer_load_dwordx4 v237, s[52:55], s76 offen offset:2048 nt lds
mvaa 208,216,184
s_add_u32 s76, s76, 0x3000
ex 197
mvaa 216,216,188
wl 4
ex 198
mvaa 212,220,184
s_cmp_le_u32 s83, 1
s_cbranch_scc1 L_k1_tw_u52
L_k1_hb_u53:
s_waitcnt vmcnt(9) lgkmcnt(0)
mvaa 220,220,188
s_barrier
mvaa 208,224,192
tra 208,248,0
tra 210,248,768
mvaa 216,224,196
tra 212,248,32
tra 214,248,800
mvaa 212,228,192
tra 216,248,64
tra 218,248,832
mvaa 220,228,196
tra 220,248,96
tra 222,248,864
mvaa 208,232,200
s_add_u32 m0, s73, 0x9180
tra 224,248,128
buffer_load_dwordx4 v232, s[48:51], s75 offen nt lds
mvaa 216,232,204
tra 226,248,896
tra 228,248,160
mvaa 212,236,200
tra 230,248,928
tra 232,248,192
mvaa 220,236,204
wl 11
tra 234,248,960
tra 236,248,224
mvaa 96,208,96
tra 238,248,992
mvaa 104,208,100
wl 12
tra 208,248,256
mvaa 100,212,96
tra 210,248,1024
mvaa 108,212,100
wl 12
tra 212,248,288
cv 194,196
mvaa 112,216,96
tra 214,248,1056
buffer_load_dwordx4 v233, s[48:51], s75 offen offset:1024 nt lds
mvaa 120,216,100
wl 12
tra 216,248,320
mvaa 116,220,96
tra 218,248,1088
mvaa 124,220,100
wl 12
tra 220,248,352
ex 199
mvaa 128,224,96
tra 222,248,1120
mvaa 136,224,100
wl 12
tra 224,248,12416
tra 226,248,13184
mvaa 132,228,96
ex 200
mvaa 140,228,100
wl 12
tra 228,248,12448
cv 195,198
mvaa 144,232,96
tra 230,248,13216
buffer_load_dwordx4 v234, s[48:51], s75 offen offset:2048 nt lds
mvaa 152,232,100
wl 12
s_add_u32 s75, s75, 0x3000
tra 232,248,12480
mvaa 148,236,96
tra 234,248,13248
mvaa 156,236,100
wl 12
tra 236,248,12512
ex 201
mvaa 160,208,96
tra 238,248,13280
mvaa 168,208,100
wl 12
tra 208,248,12544
tra 210,248,13312
mvaa 164,212,96
s_add_u32 m0, s74, 0xc200
ex 202
mvaa 172,212,100
wl 12
tra 212,248,12576
buffer_load_dwordx4 v238, s[56:59], s77 offen lds
mvaa 176,216,96
tra 214,248,13344
mvaa 184,216,100
wl 12
tra 216,248,12608
cv 200,200
mvaa 180,220,96
tra 218,248,13376
mvaa 188,220,100
wl 12
tra 220,248,12640
tra 222,248,13408
mvaa 96,224,104
ex 203
mvaa 104,224,108
wl 12
tra 224,248,12672
mvaa 100,228,104
tra 226,248,13440
mvaa 108,228,108
wl 12
tra 228,248,12704
buffer_load_dwordx4 v239, s[56:59], s77 offen offset:1024 lds
mvaa 112,232,104
ex 204
mvaa 120,232,108
wl 11
tra 230,248,13472
mvaa 116,236,104
tra 232,248,12736
cv 201,202
mvaa 124,236,108
wl 11
tra 234,248,13504
mvaa 128,208,104
tra 236,248,12768
mvaa 136,208,108
wl 11
ex 205
mvaa 132,212,104
tra 238,248,13536
mvaa 140,212,108
wl 10
ex 206
mvaa 144,216,104
buffer_load_dwordx4 v240, s[56:59], s77 offen offset:2048 lds
mvaa 152,216,108
wl 8
s_add_u32 s77, s77, s80
mvaa 148,220,104
s_cmp_le_u32 s83, 1
s_cbranch_scc1 L_k1_tw_u55
L_k1_hb_u56:
s_waitcnt vmcnt(9) lgkmcnt(0)
mvaa 156,220,108
s_barrier
mvaa 160,224,104
tra 208,248,24832
cv 202,204
mvaa 168,224,108
tra 210,248,25600
tra 212,248,24864
mvaa 164,228,104
tra 214,248,25632
ex 207
mvaa 172,228,108
tra 216,248,24896
tra 218,248,25664
mvaa 176,232,104
s_add_u32 m0, s74, 0xf280
tra 220,248,24928
buffer_load_dwordx4 v238, s[56:59], s77 offen lds
mvaa 184,232,108
tra 222,248,25696
cv 203,206
mvaa 180,236,104
tra 224,248,24960
mvaa 188,236,108
tra 226,248,25728
maav 240,248,192
wl 8
tra 228,248,24992
maav 244,248,200
s_cmp_eq_u32 s83, 2
s_cbranch_scc1 L_k1_hk_u58
L_k1_hb_u59:
mvav 0,208,192
tra 230,248,25760
mvav 8,208,200
wl 8
tra 232,248,25024
mvav 4,212,192
buffer_load_dwordx4 v239, s[56:59], s77 offen offset:1024 lds
mvav 12,212,200
wl 7
tra 234,248,25792
v_max3_f32 v251, v208, v209, v210
mvav 16,216,192
tra 236,248,25056
mvav 24,216,200
wl 7
tra 238,248,25824
v_max3_f32 v251, v251, v211, v212
mvav 20,220,192
tra 208,248,25088
mvav 28,220,200
wl 7
tra 210,248,25856
v_max3_f32 v251, v251, v213, v214
mvav 32,224,192
tra 212,248,25120
mvav 40,224,200
wl 7
tra 214,248,25888
v_max3_f32 v251, v251, v215, v216
mvav 36,228,192
buffer_load_dwordx4 v240, s[56:59], s77 offen offset:2048 lds
mvav 44,228,200
wl 6
s_add_u32 s77, s77, s18
tra 216,248,25152
mvav 48,232,192
s_sub_u32 s23, s77, s79
s_min_u32 s77, s77, s23
tra 218,248,25920
mvav 56,232,200
wl 6
tra 220,248,25184
v_max3_f32 v251, v251, v217, v218
mvav 52,236,192
tra 222,248,25952
v_max3_f32 v251, v251, v219, v220
mvav 60,236,200
wl 6
rqa 224,241,0
mvav 64,208,192
rqa 228,241,1536
v_max3_f32 v251, v251, v221, v222
mvav 72,208,200
wl 6
rqa 232,242,0
v_max_f32 v251, v251, v223
mvav 68,212,192
rqa 236,242,1536
v_cmp_lt_f32 vcc, s43, v251
mvav 76,212,200
wl 6
s_add_u32 m0, s74, 0x12300
rqa 208,241,128
mvav 80,216,192
buffer_load_dwordx4 v235, s[52:55], s76 offen nt lds
mvav 88,216,200
wl 5
rqa 212,241,1664
mvav 84,220,192
wl 5
rqa 216,242,128
mvav 92,220,200
s_cbranch_vccnz L_k1_rr_u60
L_k1_rb_u61:
rqa 220,242,1664
cvaa 192,224,160,224
ex 208
cvaa 200,224,164,228
wl 6
rqa 224,241,256
ex 209
cvaa 196,228,160,224
ex 210
cvaa 204,228,164,228
wl 6
rqa 228,241,1792
buffer_load_dwordx4 v236, s[52:55], s76 offen offset:1024 nt lds
cv 208,208
mvaa 192,232,168
ex 211
mvaa 200,232,172
wl 6
rqa 232,242,256
ex 212
mvaa 196,236,168
cv 209,210
ex 213
mvaa 204,236,172
wl 6
rqa 236,242,1792
ex 214
mvaa 192,208,176
cv 210,212
ex 215
mvaa 200,208,180
wl 6
ex 216
mvaa 196,212,176
cv 211,214
ex 217
mvaa 204,212,180
wl 5
buffer_load_dwordx4 v237, s[52:55], s76 offen offset:2048 nt lds
mvaa 192,216,184
s_add_u32 s76, s76, 0x3000
ex 218
mvaa 200,216,188
wl 4
cv 216,216
ex 219
mvaa 196,220,184
s_cmp_le_u32 s83, 1
s_cbranch_scc1 L_k1_tw_u62
L_k1_hb_u63:
s_waitcnt vmcnt(9) lgkmcnt(0)
mvaa 204,220,188
s_barrier
mvaa 192,224,192
tra 208,247,12416
ex 220
mvaa 200,224,196
tra 210,247,13184
cv 217,218
mvaa 196,228,192
tra 212,247,12448
ex 221
mvaa 204,228,196
tra 214,247,13216
ex 222
mvaa 192,232,200
tra 216,247,12480
cv 218,220
ex 223
mvaa 200,232,204
tra 218,247,13248
cv 219,222
mvaa 196,236,200
tra 220,247,12512
tra 222,247,13280
mvaa 204,236,204
s_add_u32 m0, s73, 0x15380
tra 224,247,12544
buffer_load_dwordx4 v232, s[48:51], s75 offen nt lds
maav 240,248,208
tra 226,247,13312
maav 244,248,216
wl 8
tra 228,247,12576
mvav 0,208,208
tra 230,247,13344
mvav 8,208,216
wl 8
tra 232,247,12608
mvav 4,212,208
buffer_load_dwordx4 v233, s[48:51], s75 offen offset:1024 nt lds
mvav 12,212,216
wl 7
tra 234,247,13376
v_max3_f32 v251, v192, v193, v194
mvav 16,216,208
tra 236,247,12640
mvav 24,216,216
wl 7
tra 238,247,13408
v_max3_f32 v251, v251, v195, v196
mvav 20,220,208
tra 208,247,12672
mvav 28,220,216
wl 7
tra 210,247,13440
v_max3_f32 v251, v251, v197, v198
mvav 32,224,208
tra 212,247,12704
mvav 40,224,216
wl 7
tra 214,247,13472
v_max3_f32 v251, v251, v199, v200
mvav 36,228,208
buffer_load_dwordx4 v234, s[48:51], s75 offen offset:2048 nt lds
mvav 44,228,216
wl 6
s_add_u32 s75, s75, 0x3000
tra 216,247,12736
mvav 48,232,208
tra 218,247,13504
v_max3_f32 v251, v251, v201, v202
mvav 56,232,216
wl 6
tra 220,247,12768
mvav 52,236,208
tra 222,247,13536
v_max3_f32 v251, v251, v203, v204
mvav 60,236,216
wl 6
rqa 224,241,37248
mvav 64,208,208
rqa 228,241,38784
v_max3_f32 v251, v251, v205, v206
mvav 72,208,216
wl 6
rqa 232,242,37248
v_max_f32 v251, v251, v207
mvav 68,212,208
rqa 236,242,38784
v_cmp_lt_f32 vcc, s43, v251
mvav 76,212,216
wl 6
s_add_u32 m0, s74, 0
rqa 208,241,37376
mvav 80,216,208
buffer_load_dwordx4 v238, s[56:59], s77 offen lds
mvav 88,216,216
wl 5
rqa 212,241,38912
mvav 84,220,208
wl 5
rqa 216,242,37376
mvav 92,220,216
s_cbranch_vccnz L_k1_rr_u65
L_k1_rb_u66:
cvaa 208,224,160,224
ex 192
cvaa 216,224,164,228
wl 5
rqa 220,242,38912
cvaa 212,228,160,224
buffer_load_dwordx4 v239, s[56:59], s77 offen offset:1024 lds
cvaa 220,228,164,228
wl 5
rqa 224,241,37504
mvaa 208,232,168
ex 193
mvaa 216,232,172
wl 5
rqa 228,241,39040
mvaa 212,236,168
ex 194
mvaa 220,236,172
wl 5
rqa 232,242,37504
cv 192,192
mvaa 208,208,176
ex 195
mvaa 216,208,180
wl 5
ex 196
mvaa 212,212,176
rqa 236,242,39040
cv 193,194
mvaa 220,212,180
wl 5
buffer_load_dwordx4 v240, s[56:59], s77 offen offset:2048 lds
mvaa 208,216,184
s_add_u32 s77, s77, s80
ex 197
mvaa 216,216,188
wl 4
ex 198
mvaa 212,220,184
s_cmp_le_u32 s83, 1
s_cbranch_scc1 L_k1_tw_u67
L_k1_hb_u68:
s_waitcnt vmcnt(9) lgkmcnt(0)
mvaa 220,220,188
s_barrier
mvaa 208,224,192
tra 208,247,49664
tra 210,247,50432
mvaa 216,224,196
tra 212,247,49696
tra 214,247,50464
mvaa 212,228,192
tra 216,247,49728
tra 218,247,50496
mvaa 220,228,196
tra 220,247,49760
tra 222,247,50528
mvaa 208,232,200
s_add_u32 m0, s74, 0x3080
tra 224,247,49792
buffer_load_dwordx4 v238, s[56:59], s77 offen lds
mvaa 216,232,204
tra 226,247,50560
tra 228,247,49824
mvaa 212,236,200
tra 230,247,50592
tra 232,247,49856
mvaa 220,236,204
wl 11
tra 234,247,50624
tra 236,247,49888
mvaa 96,208,112
tra 238,247,50656
mvaa 104,208,116
wl 12
tra 208,247,49920
mvaa 100,212,112
tra 210,247,50688
mvaa 108,212,116
wl 12
tra 212,247,49952
cv 194,196
mvaa 112,216,112
tra 214,247,50720
buffer_load_dwordx4 v239, s[56:59], s77 offen offset:1024 lds
mvaa 120,216,116
wl 12
tra 216,247,49984
mvaa 116,220,112
tra 218,247,50752
mvaa 124,220,116
wl 12
tra 220,247,50016
ex 199
mvaa 128,224,112
tra 222,247,50784
mvaa 136,224,116
wl 12
tra 224,248,0
tra 226,248,768
mvaa 132,228,112
ex 200
mvaa 140,228,116
wl 12
tra 228,248,32
cv 195,198
mvaa 144,232,112
tra 230,248,800
buffer_load_dwordx4 v240, s[56:59], s77 offen offset:2048 lds
mvaa 152,232,116
wl 12
s_add_u32 s77, s77, s16
tra 232,248,64
mvaa 148,236,112
s_sub_u32 s23, s77, s79
s_min_u32 s77, s77, s23
tra 234,248,832
mvaa 156,236,116
wl 12
tra 236,248,96
ex 201
mvaa 160,208,112
tra 238,248,864
mvaa 168,208,116
wl 12
tra 208,248,128
tra 210,248,896
mvaa 164,212,112
s_add_u32 m0, s74, 0x6100
ex 202
mvaa 172,212,116
wl 12
tra 212,248,160
buffer_load_dwordx4 v235, s[52:55], s76 offen nt lds
mvaa 176,216,112
tra 214,248,928
mvaa 184,216,116
wl 12
tra 216,248,192
cv 200,200
mvaa 180,220,112
tra 218,248,960
mvaa 188,220,116
wl 12
tra 220,248,224
tra 222,248,992
mvaa 96,224,120
ex 203
mvaa 104,224,124
wl 12
tra 224,248,256
mvaa 100,228,120
tra 226,248,1024
mvaa 108,228,124
wl 12
tra 228,248,288
buffer_load_dwordx4 v236, s[52:55], s76 offen offset:1024 nt lds
mvaa 112,232,120
ex 204
mvaa 120,232,124
wl 11
tra 230,248,1056
mvaa 116,236,120
tra 232,248,320
cv 201,202
mvaa 124,236,124
wl 11
tra 234,248,1088
mvaa 128,208,120
tra 236,248,352
mvaa 136,208,124
wl 11
ex 205
mvaa 132,212,120
tra 238,248,1120
mvaa 140,212,124
wl 10
ex 206
mvaa 144,216,120
buffer_load_dwordx4 v237, s[52:55], s76 offen offset:2048 nt lds
mvaa 152,216,124
wl 8
s_add_u32 s76, s76, 0x3000
mvaa 148,220,120
s_cmp_le_u32 s83, 1
s_cbranch_scc1 L_k1_tw_u70
L_k1_hb_u71:
s_waitcnt vmcnt(9) lgkmcnt(0)
mvaa 156,220,124
s_barrier
mvaa 160,224,120
tra 208,248,12416
cv 202,204
mvaa 168,224,124
tra 210,248,13184
tra 212,248,12448
mvaa 164,228,120
tra 214,248,13216
ex 207
mvaa 172,228,124
tra 216,248,12480
tra 218,248,13248
mvaa 176,232,120
s_add_u32 m0, s73, 0x9180
tra 220,248,12512
buffer_load_dwordx4 v232, s[48:51], s75 offen nt lds
mvaa 184,232,124
tra 222,248,13280
cv 203,206
mvaa 180,236,120
tra 224,248,12544
mvaa 188,236,124
tra 226,248,13312
maav 240,248,192
wl 8
tra 228,248,12576
maav 244,248,200
s_cmp_eq_u32 s83, 2
s_cbranch_scc1 L_k1_hk_u73
L_k1_hb_u74:
mvav 0,208,192
tra 230,248,13344
mvav 8,208,200
wl 8
tra 232,248,12608
mvav 4,212,192
buffer_load_dwordx4 v233, s[48:51], s75 offen offset:1024 nt lds
mvav 12,212,200
wl 7
tra 234,248,13376
v_max3_f32 v251, v208, v209, v210
mvav 16,216,192
tra 236,248,12640
mvav 24,216,200
wl 7
tra 238,248,13408
v_max3_f32 v251, v251, v211, v212
mvav 20,220,192
tra 208,248,12672
mvav 28,220,200
wl 7
tra 210,248,13440
v_max3_f32 v251, v251, v213, v214
mvav 32,224,192
tra 212,248,12704
mvav 40,224,200
wl 7
tra 214,248,13472
v_max3_f32 v251, v251, v215, v216
mvav 36,228,192
buffer_load_dwordx4 v234, s[48:51], s75 offen offset:2048 nt lds
mvav 44,228,200
wl 6
s_add_u32 s75, s75, 0x3000
tra 216,248,12736
mvav 48,232,192
tra 218,248,13504
v_max3_f32 v251, v251, v217, v218
mvav 56,232,200
wl 6
tra 220,248,12768
mvav 52,236,192
tra 222,248,13536
v_max3_f32 v251, v251, v219, v220
mvav 60,236,200
wl 6
rqa 224,243,24832
mvav 64,208,192
rqa 228,243,26368
v_max3_f32 v251, v251, v221, v222
mvav 72,208,200
wl 6
rqa 232,244,24832
v_max_f32 v251, v251, v223
mvav 68,212,192
rqa 236,244,26368
v_cmp_lt_f32 vcc, s43, v251
mvav 76,212,200
wl 6
s_add_u32 m0, s74, 0xc200
rqa 208,243,24960
mvav 80,216,192
buffer_load_dwordx4 v235, s[52:55], s76 offen nt lds
mvav 88,216,200
wl 5
rqa 212,243,26496
mvav 84,220,192
wl 5
rqa 216,244,24960
mvav 92,220,200
s_cbranch_vccnz L_k1_rr_u75
L_k1_rb_u76:
cvaa 192,224,160,224
ex 208
cvaa 200,224,164,228
wl 5
rqa 220,244,26496
cvaa 196,228,160,224
buffer_load_dwordx4 v236, s[52:55], s76 offen offset:1024 nt lds
cvaa 204,228,164,228
wl 5
rqa 224,243,25088
mvaa 192,232,168
ex 209
mvaa 200,232,172
wl 5
rqa 228,243,26624
mvaa 196,236,168
ex 210
mvaa 204,236,172
wl 5
rqa 232,244,25088
cv 208,208
mvaa 192,208,176
ex 211
mvaa 200,208,180
wl 5
ex 212
mvaa 196,212,176
rqa 236,244,26624
cv 209,210
mvaa 204,212,180
wl 5
buffer_load_dwordx4 v237, s[52:55], s76 offen offset:2048 nt lds
mvaa 192,216,184
s_add_u32 s76, s76, 0x3000
ex 213
mvaa 200,216,188
wl 4
ex 214
mvaa 196,220,184
s_cmp_le_u32 s83, 1
s_cbranch_scc1 L_k1_tw_u77
L_k1_hb_u78:
s_waitcnt vmcnt(9) lgkmcnt(0)
mvaa 204,220,188
s_barrier
mvaa 192,224,192
tra 208,247,0
tra 210,247,768
mvaa 200,224,196
tra 212,247,32
tra 214,247,800
mvaa 196,228,192
tra 216,247,64
tra 218,247,832
mvaa 204,228,196
tra 220,247,96
tra 222,247,864
mvaa 192,232,200
s_add_u32 m0, s73, 0xf280
tra 224,247,128
buffer_load_dwordx4 v232, s[48:51], s75 offen nt lds
mvaa 200,232,204
tra 226,247,896
tra 228,247,160
mvaa 196,236,200
tra 230,247,928
tra 232,247,192
mvaa 204,236,204
wl 11
tra 234,247,960
tra 236,247,224
mvaa 96,208,128
tra 238,247,992
mvaa 104,208,132
wl 12
tra 208,247,256
mvaa 100,212,128
tra 210,247,1024
mvaa 108,212,132
wl 12
tra 212,247,288
cv 210,212
mvaa 112,216,128
tra 214,247,1056
buffer_load_dwordx4 v233, s[48:51], s75 offen offset:1024 nt lds
mvaa 120,216,132
wl 12
tra 216,247,320
mvaa 116,220,128
tra 218,247,1088
mvaa 124,220,132
wl 12
tra 220,247,352
ex 215
mvaa 128,224,128
tra 222,247,1120
mvaa 136,224,132
wl 12
tra 224,247,12416
tra 226,247,13184
mvaa 132,228,128
ex 216
mvaa 140,228,132
wl 12
tra 228,247,12448
cv 211,214
mvaa 144,232,128
tra 230,247,13216
buffer_load_dwordx4 v234, s[48:51], s75 offen offset:2048 nt lds
mvaa 152,232,132
wl 12
s_add_u32 s75, s75, 0x3000
tra 232,247,12480
mvaa 148,236,128
tra 234,247,13248
mvaa 156,236,132
wl 12
tra 236,247,12512
ex 217
mvaa 160,208,128
tra 238,247,13280
mvaa 168,208,132
wl 12
tra 208,247,12544
tra 210,247,13312
mvaa 164,212,128
s_add_u32 m0, s74, 0x12300
ex 218
mvaa 172,212,132
wl 12
tra 212,247,12576
buffer_load_dwordx4 v238, s[56:59], s77 offen lds
mvaa 176,216,128
tra 214,247,13344
mvaa 184,216,132
wl 12
tra 216,247,12608
cv 216,216
mvaa 180,220,128
tra 218,247,13376
mvaa 188,220,132
wl 12
tra 220,247,12640
tra 222,247,13408
mvaa 96,224,136
ex 219
mvaa 104,224,140
wl 12
tra 224,247,12672
mvaa 100,228,136
tra 226,247,13440
mvaa 108,228,140
wl 12
tra 228,247,12704
buffer_load_dwordx4 v239, s[56:59], s77 offen offset:1024 lds
mvaa 112,232,136
ex 220
mvaa 120,232,140
wl 11
tra 230,247,13472
mvaa 116,236,136
tra 232,247,12736
cv 217,218
mvaa 124,236,140
wl 11
tra 234,247,13504
mvaa 128,208,136
tra 236,247,12768
mvaa 136,208,140
wl 11
ex 221
mvaa 132,212,136
tra 238,247,13536
mvaa 140,212,140
wl 10
ex 222
mvaa 144,216,136
buffer_load_dwordx4 v240, s[56:59], s77 offen offset:2048 lds
mvaa 152,216,140
wl 8
s_add_u32 s77, s77, s80
mvaa 148,220,136
s_cmp_le_u32 s83, 1
s_cbranch_scc1 L_k1_tw_u80
L_k1_hb_u81:
s_waitcnt vmcnt(9) lgkmcnt(0)
mvaa 156,220,140
s_barrier
mvaa 160,224,136
tra 208,247,24832
cv 218,220
mvaa 168,224,140
tra 210,247,25600
tra 212,247,24864
mvaa 164,228,136
tra 214,247,25632
ex 223
mvaa 172,228,140
tra 216,247,24896
tra 218,247,25664
mvaa 176,232,136
s_add_u32 m0, s74, 0x15380
tra 220,247,24928
buffer_load_dwordx4 v238, s[56:59], s77 offen lds
mvaa 184,232,140
tra 222,247,25696
cv 219,222
mvaa 180,236,136
tra 224,247,24960
mvaa 188,236,140
tra 226,247,25728
maav 240,248,208
wl 8
tra 228,247,24992
maav 244,248,216
s_cmp_eq_u32 s83, 2
s_cbranch_scc1 L_k1_hk_u83
L_k1_hb_u84:
mvav 0,208,208
tra 230,247,25760
mvav 8,208,216
wl 8
tra 232,247,25024
mvav 4,212,208
buffer_load_dwordx4 v239, s[56:59], s77 offen offset:1024 lds
mvav 12,212,216
wl 7
tra 234,247,25792
v_max3_f32 v251, v192, v193, v194
mvav 16,216,208
tra 236,247,25056
mvav 24,216,216
wl 7
tra 238,247,25824
v_max3_f32 v251, v251, v195, v196
mvav 20,220,208
tra 208,247,25088
mvav 28,220,216
wl 7
tra 210,247,25856
v_max3_f32 v251, v251, v197, v198
mvav 32,224,208
tra 212,247,25120
mvav 40,224,216
wl 7
tra 214,247,25888
v_max3_f32 v251, v251, v199, v200
mvav 36,228,208
buffer_load_dwordx4 v240, s[56:59], s77 offen offset:2048 lds
mvav 44,228,216
wl 6
s_add_u32 s77, s77, s80
tra 216,247,25152
mvav 48,232,208
s_sub_u32 s23, s77, s79
s_min_u32 s77, s77, s23
tra 218,247,25920
mvav 56,232,216
wl 6
tra 220,247,25184
v_max3_f32 v251, v251, v201, v202
mvav 52,236,208
tra 222,247,25952
v_max3_f32 v251, v251, v203, v204
mvav 60,236,216
wl 6
rqa 224,241,37248
mvav 64,208,208
rqa 228,241,38784
v_max3_f32 v251, v251, v205, v206
mvav 72,208,216
wl 6
rqa 232,242,37248
v_max_f32 v251, v251, v207
mvav 68,212,208
rqa 236,242,38784
v_cmp_lt_f32 vcc, s43, v251
mvav 76,212,216
wl 6
s_add_u32 m0, s74, 0x3080
rqa 208,241,37376
mvav 80,216,208
buffer_load_dwordx4 v235, s[52:55], s76 offen nt lds
mvav 88,216,216
wl 5
rqa 212,241,38912
mvav 84,220,208
wl 5
rqa 216,242,37376
mvav 92,220,216
s_cbranch_vccnz L_k1_rr_u85
L_k1_rb_u86:
rqa 220,242,38912
cvaa 208,224,160,224
ex 192
cvaa 216,224,164,228
wl 6
rqa 224,241,37504
ex 193
cvaa 212,228,160,224
ex 194
cvaa 220,228,164,228
wl 6
rqa 228,241,39040
buffer_load_dwordx4 v236, s[52:55], s76 offen offset:1024 nt lds
cv 192,192
mvaa 208,232,168
ex 195
mvaa 216,232,172
wl 6
rqa 232,242,37504
ex 196
mvaa 212,236,168
cv 193,194
ex 197
mvaa 220,236,172
wl 6
rqa 236,242,39040
ex 198
mvaa 208,208,176
cv 194,196
ex 199
mvaa 216,208,180
wl 6
ex 200
mvaa 212,212,176
cv 195,198
ex 201
mvaa 220,212,180
wl 5
buffer_load_dwordx4 v237, s[52:55], s76 offen offset:2048 nt lds
mvaa 208,216,184
s_add_u32 s76, s76, 0x3000
ex 202
mvaa 216,216,188
wl 4
cv 200,200
ex 203
mvaa 212,220,184
s_cmp_le_u32 s83, 1
s_cbranch_scc1 L_k1_tw_u87
L_k1_hb_u88:
s_waitcnt vmcnt(9) lgkmcnt(0)
mvaa 220,220,188
s_barrier
mvaa 208,224,192
tra 208,247,49664
ex 204
mvaa 216,224,196
tra 210,247,50432
cv 201,202
mvaa 212,228,192
tra 212,247,49696
ex 205
mvaa 220,228,196
tra 214,247,50464
ex 206
mvaa 208,232,200
tra 216,247,49728
cv 202,204
ex 207
mvaa 216,232,204
tra 218,247,50496
cv 203,206
mvaa 212,236,200
tra 220,247,49760
tra 222,247,50528
mvaa 220,236,204
s_add_u32 m0, s73, 0x6100
tra 224,247,49792
buffer_load_dwordx4 v232, s[48:51], s75 offen nt lds
maav 240,248,192
tra 226,247,50560
maav 244,248,200
wl 8
tra 228,247,49824
mvav 0,208,192
tra 230,247,50592
mvav 8,208,200
wl 8
tra 232,247,49856
mvav 4,212,192
buffer_load_dwordx4 v233, s[48:51], s75 offen offset:1024 nt lds
mvav 12,212,200
wl 7
tra 234,247,50624
v_max3_f32 v251, v208, v209, v210
mvav 16,216,192
tra 236,247,49888
mvav 24,216,200
wl 7
tra 238,247,50656
v_max3_f32 v251, v251, v211, v212
mvav 20,220,192
tra 208,247,49920
mvav 28,220,200
wl 7
tra 210,247,50688
v_max3_f32 v251, v251, v213, v214
mvav 32,224,192
tra 212,247,49952
mvav 40,224,200
wl 7
tra 214,247,50720
v_max3_f32 v251, v251, v215, v216
mvav 36,228,192
buffer_load_dwordx4 v234, s[48:51], s75 offen offset:2048 nt lds
mvav 44,228,200
wl 6
s_add_u32 s75, s75, 0x3000
tra 216,247,49984
mvav 48,232,192
tra 218,247,50752
v_max3_f32 v251, v251, v217, v218
mvav 56,232,200
wl 6
tra 220,247,50016
mvav 52,236,192
tra 222,247,50784
v_max3_f32 v251, v251, v219, v220
mvav 60,236,200
wl 6
rqa 224,243,0
mvav 64,208,192
rqa 228,243,1536
v_max3_f32 v251, v251, v221, v222
mvav 72,208,200
wl 6
rqa 232,244,0
v_max_f32 v251, v251, v223
mvav 68,212,192
rqa 236,244,1536
v_cmp_lt_f32 vcc, s43, v251
mvav 76,212,200
wl 6
s_add_u32 m0, s74, 0x9180
rqa 208,243,128
mvav 80,216,192
buffer_load_dwordx4 v235, s[52:55], s76 offen nt lds
mvav 88,216,200
wl 5
rqa 212,243,1664
mvav 84,220,192
wl 5
rqa 216,244,128
mvav 92,220,200
s_cbranch_vccnz L_k1_rr_u90
L_k1_rb_u91:
cvaa 192,224,160,224
ex 208
cvaa 200,224,164,228
wl 5
rqa 220,244,1664
cvaa 196,228,160,224
buffer_load_dwordx4 v236, s[52:55], s76 offen offset:1024 nt lds
cvaa 204,228,164,228
wl 5
rqa 224,243,256
mvaa 192,232,168
ex 209
mvaa 200,232,172
wl 5
rqa 228,243,1792
mvaa 196,236,168
ex 210
mvaa 204,236,172
wl 5
rqa 232,244,256
mvaa 192,208,176
rqa 236,244,1792
cv 208,208
mvaa 200,208,180
wl 6
ex 211
mvaa 196,212,176
ex 212
mvaa 204,212,180
wl 5
buffer_load_dwordx4 v237, s[52:55], s76 offen offset:2048 nt lds
mvaa 192,216,184
wl 4
s_add_u32 s76, s76, 0x3000
s_add_u32 s77, s77, 0x180
mvaa 200,216,188
s_cmp_eq_u32 s83, 2
s_cbranch_scc1 L_k1_hk_u92
L_k1_hb_u93:
mvaa 196,220,184
s_cmp_le_u32 s83, 1
s_cbranch_scc1 L_k1_tw_u94
L_k1_hb_u95:
s_waitcnt vmcnt(9) lgkmcnt(0)
mvaa 204,220,188
s_barrier
mvaa 192,224,192
tra 208,248,12416
tra 210,248,13184
mvaa 200,224,196
tra 212,248,12448
tra 214,248,13216
mvaa 196,228,192
tra 216,248,12480
tra 218,248,13248
mvaa 204,228,196
tra 220,248,12512
tra 222,248,13280
mvaa 192,232,200
s_add_u32 m0, s74, 0xc200
tra 224,248,12544
buffer_load_dwordx4 v238, s[56:59], s77 offen lds
mvaa 200,232,204
tra 226,248,13312
cv 209,210
mvaa 196,236,200
tra 228,248,12576
ex 213
mvaa 204,236,204
wl 9
tra 230,248,13344
tra 232,248,12608
mvaa 96,208,144
tra 234,248,13376
tra 236,248,12640
mvaa 104,208,148
wl 11
tra 238,248,13408
ex 214
mvaa 100,212,144
tra 208,248,12672
tra 210,248,13440
mvaa 108,212,148
wl 12
tra 212,248,12704
cv 210,212
mvaa 112,216,144
tra 214,248,13472
buffer_load_dwordx4 v239, s[56:59], s77 offen offset:1024 lds
mvaa 120,216,148
wl 12
tra 216,248,12736
mvaa 116,220,144
tra 218,248,13504
mvaa 124,220,148
wl 12
tra 220,248,12768
ex 215
mvaa 128,224,144
tra 222,248,13536
mvaa 136,224,148
wl 12
tra 224,248,24832
tra 226,248,25600
mvaa 132,228,144
ex 216
mvaa 140,228,148
wl 12
tra 228,248,24864
cv 211,214
mvaa 144,232,144
tra 230,248,25632
buffer_load_dwordx4 v240, s[56:59], s77 offen offset:2048 lds
mvaa 152,232,148
wl 12
s_add_u32 s77, s77, s80
tra 232,248,24896
mvaa 148,236,144
tra 234,248,25664
mvaa 156,236,148
wl 12
tra 236,248,24928
ex 217
mvaa 160,208,144
tra 238,248,25696
mvaa 168,208,148
wl 12
tra 208,248,24960
tra 210,248,25728
mvaa 164,212,144
s_add_u32 m0, s73, 0xf280
ex 218
mvaa 172,212,148
wl 12
tra 212,248,24992
buffer_load_dwordx4 v232, s[48:51], s75 offen nt lds
mvaa 176,216,144
tra 214,248,25760
mvaa 184,216,148
wl 12
tra 216,248,25024
cv 216,216
mvaa 180,220,144
tra 218,248,25792
mvaa 188,220,148
wl 12
tra 220,248,25056
mvaa 96,224,152
ex 219
mvaa 104,224,156
wl 11
tra 222,248,25824
mvaa 100,228,152
tra 224,248,25088
mvaa 108,228,156
wl 11
buffer_load_dwordx4 v233, s[48:51], s75 offen offset:1024 nt lds
mvaa 112,232,152
ex 220
mvaa 120,232,156
wl 9
tra 226,248,25856
mvaa 116,236,152
tra 228,248,25120
cv 217,218
mvaa 124,236,156
wl 9
ex 221
mvaa 128,208,152
tra 230,248,25888
tra 232,248,25152
tra 234,248,25920
v_pk_mul_f32 v[96:97], v[96:97], s[26:27]
v_pk_mul_f32 v[98:99], v[98:99], s[26:27]
v_pk_mul_f32 v[100:101], v[100:101], s[26:27]
v_pk_mul_f32 v[102:103], v[102:103], s[26:27]
v_pk_mul_f32 v[104:105], v[104:105], s[26:27]
v_pk_mul_f32 v[106:107], v[106:107], s[26:27]
v_pk_mul_f32 v[108:109], v[108:109], s[26:27]
v_pk_mul_f32 v[110:111], v[110:111], s[26:27]
mvaa 136,208,156
wl 10
tra 236,248,25184
cv 96,96
mvaa 132,212,152
tra 238,248,25952
cv 97,98
mvaa 140,212,156
wl 10
ex 222
cv 98,100
mvaa 144,216,152
buffer_load_dwordx4 v234, s[48:51], s75 offen offset:2048 nt lds
cv 99,102
mvaa 152,216,156
wl 8
s_add_u32 s75, s75, 0x3000
cv 104,104
mvaa 148,220,152
s_cmp_le_u32 s83, 1
s_cbranch_scc1 L_k1_tw_u97
L_k1_hb_u98:
s_waitcnt vmcnt(9) lgkmcnt(0)
mvaa 156,220,156
s_barrier
mvaa 160,224,152
tra 208,247,12416
cv 218,220
mvaa 168,224,156
tra 210,247,13184
cv 105,106
mvaa 164,228,152
tra 212,247,12448
ex 223
mvaa 172,228,156
tra 214,247,13216
cv 106,108
mvaa 176,232,152
s_add_u32 m0, s74, 0x12300
tra 216,247,12480
buffer_load_dwordx4 v238, s[56:59], s77 offen lds
mvaa 184,232,156
tra 218,247,13248
cv 219,222
mvaa 180,236,152
tra 220,247,12512
cv 107,110
mvaa 188,236,156
tra 222,247,13280
v_permlane32_swap_b32 v96, v98
v_permlane32_swap_b32 v97, v99
v_pk_mul_f32 v[112:113], v[112:113], s[26:27]
v_pk_mul_f32 v[114:115], v[114:115], s[26:27]
v_pk_mul_f32 v[116:117], v[116:117], s[26:27]
v_pk_mul_f32 v[118:119], v[118:119], s[26:27]
v_pk_mul_f32 v[120:121], v[120:121], s[26:27]
v_pk_mul_f32 v[122:123], v[122:123], s[26:27]
v_pk_mul_f32 v[124:125], v[124:125], s[26:27]
v_pk_mul_f32 v[126:127], v[126:127], s[26:27]
maav 240,248,208
tra 224,247,12544
v_permlane32_swap_b32 v104, v106
maav 244,248,216
wl 7
tra 226,247,13312
v_permlane32_swap_b32 v105, v107
mvav 0,208,208
tra 228,247,12576
cv 112,112
mvav 8,208,216
wl 7
tra 230,247,13344
cv 113,114
mvav 4,212,208
tra 232,247,12608
buffer_load_dwordx4 v239, s[56:59], s77 offen offset:1024 lds
mvav 12,212,216
wl 7
tra 234,247,13376
v_max3_f32 v251, v192, v193, v194
mvav 16,216,208
tra 236,247,12640
cv 114,116
mvav 24,216,216
wl 7
tra 238,247,13408
v_max3_f32 v251, v251, v195, v196
mvav 20,220,208
tra 208,247,12672
cv 115,118
mvav 28,220,216
wl 7
tra 210,247,13440
v_max3_f32 v251, v251, v197, v198
mvav 32,224,208
tra 212,247,12704
cv 120,120
mvav 40,224,216
wl 7
tra 214,247,13472
v_max3_f32 v251, v251, v199, v200
cv 121,122
mvav 36,228,208
wl 6
tra 216,247,12736
buffer_load_dwordx4 v240, s[56:59], s77 offen offset:2048 lds
cv 122,124
mvav 44,228,216
s_add_u32 s77, s77, s16
tra 218,247,13504
cv 123,126
mvav 48,232,208
s_sub_u32 s23, s77, s79
s_min_u32 s77, s77, s23
tra 220,247,12768
mvav 56,232,216
wl 7
tra 222,247,13536
v_max3_f32 v251, v251, v201, v202
mvav 52,236,208
rqa 224,241,24832
v_max3_f32 v251, v251, v203, v204
mvav 60,236,216
wl 7
rqa 228,241,26368
v_permlane32_swap_b32 v112, v114
v_permlane32_swap_b32 v113, v115
v_pk_mul_f32 v[128:129], v[128:129], s[26:27]
v_pk_mul_f32 v[130:131], v[130:131], s[26:27]
v_pk_mul_f32 v[132:133], v[132:133], s[26:27]
v_pk_mul_f32 v[134:135], v[134:135], s[26:27]
v_pk_mul_f32 v[136:137], v[136:137], s[26:27]
v_pk_mul_f32 v[138:139], v[138:139], s[26:27]
v_pk_mul_f32 v[140:141], v[140:141], s[26:27]
v_pk_mul_f32 v[142:143], v[142:143], s[26:27]
mvav 64,208,208
rqa 232,242,24832
v_max3_f32 v251, v251, v205, v206
mvav 72,208,216
wl 7
rqa 236,242,26368
v_max_f32 v251, v251, v207
mvav 68,212,208
rqa 208,241,24960
v_cmp_lt_f32 vcc, s43, v251
mvav 76,212,216
wl 7
s_add_u32 m0, s74, 0x15380
rqa 212,241,26496
mvav 80,216,208
buffer_load_dwordx4 v235, s[52:55], s76 offen nt lds
mvav 88,216,216
wl 6
rqa 216,242,24960
v_permlane32_swap_b32 v120, v122
mvav 84,220,208
wl 6
v_permlane32_swap_b32 v121, v123
mvav 92,220,216
s_cbranch_vccnz L_k1_rr_u100
L_k1_rb_u101:
rqa 220,242,26496
cvaa 208,224,160,224
ex 192
cv 128,128
cvaa 216,224,164,228
wl 6
rqa 224,241,25088
ex 193
cv 129,130
cvaa 212,228,160,224
ex 194
cv 130,132
cvaa 220,228,164,228
wl 6
rqa 228,241,26624
buffer_load_dwordx4 v236, s[52:55], s76 offen offset:1024 nt lds
cv 192,192
cv 131,134
mvaa 208,232,168
ex 195
cv 136,136
v_accvgpr_write_b32 a160, v96
v_accvgpr_write_b32 a161, v97
v_accvgpr_write_b32 a162, v98
v_accvgpr_write_b32 a163, v99
v_accvgpr_write_b32 a164, v104
v_accvgpr_write_b32 a165, v105
v_accvgpr_write_b32 a166, v106
v_accvgpr_write_b32 a167, v107
mvaa 216,232,172
wl 6
rqa 232,242,25088
ex 196
cv 137,138
mvaa 212,236,168
cv 193,194
cv 138,140
mvaa 220,236,172
wl 6
rqa 236,242,26624
ex 197
cv 139,142
mvaa 208,208,176
ex 198
v_permlane32_swap_b32 v128, v130
v_accvgpr_write_b32 a168, v112
v_accvgpr_write_b32 a169, v113
v_accvgpr_write_b32 a170, v114
v_accvgpr_write_b32 a171, v115
v_accvgpr_write_b32 a172, v120
v_accvgpr_write_b32 a173, v121
v_accvgpr_write_b32 a174, v122
v_accvgpr_write_b32 a175, v123
mvaa 216,208,180
wl 6
cv 194,196
ex 199
mvaa 212,212,176
v_permlane32_swap_b32 v129, v131
mvaa 220,212,180
wl 5
buffer_load_dwordx4 v237, s[52:55], s76 offen offset:2048 nt lds
ex 200
cv 195,198
v_pk_mul_f32 v[144:145], v[144:145], s[26:27]
v_pk_mul_f32 v[146:147], v[146:147], s[26:27]
mvaa 208,216,184
s_add_u32 s76, s76, 0x3000
ex 201
v_pk_mul_f32 v[148:149], v[148:149], s[26:27]
v_accvgpr_write_b32 a176, v128
v_accvgpr_write_b32 a177, v129
v_accvgpr_write_b32 a178, v130
v_accvgpr_write_b32 a179, v131
mvaa 216,216,188
wl 4
ex 202
mvaa 212,220,184
s_cmp_le_u32 s83, 1
s_cbranch_scc1 L_k1_tw_u102
L_k1_hb_u103:
s_waitcnt vmcnt(9) lgkmcnt(0)
cv 200,200
v_pk_mul_f32 v[150:151], v[150:151], s[26:27]
mvaa 220,220,188
s_barrier
ex 203
v_pk_mul_f32 v[152:153], v[152:153], s[26:27]
mvaa 208,224,192
tra 208,247,37248
tra 210,247,38016
ex 204
v_pk_mul_f32 v[154:155], v[154:155], s[26:27]
v_pk_mul_f32 v[156:157], v[156:157], s[26:27]
v_pk_mul_f32 v[158:159], v[158:159], s[26:27]
mvaa 216,224,196
tra 212,247,37280
cv 201,202
mvaa 212,228,192
tra 214,247,38048
ex 205
mvaa 220,228,196
tra 216,247,37312
ex 206
v_permlane32_swap_b32 v136, v138
mvaa 208,232,200
s_add_u32 m0, s73, 0
tra 218,247,38080
buffer_load_dwordx4 v232, s[48:51], s75 offen nt lds
cv 202,204
ex 207
v_permlane32_swap_b32 v137, v139
mvaa 216,232,204
tra 220,247,37344
cv 203,206
cv 144,144
v_accvgpr_write_b32 a180, v136
v_accvgpr_write_b32 a181, v137
v_accvgpr_write_b32 a182, v138
v_accvgpr_write_b32 a183, v139
mvaa 212,236,200
tra 222,247,38112
cv 145,146
mvaa 220,236,204
tra 224,247,37376
cv 146,148
maav 240,248,192
tra 226,247,38144
cv 147,150
maav 244,248,200
wl 8
tra 228,247,37408
cv 152,152
mvav 0,208,192
tra 230,247,38176
cv 153,154
mvav 8,208,200
wl 8
tra 232,247,37440
cv 154,156
mvav 4,212,192
tra 234,247,38208
buffer_load_dwordx4 v233, s[48:51], s75 offen offset:1024 nt lds
cv 155,158
mvav 12,212,200
wl 8
tra 236,247,37472
v_max3_f32 v251, v208, v209, v210
mvav 16,216,192
tra 238,247,38240
v_permlane32_swap_b32 v144, v146
mvav 24,216,200
wl 8
tra 208,247,37504
v_max3_f32 v251, v251, v211, v212
mvav 20,220,192
tra 210,247,38272
v_permlane32_swap_b32 v145, v147
mvav 28,220,200
wl 8
tra 212,247,37536
tra 214,247,38304
tra 216,247,37568
v_max3_f32 v251, v251, v213, v214
v_pk_mul_f32 v[160:161], v[160:161], s[26:27]
v_pk_mul_f32 v[162:163], v[162:163], s[26:27]
v_pk_mul_f32 v[164:165], v[164:165], s[26:27]
v_pk_mul_f32 v[166:167], v[166:167], s[26:27]
v_pk_mul_f32 v[168:169], v[168:169], s[26:27]
v_pk_mul_f32 v[170:171], v[170:171], s[26:27]
v_pk_mul_f32 v[172:173], v[172:173], s[26:27]
v_pk_mul_f32 v[174:175], v[174:175], s[26:27]
v_accvgpr_write_b32 a184, v144
v_accvgpr_write_b32 a185, v145
v_accvgpr_write_b32 a186, v146
v_accvgpr_write_b32 a187, v147
mvav 32,224,192
tra 218,247,38336
v_permlane32_swap_b32 v152, v154
mvav 40,224,200
wl 10
tra 220,247,37600
v_max3_f32 v251, v251, v215, v216
mvav 36,228,192
tra 222,247,38368
buffer_load_dwordx4 v234, s[48:51], s75 offen offset:2048 nt lds
mvav 44,228,200
wl 10
s_add_u32 s75, s75, 0x3000
tra 224,247,49664
mvav 48,232,192
tra 226,247,50432
v_max3_f32 v251, v251, v217, v218
mvav 56,232,200
wl 10
tra 228,247,49696
v_permlane32_swap_b32 v153, v155
mvav 52,236,192
tra 230,247,50464
v_max3_f32 v251, v251, v219, v220
v_accvgpr_write_b32 a188, v152
v_accvgpr_write_b32 a189, v153
v_accvgpr_write_b32 a190, v154
v_accvgpr_write_b32 a191, v155
mvav 60,236,200
wl 10
tra 232,247,49728
cv 160,160
mvav 64,208,192
tra 234,247,50496
v_max3_f32 v251, v251, v221, v222
cv 161,162
mvav 72,208,200
wl 10
tra 236,247,49760
cv 162,164
mvav 68,212,192
s_add_u32 m0, s74, 0x3080
tra 238,247,50528
v_max_f32 v251, v251, v223
mvav 76,212,200
wl 10
tra 208,247,49792
buffer_load_dwordx4 v238, s[56:59], s77 offen lds
cv 163,166
mvav 80,216,192
tra 210,247,50560
v_cmp_lt_f32 vcc, s43, v251
cv 168,168
mvav 88,216,200
wl 10
tra 212,247,49824
cv 169,170
mvav 84,220,192
wl 9
tra 214,247,50592
cv 170,172
mvav 92,220,200
s_cbranch_vccnz L_k1_rr_u105
L_k1_rb_u106:
tra 216,247,49856
zvaa 96,224,0
tra 218,247,50624
cv 171,174
zvaa 104,224,4
wl 10
tra 220,247,49888
ex 208
zvaa 100,228,0
tra 222,247,50656
v_permlane32_swap_b32 v160, v162
zvaa 108,228,4
wl 10
tra 224,247,49920
buffer_load_dwordx4 v239, s[56:59], s77 offen offset:1024 lds
zvaa 112,232,0
tra 226,247,50688
v_permlane32_swap_b32 v161, v163
zvaa 120,232,4
wl 10
tra 228,247,49952
tra 230,247,50720
tra 232,247,49984
v_pk_mul_f32 v[176:177], v[176:177], s[26:27]
v_pk_mul_f32 v[178:179], v[178:179], s[26:27]
v_pk_mul_f32 v[180:181], v[180:181], s[26:27]
v_pk_mul_f32 v[182:183], v[182:183], s[26:27]
v_pk_mul_f32 v[184:185], v[184:185], s[26:27]
v_pk_mul_f32 v[186:187], v[186:187], s[26:27]
v_pk_mul_f32 v[188:189], v[188:189], s[26:27]
v_pk_mul_f32 v[190:191], v[190:191], s[26:27]
v_accvgpr_write_b32 a192, v160
v_accvgpr_write_b32 a193, v161
v_accvgpr_write_b32 a194, v162
zvaa 116,236,0
tra 234,247,50752
v_permlane32_swap_b32 v168, v170
zvaa 124,236,4
wl 12
tra 236,247,50016
v_accvgpr_write_b32 a195, v163
zvaa 128,208,0
tra 238,247,50784
v_permlane32_swap_b32 v169, v171
zvaa 136,208,4
wl 12
v_accvgpr_write_b32 a196, v168
v_accvgpr_write_b32 a197, v169
v_accvgpr_write_b32 a198, v170
v_accvgpr_write_b32 a199, v171
zvaa 132,212,0
ex 209
zvaa 140,212,4
wl 10
buffer_load_dwordx4 v240, s[56:59], s77 offen offset:2048 lds
cv 176,176
cv 177,178
cv 178,180
cv 179,182
cv 184,184
cv 185,186
cv 186,188
cv 187,190
v_permlane32_swap_b32 v176, v178
v_permlane32_swap_b32 v177, v179
zvaa 144,216,0
wl 8
v_accvgpr_write_b32 a200, v176
v_accvgpr_write_b32 a201, v177
v_accvgpr_write_b32 a202, v178
v_accvgpr_write_b32 a203, v179
zvaa 152,216,4
s_add_u32 s77, s77, s80
v_permlane32_swap_b32 v184, v186
v_permlane32_swap_b32 v185, v187
zvaa 148,220,0
s_cmp_le_u32 s83, 1
s_cbranch_scc1 L_k1_tw_u107
L_k1_hb_u108:
s_waitcnt vmcnt(9) lgkmcnt(0)
zvaa 156,220,4
s_barrier
v_accvgpr_write_b32 a204, v184
zvaa 160,224,0
rqa 208,243,0
ex 210
zvaa 168,224,4
rqa 212,243,1536
v_accvgpr_write_b32 a205, v185
v_accvgpr_write_b32 a206, v186
v_accvgpr_write_b32 a207, v187
zvaa 164,228,0
rqa 216,244,0
cv 208,208
zvaa 172,228,4
rqa 220,244,1536
ex 211
zvaa 176,232,0
rqa 224,243,128
ex 212
zvaa 184,232,4
rqa 228,243,1664
cv 209,210
zvaa 180,236,0
rqa 232,244,128
ex 213
zvaa 188,236,4
wl 6
s_add_u32 m0, s74, 0x6100
rqa 236,244,1664
zvaa 192,208,160
buffer_load_dwordx4 v238, s[56:59], s77 offen lds
zvaa 200,208,164
wl 6
rqa 208,243,256
zvaa 196,212,160
ex 214
zvaa 204,212,164
wl 6
rqa 212,243,1792
cv 210,212
mvaa 192,216,168
buffer_load_dwordx4 v239, s[56:59], s77 offen offset:1024 lds
mvaa 200,216,172
wl 6
rqa 216,244,256
mvaa 196,220,168
ex 215
mvaa 204,220,172
wl 6
rqa 220,244,1792
mvaa 192,224,176
buffer_load_dwordx4 v240, s[56:59], s77 offen offset:2048 lds
mvaa 200,224,180
wl 6
s_add_u32 s77, s77, s18
tra 224,248,12416
mvaa 196,228,176
s_sub_u32 s23, s77, s79
s_min_u32 s77, s77, s23
tra 226,248,13184
mvaa 204,228,180
wl 7
tra 228,248,12448
ex 216
mvaa 192,232,184
tra 230,248,13216
cv 211,214
mvaa 200,232,188
wl 8
tra 232,248,12480
mvaa 196,236,184
tra 234,248,13248
mvaa 204,236,188
wl 9
tra 236,248,12512
ex 217
mvaa 192,208,192
tra 238,248,13280
mvaa 200,208,196
wl 10
tra 208,248,12544
tra 210,248,13312
mvaa 196,212,192
s_add_u32 m0, s74, 0x9180
ex 218
mvaa 204,212,196
wl 11
tra 212,248,12576
buffer_load_dwordx4 v235, s[52:55], s76 offen nt lds
mvaa 192,216,200
tra 214,248,13344
mvaa 200,216,204
wl 12
tra 216,248,12608
cv 216,216
mvaa 196,220,200
tra 218,248,13376
mvaa 204,220,204
wl 12
tra 220,248,12640
tra 222,248,13408
mvaa 96,224,8
ex 219
mvaa 104,224,12
wl 12
tra 224,248,12672
tra 226,248,13440
mvaa 100,228,8
buffer_load_dwordx4 v236, s[52:55], s76 offen offset:1024 nt lds
mvaa 108,228,12
wl 12
tra 228,248,12704
ex 220
mvaa 112,232,8
tra 230,248,13472
v_max3_f32 v252, v192, v193, v194
mvaa 120,232,12
wl 12
tra 232,248,12736
v_max3_f32 v253, v200, v201, v202
mvaa 116,236,8
tra 234,248,13504
cv 217,218
mvaa 124,236,12
wl 12
tra 236,248,12768
v_max3_f32 v252, v252, v195, v196
mvaa 128,208,8
tra 238,248,13536
v_max3_f32 v253, v253, v203, v204
mvaa 136,208,12
wl 12
ex 221
v_max3_f32 v252, v252, v197, v198
mvaa 132,212,8
ex 222
mvaa 140,212,12
wl 10
v_max3_f32 v253, v253, v205, v206
v_max_f32 v252, v252, v199
mvaa 144,216,8
buffer_load_dwordx4 v237, s[52:55], s76 offen offset:2048 nt lds
mvaa 152,216,12
wl 8
s_add_u32 s76, s76, 0x3000
v_max_f32 v253, v253, v207
mvaa 148,220,8
s_cmp_le_u32 s83, 1
s_cbranch_scc1 L_k1_tw_u110
L_k1_hb_u111:
s_waitcnt vmcnt(9) lgkmcnt(0)
mvaa 156,220,12
s_barrier
v_permlane32_swap_b32 v252, v253
v_max_f32 v252, v252, v253
mvaa 160,224,8
tra 208,248,24832
cv 218,220
mvaa 168,224,12
tra 210,248,25600
v_mov_b32 v253, v252
mvaa 164,228,8
tra 212,248,24864
ex 223
mvaa 172,228,12
tra 214,248,25632
v_permlane16_swap_b32 v252, v253
v_max_f32 v252, v252, v253
mvaa 176,232,8
s_add_u32 m0, s73, 0xc200
tra 216,248,24896
buffer_load_dwordx4 v232, s[48:51], s75 offen nt lds
v_mov_b32 v253, v252
mvaa 184,232,12
tra 218,248,25664
cv 219,222
mvaa 180,236,8
tra 220,248,24928
v_permlane32_swap_b32 v252, v253
mvaa 188,236,12
tra 222,248,25696
v_sub_f32 v224, 0, v252
maav 240,248,208
tra 224,248,24960
v_sub_f32 v225, 0, v252
maav 244,248,216
wl 7
tra 226,248,25728
v_sub_f32 v228, 0, v253
mvav 0,208,208
tra 228,248,24992
v_sub_f32 v229, 0, v253
mvav 8,208,216
wl 7
tra 230,248,25760
v_mov_b64 v[226:227], v[224:225]
mvav 4,212,208
tra 232,248,25024
buffer_load_dwordx4 v233, s[48:51], s75 offen offset:1024 nt lds
v_mov_b64 v[230:231], v[228:229]
mvav 12,212,216
wl 7
tra 234,248,25792
v_sub_f32 v192, v192, v252
mvav 16,216,208
tra 236,248,25056
v_accvgpr_read_b32 v254, a240
mvav 24,216,216
wl 7
tra 238,248,25824
v_sub_f32 v193, v193, v252
v_accvgpr_read_b32 v255, a244
mvav 20,220,208
tra 208,248,25088
v_sub_f32 v194, v194, v252
v_rcp_f32 v254, v254
v_rcp_f32 v255, v255
mvav 28,220,216
wl 7
tra 210,248,25856
v_sub_f32 v195, v195, v252
mvav 32,224,208
tra 212,248,25120
v_sub_f32 v196, v196, v252
v_mul_f32 v0, v0, v254
v_mul_f32 v1, v1, v254
v_mul_f32 v2, v2, v254
mvav 40,224,216
wl 7
tra 214,248,25888
v_mul_f32 v3, v3, v254
v_mul_f32 v4, v4, v254
mvav 36,228,208
wl 6
tra 216,248,25152
buffer_load_dwordx4 v234, s[48:51], s75 offen offset:2048 nt lds
v_sub_f32 v197, v197, v252
v_mul_f32 v5, v5, v254
v_mul_f32 v6, v6, v254
mvav 44,228,216
s_add_u32 s75, s75, 0x3000
tra 218,248,25920
v_sub_f32 v198, v198, v252
v_mul_f32 v7, v7, v254
mvav 48,232,208
tra 220,248,25184
v_sub_f32 v199, v199, v252
v_mul_f32 v8, v8, v255
v_mul_f32 v9, v9, v255
mvav 56,232,216
wl 7
tra 222,248,25952
v_sub_f32 v200, v200, v253
v_mul_f32 v10, v10, v255
v_mul_f32 v11, v11, v255
mvav 52,236,208
rqa 224,241,0
v_sub_f32 v201, v201, v253
v_mul_f32 v12, v12, v255
mvav 60,236,216
wl 7
rqa 228,241,1536
v_sub_f32 v202, v202, v253
v_mul_f32 v13, v13, v255
v_mul_f32 v14, v14, v255
mvav 64,208,208
rqa 232,242,0
v_mul_f32 v15, v15, v255
cv 0,0
mvav 72,208,216
wl 7
rqa 236,242,1536
v_sub_f32 v203, v203, v253
cv 1,2
mvav 68,212,208
wl 6
rqa 208,241,128
v_sub_f32 v204, v204, v253
cv 2,4
cv 3,6
mvav 76,212,216
s_add_u32 m0, s74, 0xf280
rqa 212,241,1664
buffer_load_dwordx4 v235, s[52:55], s76 offen nt lds
v_sub_f32 v205, v205, v253
cv 8,8
mvav 80,216,208
v_sub_f32 v206, v206, v253
cv 9,10
cv 10,12
mvav 88,216,216
wl 6
rqa 216,242,128
v_sub_f32 v207, v207, v253
cv 11,14
v_mul_f32 v16, v16, v254
mvav 84,220,208
v_mul_f32 v17, v17, v254
v_mul_f32 v18, v18, v254
mvav 92,220,216
wl 6
rqa 220,242,1664
v_mul_f32 v19, v19, v254
cvaa 208,224,160,224
v_mul_f32 v20, v20, v254
v_mul_f32 v21, v21, v254
cvaa 216,224,164,228
wl 6
rqa 224,241,256
ex 192
v_mul_f32 v22, v22, v254
cvaa 212,228,160,224
v_mul_f32 v23, v23, v254
v_mul_f32 v24, v24, v255
cvaa 220,228,164,228
wl 6
rqa 228,241,1792
buffer_load_dwordx4 v236, s[52:55], s76 offen offset:1024 nt lds
v_mul_f32 v25, v25, v255
v_mul_f32 v26, v26, v255
mvaa 208,232,168
ex 193
v_mul_f32 v27, v27, v255
mvaa 216,232,172
wl 6
rqa 232,242,256
v_mul_f32 v28, v28, v255
v_mul_f32 v29, v29, v255
mvaa 212,236,168
v_mul_f32 v30, v30, v255
v_mul_f32 v31, v31, v255
mvaa 220,236,172
wl 6
rqa 236,242,1792
ex 194
cv 16,16
mvaa 208,208,176
cv 17,18
cv 18,20
mvaa 216,208,180
wl 6
cv 19,22
cv 24,24
mvaa 212,212,176
cv 192,192
cv 25,26
mvaa 220,212,180
wl 5
buffer_load_dwordx4 v237, s[52:55], s76 offen offset:2048 nt lds
cv 26,28
cv 27,30
mvaa 208,216,184
s_add_u32 s76, s76, 0x3000
ex 195
v_mul_f32 v32, v32, v254
mvaa 216,216,188
wl 4
v_mul_f32 v33, v33, v254
v_mul_f32 v34, v34, v254
mvaa 212,220,184
s_cmp_le_u32 s83, 1
s_cbranch_scc1 L_k1_tw_u113
L_k1_hb_u114:
s_waitcnt vmcnt(9) lgkmcnt(0)
v_mul_f32 v35, v35, v254
v_mul_f32 v36, v36, v254
mvaa 220,220,188
s_barrier
v_mul_f32 v37, v37, v254
mvaa 208,224,192
tra 208,247,12416
tra 210,247,13184
tra 212,247,12448
tra 214,247,13216
tra 216,247,12480
ex 196
v_mul_f32 v38, v38, v254
v_mul_f32 v39, v39, v254
mvaa 216,224,196
tra 218,247,13248
v_mul_f32 v40, v40, v255
v_mul_f32 v41, v41, v255
mvaa 212,228,192
tra 220,247,12512
v_mul_f32 v42, v42, v255
mvaa 220,228,196
tra 222,247,13280
cv 193,194
v_mul_f32 v43, v43, v255
v_mul_f32 v44, v44, v255
mvaa 208,232,200
s_add_u32 m0, s73, 0x15380
tra 224,247,12544
buffer_load_dwordx4 v232, s[48:51], s75 offen nt lds
v_mul_f32 v45, v45, v255
v_mul_f32 v46, v46, v255
mvaa 216,232,204
tra 226,247,13312
v_mul_f32 v47, v47, v255
mvaa 212,236,200
tra 228,247,12576
ex 197
cv 32,32
cv 33,34
mvaa 220,236,204
wl 9
tra 230,247,13344
cv 34,36
cv 35,38
mvaa 96,208,16
tra 232,247,12608
cv 40,40
mvaa 104,208,20
wl 9
tra 234,247,13376
ex 198
cv 41,42
cv 42,44
mvaa 100,212,16
tra 236,247,12640
cv 43,46
mvaa 108,212,20
wl 9
tra 238,247,13408
v_mul_f32 v48, v48, v254
v_mul_f32 v49, v49, v254
mvaa 112,216,16
tra 208,247,12672
buffer_load_dwordx4 v233, s[48:51], s75 offen offset:1024 nt lds
cv 194,196
v_mul_f32 v50, v50, v254
v_mul_f32 v51, v51, v254
mvaa 120,216,20
wl 9
tra 210,247,13440
v_mul_f32 v52, v52, v254
mvaa 116,220,16
tra 212,247,12704
v_mul_f32 v53, v53, v254
v_mul_f32 v54, v54, v254
mvaa 124,220,20
wl 9
tra 214,247,13472
ex 199
v_mul_f32 v55, v55, v254
v_mul_f32 v56, v56, v255
mvaa 128,224,16
tra 216,247,12736
v_mul_f32 v57, v57, v255
mvaa 136,224,20
wl 9
tra 218,247,13504
v_mul_f32 v58, v58, v255
v_mul_f32 v59, v59, v255
mvaa 132,228,16
tra 220,247,12768
ex 200
v_mul_f32 v60, v60, v255
v_mul_f32 v61, v61, v255
mvaa 140,228,20
wl 9
tra 222,247,13536
v_mul_f32 v62, v62, v255
mvaa 144,232,16
wl 8
tra 224,247,24832
buffer_load_dwordx4 v234, s[48:51], s75 offen offset:2048 nt lds
cv 195,198
v_mul_f32 v63, v63, v255
cv 48,48
mvaa 152,232,20
s_add_u32 s75, s75, 0x3000
tra 226,247,25600
cv 49,50
cv 50,52
mvaa 148,236,16
tra 228,247,24864
cv 51,54
mvaa 156,236,20
wl 9
tra 230,247,25632
ex 201
cv 56,56
cv 57,58
mvaa 160,208,16
tra 232,247,24896
cv 58,60
mvaa 168,208,20
wl 9
tra 234,247,25664
cv 59,62
v_mul_f32 v64, v64, v254
mvaa 164,212,16
s_add_u32 m0, s74, 0
tra 236,247,24928
ex 202
v_mul_f32 v65, v65, v254
v_mul_f32 v66, v66, v254
mvaa 172,212,20
wl 9
tra 238,247,25696
buffer_load_dwordx4 v238, s[56:59], s77 offen lds
v_mul_f32 v67, v67, v254
mvaa 176,216,16
tra 208,247,24960
v_mul_f32 v68, v68, v254
v_mul_f32 v69, v69, v254
mvaa 184,216,20
wl 9
tra 210,247,25728
cv 200,200
v_mul_f32 v70, v70, v254
v_mul_f32 v71, v71, v254
mvaa 180,220,16
tra 212,247,24992
v_mul_f32 v72, v72, v255
mvaa 188,220,20
wl 9
tra 214,247,25760
v_mul_f32 v73, v73, v255
v_mul_f32 v74, v74, v255
mvaa 96,224,24
tra 216,247,25024
ex 203
v_mul_f32 v75, v75, v255
v_mul_f32 v76, v76, v255
mvaa 104,224,28
wl 9
tra 218,247,25792
v_mul_f32 v77, v77, v255
mvaa 100,228,24
tra 220,247,25056
v_mul_f32 v78, v78, v255
v_mul_f32 v79, v79, v255
mvaa 108,228,28
wl 9
tra 222,247,25824
buffer_load_dwordx4 v239, s[56:59], s77 offen offset:1024 lds
ex 204
cv 64,64
cv 65,66
mvaa 112,232,24
tra 224,247,25088
cv 66,68
mvaa 120,232,28
wl 9
tra 226,247,25856
cv 67,70
cv 72,72
mvaa 116,236,24
tra 228,247,25120
cv 201,202
cv 73,74
cv 74,76
mvaa 124,236,28
wl 9
tra 230,247,25888
cv 75,78
mvaa 128,208,24
tra 232,247,25152
v_mul_f32 v80, v80, v254
v_mul_f32 v81, v81, v254
mvaa 136,208,28
wl 9
tra 234,247,25920
ex 205
v_mul_f32 v82, v82, v254
mvaa 132,212,24
tra 236,247,25184
v_mul_f32 v83, v83, v254
v_mul_f32 v84, v84, v254
mvaa 140,212,28
wl 9
tra 238,247,25952
buffer_load_dwordx4 v240, s[56:59], s77 offen offset:2048 lds
v_mul_f32 v85, v85, v254
v_mul_f32 v86, v86, v254
mvaa 144,216,24
wl 8
ex 206
v_mul_f32 v87, v87, v254
mvaa 152,216,28
s_add_u32 s77, s77, s80
v_mul_f32 v88, v88, v255
v_mul_f32 v89, v89, v255
mvaa 148,220,24
s_cmp_le_u32 s83, 1
s_cbranch_scc1 L_k1_tw_u116
L_k1_hb_u117:
s_waitcnt vmcnt(9) lgkmcnt(0)
v_mul_f32 v90, v90, v255
v_mul_f32 v91, v91, v255
mvaa 156,220,28
s_barrier
cv 202,204
v_mul_f32 v92, v92, v255
mvaa 160,224,24
tra 208,247,37248
v_mul_f32 v93, v93, v255
v_mul_f32 v94, v94, v255
mvaa 168,224,28
tra 210,247,38016
v_mul_f32 v95, v95, v255
cv 80,80
mvaa 164,228,24
tra 212,247,37280
ex 207
cv 81,82
mvaa 172,228,28
tra 214,247,38048
cv 82,84
cv 83,86
mvaa 176,232,24
tra 216,247,37312
cv 88,88
cv 89,90
cv 90,92
cv 91,94
mvaa 184,232,28
L_k1_ps11:
s_cbranch_execz L_k1_pr0
tra 218,247,38080
cv 203,206
mvaa 180,236,24
tra 220,247,37344
tra 222,247,38112
mvaa 188,236,28
s_add_u32 m0, s74, 0x3080
tra 224,247,37376
buffer_load_dwordx4 v238, s[56:59], s77 offen lds
s_cmp_eq_u32 s83, 0
s_cbranch_scc1 L_k1_hk_u119
L_k1_hb_u120:
s_cmp_eq_u32 s83, 1
s_cbranch_scc1 L_k1_hk_u121
L_k1_hb_u122:
s_cmp_eq_u32 s83, 2
s_cbranch_scc1 L_k1_hk_u123
L_k1_hb_u124:
s_add_u32 s83, s83, 1
s_branch L_k1_loop
L_k1_exit:
cvaa 192,224,160,224
ex 208
cvaa 200,224,164,228
wl 5
rqa 220,242,1664
cvaa 196,228,160,224
buffer_load_dwordx4 v239, s[56:59], s77 offen offset:1024 lds
cvaa 204,228,164,228
wl 5
rqa 224,241,256
mvaa 192,232,168
ex 209
mvaa 200,232,172
wl 5
rqa 228,241,1792
mvaa 196,236,168
ex 210
mvaa 204,236,172
wl 5
rqa 232,242,256
cv 208,208
mvaa 192,208,176
ex 211
mvaa 200,208,180
wl 5
ex 212
mvaa 196,212,176
rqa 236,242,1792
cv 209,210
mvaa 204,212,180
wl 5
buffer_load_dwordx4 v240, s[56:59], s77 offen offset:2048 lds
mvaa 192,216,184
s_add_u32 s77, s77, s80
ex 213
mvaa 200,216,188
wl 4
ex 214
mvaa 196,220,184
s_waitcnt vmcnt(9) lgkmcnt(0)
mvaa 204,220,188
s_barrier
mvaa 192,224,192
tra 208,247,12416
tra 210,247,13184
mvaa 200,224,196
tra 212,247,12448
tra 214,247,13216
mvaa 196,228,192
tra 216,247,12480
tra 218,247,13248
mvaa 204,228,196
tra 220,247,12512
tra 222,247,13280
mvaa 192,232,200
s_add_u32 m0, s74, 0x12300
tra 224,247,12544
buffer_load_dwordx4 v238, s[56:59], s77 offen lds
mvaa 200,232,204
tra 226,247,13312
tra 228,247,12576
mvaa 196,236,200
tra 230,247,13344
tra 232,247,12608
mvaa 204,236,204
wl 11
tra 234,247,13376
tra 236,247,12640
mvaa 96,208,80
tra 238,247,13408
mvaa 104,208,84
wl 12
tra 208,247,12672
mvaa 100,212,80
tra 210,247,13440
mvaa 108,212,84
wl 12
tra 212,247,12704
cv 210,212
mvaa 112,216,80
tra 214,247,13472
buffer_load_dwordx4 v239, s[56:59], s77 offen offset:1024 lds
mvaa 120,216,84
wl 12
tra 216,247,12736
mvaa 116,220,80
tra 218,247,13504
mvaa 124,220,84
wl 12
tra 220,247,12768
ex 215
mvaa 128,224,80
tra 222,247,13536
mvaa 136,224,84
wl 12
tra 224,247,24832
tra 226,247,25600
mvaa 132,228,80
ex 216
mvaa 140,228,84
wl 12
tra 228,247,24864
cv 211,214
mvaa 144,232,80
tra 230,247,25632
buffer_load_dwordx4 v240, s[56:59], s77 offen offset:2048 lds
mvaa 152,232,84
wl 12
s_add_u32 s77, s77, s17
tra 232,247,24896
mvaa 148,236,80
s_sub_u32 s23, s77, s79
s_min_u32 s77, s77, s23
tra 234,247,25664
mvaa 156,236,84
wl 12
tra 236,247,24928
ex 217
mvaa 160,208,80
tra 238,247,25696
mvaa 168,208,84
wl 12
tra 208,247,24960
tra 210,247,25728
mvaa 164,212,80
s_add_u32 m0, s74, 0x15380
ex 218
mvaa 172,212,84
wl 12
tra 212,247,24992
buffer_load_dwordx4 v235, s[52:55], s76 offen nt lds
mvaa 176,216,80
tra 214,247,25760
mvaa 184,216,84
wl 12
tra 216,247,25024
cv 216,216
mvaa 180,220,80
tra 218,247,25792
mvaa 188,220,84
wl 12
tra 220,247,25056
tra 222,247,25824
mvaa 96,224,88
ex 219
mvaa 104,224,92
wl 12
tra 224,247,25088
mvaa 100,228,88
tra 226,247,25856
mvaa 108,228,92
wl 12
tra 228,247,25120
buffer_load_dwordx4 v236, s[52:55], s76 offen offset:1024 nt lds
mvaa 112,232,88
ex 220
mvaa 120,232,92
wl 11
tra 230,247,25888
mvaa 116,236,88
tra 232,247,25152
cv 217,218
mvaa 124,236,92
wl 11
tra 234,247,25920
mvaa 128,208,88
tra 236,247,25184
mvaa 136,208,92
wl 11
ex 221
mvaa 132,212,88
tra 238,247,25952
mvaa 140,212,92
wl 10
ex 222
mvaa 144,216,88
buffer_load_dwordx4 v237, s[52:55], s76 offen offset:2048 nt lds
mvaa 152,216,92
wl 8
s_add_u32 s76, s76, 0x3000
mvaa 148,220,88
s_waitcnt vmcnt(9) lgkmcnt(0)
cv 218,220
mvaa 156,220,92
s_barrier
mvaa 160,224,88
tra 208,247,37248
tra 210,247,38016
mvaa 168,224,92
tra 212,247,37280
tra 214,247,38048
mvaa 164,228,88
tra 216,247,37312
ex 223
mvaa 172,228,92
s_add_u32 m0, s73, 0
tra 218,247,38080
mvaa 176,232,88
buffer_load_dwordx4 v232, s[48:51], s75 offen nt lds
mvaa 184,232,92
tra 220,247,37344
cv 219,222
mvaa 180,236,88
tra 222,247,38112
mvaa 188,236,92
tra 224,247,37376
maav 240,248,208
tra 226,247,38144
maav 244,248,216
wl 8
tra 228,247,37408
mvav 0,208,208
tra 230,247,38176
mvav 8,208,216
wl 8
tra 232,247,37440
mvav 4,212,208
buffer_load_dwordx4 v233, s[48:51], s75 offen offset:1024 nt lds
mvav 12,212,216
wl 7
tra 234,247,38208
v_max3_f32 v251, v192, v193, v194
mvav 16,216,208
tra 236,247,37472
mvav 24,216,216
wl 7
tra 238,247,38240
v_max3_f32 v251, v251, v195, v196
mvav 20,220,208
tra 208,247,37504
mvav 28,220,216
wl 7
tra 210,247,38272
v_max3_f32 v251, v251, v197, v198
mvav 32,224,208
tra 212,247,37536
mvav 40,224,216
wl 7
tra 214,247,38304
v_max3_f32 v251, v251, v199, v200
mvav 36,228,208
buffer_load_dwordx4 v234, s[48:51], s75 offen offset:2048 nt lds
mvav 44,228,216
wl 6
s_add_u32 s75, s75, 0x3000
tra 216,247,37568
mvav 48,232,208
tra 218,247,38336
v_max3_f32 v251, v251, v201, v202
mvav 56,232,216
wl 6
tra 220,247,37600
mvav 52,236,208
tra 222,247,38368
v_max3_f32 v251, v251, v203, v204
mvav 60,236,216
wl 6
rqa 224,241,49664
mvav 64,208,208
rqa 228,241,51200
v_max3_f32 v251, v251, v205, v206
mvav 72,208,216
wl 6
rqa 232,242,49664
v_max_f32 v251, v251, v207
mvav 68,212,208
rqa 236,242,51200
v_cmp_lt_f32 vcc, s43, v251
mvav 76,212,216
wl 6
s_add_u32 m0, s74, 0x3080
rqa 208,241,49792
mvav 80,216,208
buffer_load_dwordx4 v238, s[56:59], s77 offen lds
mvav 88,216,216
wl 5
rqa 212,241,51328
mvav 84,220,208
wl 5
rqa 216,242,49792
mvav 92,220,216
s_cbranch_vccnz L_k1_rr_u416
L_k1_rb_u417:
cvaa 208,224,160,224
ex 192
cvaa 216,224,164,228
wl 5
rqa 220,242,51328
cvaa 212,228,160,224
buffer_load_dwordx4 v239, s[56:59], s77 offen offset:1024 lds
cvaa 220,228,164,228
wl 5
rqa 224,241,49920
mvaa 208,232,168
ex 193
mvaa 216,232,172
wl 5
rqa 228,241,51456
mvaa 212,236,168
ex 194
mvaa 220,236,172
wl 5
rqa 232,242,49920
cv 192,192
mvaa 208,208,176
ex 195
mvaa 216,208,180
wl 5
ex 196
mvaa 212,212,176
rqa 236,242,51456
cv 193,194
mvaa 220,212,180
wl 5
buffer_load_dwordx4 v240, s[56:59], s77 offen offset:2048 lds
mvaa 208,216,184
s_add_u32 s77, s77, s80
ex 197
mvaa 216,216,188
wl 4
ex 198
mvaa 212,220,184
s_waitcnt vmcnt(9) lgkmcnt(0)
mvaa 220,220,188
s_barrier
mvaa 208,224,192
tra 208,248,0
tra 210,248,768
mvaa 216,224,196
tra 212,248,32
tra 214,248,800
mvaa 212,228,192
tra 216,248,64
tra 218,248,832
mvaa 220,228,196
tra 220,248,96
tra 222,248,864
mvaa 208,232,200
s_add_u32 m0, s74, 0x9180
tra 224,248,128
buffer_load_dwordx4 v238, s[56:59], s77 offen lds
mvaa 216,232,204
tra 226,248,896
tra 228,248,160
mvaa 212,236,200
tra 230,248,928
tra 232,248,192
mvaa 220,236,204
wl 11
tra 234,248,960
tra 236,248,224
mvaa 96,208,96
tra 238,248,992
mvaa 104,208,100
wl 12
tra 208,248,256
mvaa 100,212,96
tra 210,248,1024
mvaa 108,212,100
wl 12
tra 212,248,288
cv 194,196
mvaa 112,216,96
tra 214,248,1056
buffer_load_dwordx4 v239, s[56:59], s77 offen offset:1024 lds
mvaa 120,216,100
wl 12
tra 216,248,320
mvaa 116,220,96
tra 218,248,1088
mvaa 124,220,100
wl 12
tra 220,248,352
ex 199
mvaa 128,224,96
tra 222,248,1120
mvaa 136,224,100
wl 12
tra 224,248,12416
tra 226,248,13184
mvaa 132,228,96
ex 200
mvaa 140,228,100
wl 12
tra 228,248,12448
cv 195,198
mvaa 144,232,96
tra 230,248,13216
buffer_load_dwordx4 v240, s[56:59], s77 offen offset:2048 lds
mvaa 152,232,100
wl 12
s_add_u32 s77, s77, s18
tra 232,248,12480
mvaa 148,236,96
s_sub_u32 s23, s77, s79
s_min_u32 s77, s77, s23
tra 234,248,13248
mvaa 156,236,100
wl 12
tra 236,248,12512
ex 201
mvaa 160,208,96
tra 238,248,13280
mvaa 168,208,100
wl 12
tra 208,248,12544
tra 210,248,13312
mvaa 164,212,96
s_add_u32 m0, s74, 0xc200
ex 202
mvaa 172,212,100
wl 12
tra 212,248,12576
buffer_load_dwordx4 v235, s[52:55], s76 offen nt lds
mvaa 176,216,96
tra 214,248,13344
mvaa 184,216,100
wl 12
tra 216,248,12608
cv 200,200
mvaa 180,220,96
tra 218,248,13376
mvaa 188,220,100
wl 12
tra 220,248,12640
tra 222,248,13408
mvaa 96,224,104
ex 203
mvaa 104,224,108
wl 12
tra 224,248,12672
mvaa 100,228,104
tra 226,248,13440
mvaa 108,228,108
wl 12
tra 228,248,12704
buffer_load_dwordx4 v236, s[52:55], s76 offen offset:1024 nt lds
mvaa 112,232,104
ex 204
mvaa 120,232,108
wl 11
tra 230,248,13472
mvaa 116,236,104
tra 232,248,12736
cv 201,202
mvaa 124,236,108
wl 11
tra 234,248,13504
mvaa 128,208,104
tra 236,248,12768
mvaa 136,208,108
wl 11
ex 205
mvaa 132,212,104
tra 238,248,13536
mvaa 140,212,108
wl 10
ex 206
mvaa 144,216,104
buffer_load_dwordx4 v237, s[52:55], s76 offen offset:2048 nt lds
mvaa 152,216,108
wl 8
s_add_u32 s76, s76, 0x3000
mvaa 148,220,104
s_waitcnt vmcnt(9) lgkmcnt(0)
cv 202,204
mvaa 156,220,108
s_barrier
mvaa 160,224,104
tra 208,248,24832
tra 210,248,25600
mvaa 168,224,108
tra 212,248,24864
tra 214,248,25632
mvaa 164,228,104
tra 216,248,24896
ex 207
mvaa 172,228,108
s_add_u32 m0, s73, 0xf280
tra 218,248,25664
mvaa 176,232,104
buffer_load_dwordx4 v232, s[48:51], s75 offen nt lds
mvaa 184,232,108
tra 220,248,24928
cv 203,206
mvaa 180,236,104
tra 222,248,25696
mvaa 188,236,108
tra 224,248,24960
maav 240,248,192
tra 226,248,25728
maav 244,248,200
wl 8
tra 228,248,24992
mvav 0,208,192
tra 230,248,25760
mvav 8,208,200
wl 8
tra 232,248,25024
mvav 4,212,192
buffer_load_dwordx4 v233, s[48:51], s75 offen offset:1024 nt lds
mvav 12,212,200
wl 7
tra 234,248,25792
v_max3_f32 v251, v208, v209, v210
mvav 16,216,192
tra 236,248,25056
mvav 24,216,200
wl 7
tra 238,248,25824
v_max3_f32 v251, v251, v211, v212
mvav 20,220,192
tra 208,248,25088
mvav 28,220,200
wl 7
tra 210,248,25856
v_max3_f32 v251, v251, v213, v214
mvav 32,224,192
tra 212,248,25120
mvav 40,224,200
wl 7
tra 214,248,25888
v_max3_f32 v251, v251, v215, v216
mvav 36,228,192
buffer_load_dwordx4 v234, s[48:51], s75 offen offset:2048 nt lds
mvav 44,228,200
wl 6
s_add_u32 s75, s75, 0x3000
tra 216,248,25152
mvav 48,232,192
tra 218,248,25920
v_max3_f32 v251, v251, v217, v218
mvav 56,232,200
wl 6
tra 220,248,25184
mvav 52,236,192
tra 222,248,25952
v_max3_f32 v251, v251, v219, v220
mvav 60,236,200
wl 6
rqa 224,241,0
mvav 64,208,192
rqa 228,241,1536
v_max3_f32 v251, v251, v221, v222
mvav 72,208,200
wl 6
rqa 232,242,0
v_max_f32 v251, v251, v223
mvav 68,212,192
rqa 236,242,1536
v_cmp_lt_f32 vcc, s43, v251
mvav 76,212,200
wl 6
s_add_u32 m0, s74, 0x12300
rqa 208,241,128
mvav 80,216,192
buffer_load_dwordx4 v238, s[56:59], s77 offen lds
mvav 88,216,200
wl 5
rqa 212,241,1664
mvav 84,220,192
wl 5
rqa 216,242,128
mvav 92,220,200
s_cbranch_vccnz L_k1_rr_u418
L_k1_rb_u419:
rqa 220,242,1664
cvaa 192,224,160,224
L_k1_ps12:
s_cbranch_execz L_k1_pst0
cvaa 200,224,164,228
wl 6
ex 208
cvaa 196,228,160,224
buffer_load_dwordx4 v239, s[56:59], s77 offen offset:1024 lds
cvaa 204,228,164,228
wl 5
rqa 224,241,256
mvaa 192,232,168
ex 209
mvaa 200,232,172
wl 5
rqa 228,241,1792
mvaa 196,236,168
ex 210
mvaa 204,236,172
wl 5
rqa 232,242,256
cv 208,208
mvaa 192,208,176
ex 211
mvaa 200,208,180
wl 5
ex 212
mvaa 196,212,176
rqa 236,242,1792
cv 209,210
mvaa 204,212,180
wl 5
buffer_load_dwordx4 v240, s[56:59], s77 offen offset:2048 lds
mvaa 192,216,184
s_add_u32 s77, s77, s80
ex 213
mvaa 200,216,188
wl 4
ex 214
mvaa 196,220,184
s_waitcnt vmcnt(9) lgkmcnt(0)
mvaa 204,220,188
s_barrier
mvaa 192,224,192
tra 208,247,12416
tra 210,247,13184
mvaa 200,224,196
tra 212,247,12448
tra 214,247,13216
mvaa 196,228,192
tra 216,247,12480
tra 218,247,13248
mvaa 204,228,196
tra 220,247,12512
tra 222,247,13280
mvaa 192,232,200
s_add_u32 m0, s74, 0x15380
tra 224,247,12544
buffer_load_dwordx4 v238, s[56:59], s77 offen lds
mvaa 200,232,204
tra 226,247,13312
tra 228,247,12576
mvaa 196,236,200
tra 230,247,13344
tra 232,247,12608
mvaa 204,236,204
wl 11
tra 234,247,13376
tra 236,247,12640
mvaa 96,208,112
tra 238,247,13408
mvaa 104,208,116
wl 12
tra 208,247,12672
mvaa 100,212,112
tra 210,247,13440
mvaa 108,212,116
wl 12
tra 212,247,12704
cv 210,212
mvaa 112,216,112
tra 214,247,13472
buffer_load_dwordx4 v239, s[56:59], s77 offen offset:1024 lds
mvaa 120,216,116
wl 12
tra 216,247,12736
mvaa 116,220,112
tra 218,247,13504
mvaa 124,220,116
wl 12
tra 220,247,12768
ex 215
mvaa 128,224,112
tra 222,247,13536
mvaa 136,224,116
wl 12
tra 224,247,37248
tra 226,247,38016
mvaa 132,228,112
ex 216
mvaa 140,228,116
wl 12
tra 228,247,37280
tra 230,247,38048
mvaa 144,232,112
buffer_load_dwordx4 v240, s[56:59], s77 offen offset:2048 lds
mvaa 152,232,116
wl 12
tra 232,247,37312
cv 211,214
mvaa 148,236,112
tra 234,247,38080
mvaa 156,236,116
wl 12
tra 236,247,37344
ex 217
mvaa 160,208,112
tra 238,247,38112
mvaa 168,208,116
wl 12
tra 208,247,37376
tra 210,247,38144
mvaa 164,212,112
s_add_u32 m0, s74, 0
ex 218
mvaa 172,212,116
wl 12
tra 212,247,37408
buffer_load_dwordx4 v235, s[52:55], s76 offen nt lds
mvaa 176,216,112
tra 214,247,38176
mvaa 184,216,116
wl 12
tra 216,247,37440
cv 216,216
mvaa 180,220,112
tra 218,247,38208
mvaa 188,220,116
wl 12
tra 220,247,37472
tra 222,247,38240
mvaa 96,224,120
ex 219
mvaa 104,224,124
wl 12
tra 224,247,37504
mvaa 100,228,120
tra 226,247,38272
mvaa 108,228,124
wl 12
tra 228,247,37536
buffer_load_dwordx4 v236, s[52:55], s76 offen offset:1024 nt lds
mvaa 112,232,120
ex 220
mvaa 120,232,124
wl 11
tra 230,247,38304
mvaa 116,236,120
tra 232,247,37568
cv 217,218
mvaa 124,236,124
wl 11
tra 234,247,38336
mvaa 128,208,120
tra 236,247,37600
mvaa 136,208,124
wl 11
ex 221
mvaa 132,212,120
tra 238,247,38368
mvaa 140,212,124
wl 10
ex 222
mvaa 144,216,120
buffer_load_dwordx4 v237, s[52:55], s76 offen offset:2048 nt lds
mvaa 152,216,124
wl 8
s_add_u32 s76, s76, 0x3000
mvaa 148,220,120
s_waitcnt vmcnt(9) lgkmcnt(0)
cv 218,220
mvaa 156,220,124
s_barrier
mvaa 160,224,120
tra 208,247,49664
tra 210,247,50432
mvaa 168,224,124
tra 212,247,49696
ex 223
mvaa 164,228,120
s_add_u32 m0, s73, 0x18400
tra 214,247,50464
buffer_load_dwordx4 v232, s[48:51], s75 offen nt lds
mvaa 172,228,124
tra 216,247,49728
tra 218,247,50496
mvaa 176,232,120
tra 220,247,49760
tra 222,247,50528
mvaa 184,232,124
tra 224,247,49792
cv 219,222
mvaa 180,236,120
tra 226,247,50560
buffer_load_dwordx4 v233, s[48:51], s75 offen offset:1024 nt lds
mvaa 188,236,124
tra 228,247,49824
tra 230,247,50592
maav 240,248,208
tra 232,247,49856
maav 244,248,216
wl 11
tra 234,247,50624
mvav 0,208,208
buffer_load_dwordx4 v234, s[48:51], s75 offen offset:2048 nt lds
mvav 8,208,216
wl 10
s_add_u32 s75, s75, 0x3000
tra 236,247,49888
mvav 4,212,208
tra 238,247,50656
mvav 12,212,216
wl 10
tra 208,247,49920
v_max3_f32 v251, v192, v193, v194
mvav 16,216,208
s_mov_b32 s58, 0xf0000
v_lshrrev_b32 v253, 7, v250
v_add_u32 v253, 0, v253
v_mul_u32_u24 v254, 11, v253
v_lshrrev_b32 v254, 5, v254
v_mul_u32_u24 v254, 3, v254
v_sub_u32 v253, v253, v254
v_lshrrev_b32 v252, 1, v253
v_mad_i32_i24 v254, v252, s8, v253
v_add_u32 v254, s9, v254
v_subrev_u32 v252, 10, v254
v_min_u32 v254, v252, v254
v_lshlrev_b32 v254, 7, v254
v_sub_u32 v254, v238, v254
v_mul_u32_u24 v253, 0xa000, v253
v_add_u32 v254, v254, v253
mvav 24,216,216
wl 9
tra 210,247,50688
v_max3_f32 v251, v251, v195, v196
mvav 20,220,208
s_add_u32 s90, s70, 3
tra 212,247,49952
v_max3_f32 v251, v251, v197, v198
mvav 28,220,216
wl 9
s_and_b32 s90, s90, 7
tra 214,247,50720
mvav 32,224,208
v_lshrrev_b32 v253, 7, v250
v_add_u32 v253, 8, v253
v_mul_u32_u24 v255, 11, v253
v_lshrrev_b32 v255, 5, v255
v_mul_u32_u24 v255, 3, v255
v_sub_u32 v253, v253, v255
v_lshrrev_b32 v252, 1, v253
v_mad_i32_i24 v255, v252, s8, v253
v_add_u32 v255, s9, v255
v_subrev_u32 v252, 10, v255
v_min_u32 v255, v252, v255
v_lshlrev_b32 v255, 7, v255
v_sub_u32 v255, v239, v255
v_mul_u32_u24 v253, 0xa000, v253
v_add_u32 v255, v255, v253
mvav 40,224,216
wl 8
s_add_u32 s90, s90, s97
tra 216,247,49984
mvav 36,228,208
tra 218,247,50752
v_max3_f32 v251, v251, v199, v200
mvav 44,228,216
wl 8
tra 220,247,50016
v_max3_f32 v251, v251, v201, v202
mvav 48,232,208
s_sub_u32 s25, s90, 10
v_lshrrev_b32 v253, 7, v250
v_add_u32 v253, 16, v253
v_mul_u32_u24 v245, 11, v253
v_lshrrev_b32 v245, 5, v245
v_mul_u32_u24 v245, 3, v245
v_sub_u32 v253, v253, v245
v_lshrrev_b32 v252, 1, v253
v_mad_i32_i24 v245, v252, s8, v253
v_add_u32 v245, s9, v245
v_subrev_u32 v252, 10, v245
v_min_u32 v245, v252, v245
v_lshlrev_b32 v245, 7, v245
v_sub_u32 v245, v240, v245
v_mul_u32_u24 v253, 0xa000, v253
v_add_u32 v245, v245, v253
mvav 56,232,216
wl 7
tra 222,247,50784
v_max3_f32 v251, v251, v203, v204
mvav 52,236,208
s_min_u32 s90, s90, s25
rqa 224,243,0
v_max3_f32 v251, v251, v205, v206
mvav 60,236,216
wl 7
s_add_u32 m0, s74, 0x1b480
rqa 228,243,1536
mvav 64,208,208
s_lshl_b32 s90, s90, 7
s_add_u32 s89, s90, 0
rqa 232,244,0
mvav 72,208,216
wl 7
buffer_load_dwordx4 v254, s[56:59], s89 offen lds
mvav 68,212,208
rqa 236,244,1536
v_max_f32 v251, v251, v207
mvav 76,212,216
wl 6
rqa 208,243,128
v_cmp_lt_f32 vcc, s43, v251
mvav 80,216,208
buffer_load_dwordx4 v255, s[56:59], s89 offen offset:1024 lds
mvav 88,216,216
wl 5
rqa 212,243,1664
mvav 84,220,208
wl 5
rqa 216,244,128
mvav 92,220,216
s_cbranch_vccnz L_k1_rr_u420
L_k1_rb_u421:
cvaa 208,224,160,224
buffer_load_dwordx4 v245, s[56:59], s89 offen offset:2048 lds
cvaa 216,224,164,228
wl 5
rqa 220,244,1664
cvaa 212,228,160,224
s_add_u32 m0, s74, 0x6100
ex 192
cvaa 220,228,164,228
wl 5
s_add_u32 s89, s90, 0x1e000
rqa 224,243,256
mvaa 208,232,168
buffer_load_dwordx4 v254, s[56:59], s89 offen lds
mvaa 216,232,172
wl 5
rqa 228,243,1792
mvaa 212,236,168
ex 193
mvaa 220,236,172
wl 5
rqa 232,244,256
mvaa 208,208,176
ex 194
mvaa 216,208,180
wl 5
buffer_load_dwordx4 v255, s[56:59], s89 offen offset:1024 lds
mvaa 212,212,176
rqa 236,244,1792
cv 192,192
mvaa 220,212,180
wl 5
ex 195
mvaa 208,216,184
ex 196
mvaa 216,216,188
wl 4
buffer_load_dwordx4 v245, s[56:59], s89 offen offset:2048 lds
mvaa 212,220,184
s_waitcnt vmcnt(12) lgkmcnt(0)
mvaa 220,220,188
s_barrier
mvaa 208,224,192
tra 208,248,12416
tra 210,248,13184
mvaa 216,224,196
tra 212,248,12448
tra 214,248,13216
mvaa 212,228,192
tra 216,248,12480
tra 218,248,13248
mvaa 220,228,196
tra 220,248,12512
tra 222,248,13280
mvaa 208,232,200
s_add_u32 m0, s74, 0x3080
tra 224,248,12544
buffer_load_dwordx4 v235, s[52:55], s76 offen nt lds
mvaa 216,232,204
tra 226,248,13312
cv 193,194
mvaa 212,236,200
tra 228,248,12576
ex 197
mvaa 220,236,204
wl 9
tra 230,248,13344
tra 232,248,12608
mvaa 96,208,128
tra 234,248,13376
buffer_load_dwordx4 v236, s[52:55], s76 offen offset:1024 nt lds
mvaa 104,208,132
wl 10
tra 236,248,12640
ex 198
mvaa 100,212,128
tra 238,248,13408
tra 208,248,12672
mvaa 108,212,132
wl 11
tra 210,248,13440
tra 212,248,12704
mvaa 112,216,128
tra 214,248,13472
cv 194,196
mvaa 120,216,132
wl 12
tra 216,248,12736
buffer_load_dwordx4 v237, s[52:55], s76 offen offset:2048 nt lds
mvaa 116,220,128
s_add_u32 s76, s76, 0x3000
tra 218,248,13504
mvaa 124,220,132
wl 12
tra 220,248,12768
ex 199
mvaa 128,224,128
tra 222,248,13536
mvaa 136,224,132
wl 12
tra 224,248,24832
ex 200
mvaa 132,228,128
s_add_u32 m0, s73, 0x9180
tra 226,248,25600
buffer_load_dwordx4 v232, s[48:51], s75 offen nt lds
mvaa 140,228,132
wl 12
tra 228,248,24864
mvaa 144,232,128
tra 230,248,25632
cv 195,198
mvaa 152,232,132
wl 12
tra 232,248,24896
mvaa 148,236,128
tra 234,248,25664
mvaa 156,236,132
wl 12
tra 236,248,24928
buffer_load_dwordx4 v233, s[48:51], s75 offen offset:1024 nt lds
mvaa 160,208,128
tra 238,248,25696
ex 201
mvaa 168,208,132
wl 12
tra 208,248,24960
tra 210,248,25728
mvaa 164,212,128
ex 202
mvaa 172,212,132
wl 12
tra 212,248,24992
mvaa 176,216,128
tra 214,248,25760
mvaa 184,216,132
wl 12
tra 216,248,25024
buffer_load_dwordx4 v234, s[48:51], s75 offen offset:2048 nt lds
mvaa 180,220,128
s_add_u32 s75, s75, 0x3000
tra 218,248,25792
cv 200,200
mvaa 188,220,132
wl 12
tra 220,248,25056
tra 222,248,25824
mvaa 96,224,136
ex 203
mvaa 104,224,140
wl 12
s_add_u32 m0, s74, 0xc200
tra 224,248,25088
mvaa 100,228,136
s_add_u32 s89, s90, 0x3c000
tra 226,248,25856
buffer_load_dwordx4 v254, s[56:59], s89 offen lds
mvaa 108,228,140
wl 12
ex 204
mvaa 112,232,136
tra 228,248,25120
mvaa 120,232,140
wl 11
tra 230,248,25888
mvaa 116,236,136
tra 232,248,25152
cv 201,202
mvaa 124,236,140
wl 11
buffer_load_dwordx4 v255, s[56:59], s89 offen offset:1024 lds
mvaa 128,208,136
tra 234,248,25920
mvaa 136,208,140
wl 10
ex 205
mvaa 132,212,136
tra 236,248,25184
mvaa 140,212,140
wl 9
tra 238,248,25952
mvaa 144,216,136
buffer_load_dwordx4 v245, s[56:59], s89 offen offset:2048 lds
mvaa 152,216,140
wl 8
ex 206
mvaa 148,220,136
s_waitcnt vmcnt(15) lgkmcnt(0)
cv 202,204
mvaa 156,220,140
s_barrier
mvaa 160,224,136
tra 208,247,0
tra 210,247,768
mvaa 168,224,140
tra 212,247,32
ex 207
mvaa 164,228,136
s_add_u32 s89, s90, 0x5a000
s_add_u32 m0, s74, 0xf280
tra 214,247,800
mvaa 172,228,140
tra 216,247,64
buffer_load_dwordx4 v254, s[56:59], s89 offen lds
mvaa 176,232,136
tra 218,247,832
tra 220,247,96
mvaa 184,232,140
tra 222,247,864
cv 203,206
mvaa 180,236,136
tra 224,247,128
tra 226,247,896
mvaa 188,236,140
tra 228,247,160
tra 230,247,928
maav 240,248,192
tra 232,247,192
buffer_load_dwordx4 v255, s[56:59], s89 offen offset:1024 lds
maav 244,248,200
wl 11
tra 234,247,960
tra 236,247,224
mvav 0,208,192
tra 238,247,992
mvav 8,208,200
wl 12
tra 208,247,256
mvav 4,212,192
tra 210,247,1024
mvav 12,212,200
wl 12
tra 212,247,288
v_max3_f32 v251, v208, v209, v210
mvav 16,216,192
tra 214,247,1056
buffer_load_dwordx4 v245, s[56:59], s89 offen offset:2048 lds
mvav 24,216,200
wl 12
tra 216,247,320
v_max3_f32 v251, v251, v211, v212
mvav 20,220,192
s_lshl_b32 s88, s68, 13
s_add_u32 s88, s88, 0x1e500
v_add_u32 v246, s88, v250
mvav 28,220,200
wl 11
tra 218,247,1088
v_max3_f32 v251, v251, v213, v214
mvav 32,224,192
s_add_u32 m0, s74, 0x12300
tra 220,247,352
buffer_load_dwordx4 v235, s[52:55], s76 offen nt lds
mvav 40,224,200
wl 11
ds_write_b128 v246, v[160:163] offset:0
mvav 36,228,192
tra 222,247,1120
v_max3_f32 v251, v251, v215, v216
mvav 44,228,200
wl 11
rqa 224,243,37248
v_max3_f32 v251, v251, v217, v218
mvav 48,232,192
L_k1_ps13:
s_cbranch_execz L_k1_pst1
mvav 56,232,200
wl 10
rqa 228,243,38784
v_max3_f32 v251, v251, v219, v220
mvav 52,236,192
ds_write_b128 v246, v[164:167] offset:1024
mvav 60,236,200
wl 10
rqa 232,244,37248
mvav 64,208,192
rqa 236,244,38784
v_max3_f32 v251, v251, v221, v222
mvav 72,208,200
wl 10
buffer_load_dwordx4 v236, s[52:55], s76 offen offset:1024 nt lds
mvav 68,212,192
rqa 208,243,37376
v_max_f32 v251, v251, v223
mvav 76,212,200
wl 9
rqa 212,243,38912
v_cmp_lt_f32 vcc, s43, v251
mvav 80,216,192
ds_write_b128 v246, v[168:171] offset:2048
mvav 88,216,200
wl 8
rqa 216,244,37376
buffer_load_dwordx4 v237, s[52:55], s76 offen offset:2048 nt lds
mvav 84,220,192
wl 8
ds_write_b128 v246, v[172:175] offset:3072
mvav 92,220,200
s_cbranch_vccnz L_k1_rr_u422
L_k1_rb_u423:
rqa 220,244,38912
cvaa 192,224,160,224
s_add_u32 s76, s76, 0x3000
ex 208
cvaa 200,224,164,228
wl 9
s_add_u32 m0, s73, 0x15380
rqa 224,243,37504
cvaa 196,228,160,224
buffer_load_dwordx4 v232, s[48:51], s75 offen nt lds
cvaa 204,228,164,228
wl 8
rqa 228,243,39040
mvaa 192,232,168
ds_write_b128 v246, v[176:179] offset:4096
mvaa 200,232,172
wl 9
rqa 232,244,37504
ex 209
mvaa 196,236,168
buffer_load_dwordx4 v233, s[48:51], s75 offen offset:1024 nt lds
mvaa 204,236,172
wl 9
rqa 236,244,39040
mvaa 192,208,176
ex 210
mvaa 200,208,180
wl 9
ds_write_b128 v246, v[180:183] offset:5120
mvaa 196,212,176
ds_write_b128 v246, v[184:187] offset:6144
cv 208,208
mvaa 204,212,180
wl 9
ex 211
mvaa 192,216,184
wl 7
buffer_load_dwordx4 v234, s[48:51], s75 offen offset:2048 nt lds
mvaa 200,216,188
s_add_u32 s75, s75, 0x3000
ds_write_b128 v246, v[188:191] offset:7168
mvaa 196,220,184
s_waitcnt vmcnt(18) lgkmcnt(0)
ex 212
mvaa 204,220,188
s_barrier
mvaa 192,224,192
tra 208,248,49664
tra 210,248,50432
mvaa 200,224,196
tra 212,248,49696
tra 214,248,50464
mvaa 196,228,192
s_add_u32 m0, s74, 0
tra 216,248,49728
tra 218,248,50496
mvaa 204,228,196
tra 220,248,49760
tra 222,248,50528
mvaa 192,232,200
s_add_u32 s89, s90, 0x78000
tra 224,248,49792
buffer_load_dwordx4 v254, s[56:59], s89 offen lds
mvaa 200,232,204
tra 226,248,50560
cv 209,210
mvaa 196,236,200
tra 228,248,49824
ex 213
mvaa 204,236,204
wl 9
tra 230,248,50592
tra 232,248,49856
zvaa 160,208,96
tra 234,248,50624
tra 236,248,49888
zvaa 168,208,100
wl 11
tra 238,248,50656
ex 214
zvaa 164,212,96
tra 208,248,49920
tra 210,248,50688
zvaa 172,212,100
wl 12
tra 212,248,49952
cv 210,212
zvaa 176,216,96
tra 214,248,50720
buffer_load_dwordx4 v255, s[56:59], s89 offen offset:1024 lds
zvaa 184,216,100
wl 12
tra 216,248,49984
zvaa 180,220,96
tra 218,248,50752
zvaa 188,220,100
wl 12
tra 220,248,50016
ex 215
mvaa 160,224,104
tra 222,248,50784
mvaa 168,224,108
wl 12
tra 224,247,24832
tra 226,247,25600
mvaa 164,228,104
ex 216
mvaa 172,228,108
wl 12
tra 228,247,24864
tra 230,247,25632
mvaa 176,232,104
buffer_load_dwordx4 v245, s[56:59], s89 offen offset:2048 lds
mvaa 184,232,108
wl 12
tra 232,247,24896
cv 211,214
mvaa 180,236,104
tra 234,247,25664
mvaa 188,236,108
wl 12
tra 236,247,24928
ex 217
mvaa 160,208,112
tra 238,247,25696
mvaa 168,208,116
wl 12
tra 208,247,24960
ex 218
mvaa 164,212,112
s_add_u32 s89, s90, 0x96000
s_add_u32 m0, s74, 0x18400
tra 210,247,25728
mvaa 172,212,116
wl 12
tra 212,247,24992
buffer_load_dwordx4 v254, s[56:59], s89 offen lds
mvaa 176,216,112
tra 214,247,25760
mvaa 184,216,116
wl 12
tra 216,247,25024
cv 216,216
mvaa 180,220,112
tra 218,247,25792
mvaa 188,220,116
wl 12
tra 220,247,25056
tra 222,247,25824
mvaa 160,224,120
ex 219
mvaa 168,224,124
wl 12
tra 224,247,25088
mvaa 164,228,120
tra 226,247,25856
mvaa 172,228,124
wl 12
buffer_load_dwordx4 v255, s[56:59], s89 offen offset:1024 lds
mvaa 176,232,120
ex 220
mvaa 184,232,124
wl 10
tra 228,247,25120
mvaa 180,236,120
tra 230,247,25888
cv 217,218
mvaa 188,236,124
wl 10
tra 232,247,25152
mvaa 160,208,128
tra 234,247,25920
mvaa 168,208,132
wl 10
ex 221
mvaa 164,212,128
tra 236,247,25184
mvaa 172,212,132
wl 9
tra 238,247,25952
mvaa 176,216,128
buffer_load_dwordx4 v245, s[56:59], s89 offen offset:2048 lds
mvaa 184,216,132
wl 8
ex 222
mvaa 180,220,128
s_waitcnt vmcnt(18) lgkmcnt(0)
cv 218,220
mvaa 188,220,132
s_barrier
mvaa 160,224,136
tra 208,247,12416
tra 210,247,13184
mvaa 168,224,140
tra 212,247,12448
tra 214,247,13216
mvaa 164,228,136
tra 216,247,12480
ex 223
mvaa 172,228,140
s_add_u32 m0, s74, 0x1b480
tra 218,247,13248
mvaa 176,232,136
buffer_load_dwordx4 v235, s[52:55], s76 offen nt lds
mvaa 184,232,140
tra 220,247,12512
cv 219,222
mvaa 180,236,136
tra 222,247,13280
mvaa 188,236,140
tra 224,247,12544
maav 240,248,208
tra 226,247,13312
maav 244,248,216
wl 8
tra 228,247,12576
mvav 0,208,208
tra 230,247,13344
mvav 8,208,216
wl 8
tra 232,247,12608
mvav 4,212,208
buffer_load_dwordx4 v236, s[52:55], s76 offen offset:1024 nt lds
mvav 12,212,216
wl 7
tra 234,247,13376
v_max3_f32 v251, v192, v193, v194
mvav 16,216,208
tra 236,247,12640
mvav 24,216,216
wl 7
tra 238,247,13408
v_max3_f32 v251, v251, v195, v196
mvav 20,220,208
tra 208,247,12672
mvav 28,220,216
wl 7
tra 210,247,13440
v_max3_f32 v251, v251, v197, v198
mvav 32,224,208
tra 212,247,12704
mvav 40,224,216
wl 7
tra 214,247,13472
v_max3_f32 v251, v251, v199, v200
mvav 36,228,208
buffer_load_dwordx4 v237, s[52:55], s76 offen offset:2048 nt lds
mvav 44,228,216
wl 6
s_add_u32 s76, s76, 0x3000
tra 216,247,12736
mvav 48,232,208
tra 218,247,13504
v_max3_f32 v251, v251, v201, v202
mvav 56,232,216
wl 6
tra 220,247,12768
mvav 52,236,208
tra 222,247,13536
v_max3_f32 v251, v251, v203, v204
mvav 60,236,216
wl 6
rqa 224,241,37248
mvav 64,208,208
rqa 228,241,38784
v_max3_f32 v251, v251, v205, v206
mvav 72,208,216
wl 6
rqa 232,242,37248
v_max_f32 v251, v251, v207
mvav 68,212,208
rqa 236,242,38784
v_cmp_lt_f32 vcc, s43, v251
mvav 76,212,216
wl 6
s_add_u32 m0, s73, 0x6100
rqa 208,241,37376
mvav 80,216,208
buffer_load_dwordx4 v232, s[48:51], s75 offen nt lds
mvav 88,216,216
wl 5
rqa 212,241,38912
mvav 84,220,208
wl 5
rqa 216,242,37376
mvav 92,220,216
s_cbranch_vccnz L_k1_rr_u424
L_k1_rb_u425:
cvaa 208,224,160,224
ex 192
cvaa 216,224,164,228
wl 5
rqa 220,242,38912
cvaa 212,228,160,224
buffer_load_dwordx4 v233, s[48:51], s75 offen offset:1024 nt lds
cvaa 220,228,164,228
wl 5
rqa 224,241,37504
mvaa 208,232,168
ex 193
mvaa 216,232,172
wl 5
rqa 228,241,39040
mvaa 212,236,168
ex 194
mvaa 220,236,172
wl 5
rqa 232,242,37504
cv 192,192
mvaa 208,208,176
ex 195
mvaa 216,208,180
wl 5
ex 196
mvaa 212,212,176
rqa 236,242,39040
cv 193,194
mvaa 220,212,180
wl 5
buffer_load_dwordx4 v234, s[48:51], s75 offen offset:2048 nt lds
mvaa 208,216,184
ex 197
mvaa 216,216,188
wl 4
ex 198
mvaa 212,220,184
s_waitcnt vmcnt(18) lgkmcnt(0)
mvaa 220,220,188
s_barrier
mvaa 208,224,192
tra 208,247,49664
tra 210,247,50432
mvaa 216,224,196
tra 212,247,49696
tra 214,247,50464
mvaa 212,228,192
tra 216,247,49728
tra 218,247,50496
mvaa 220,228,196
tra 220,247,49760
tra 222,247,50528
mvaa 208,232,200
tra 224,247,49792
v_mov_b32 v232, v254
mvaa 216,232,204
tra 226,247,50560
tra 228,247,49824
mvaa 212,236,200
s_add_u32 s90, s70, 2
tra 230,247,50592
tra 232,247,49856
mvaa 220,236,204
wl 11
tra 234,247,50624
tra 236,247,49888
mvaa 160,208,0
tra 238,247,50656
v_mov_b32 v233, v255
mvaa 168,208,4
wl 12
s_and_b32 s90, s90, 7
tra 208,247,49920
mvaa 164,212,0
tra 210,247,50688
mvaa 172,212,4
wl 12
s_add_u32 s90, s90, s97
tra 212,247,49952
mvaa 176,216,0
tra 214,247,50720
cv 194,196
mvaa 184,216,4
wl 12
tra 216,247,49984
v_mov_b32 v234, v245
mvaa 180,220,0
s_sub_u32 s25, s90, 10
tra 218,247,50752
mvaa 188,220,4
wl 12
tra 220,247,50016
ex 199
mvaa 160,224,8
s_min_u32 s90, s90, s25
s_add_u32 m0, s74, 0x3080
tra 222,247,50784
mvaa 168,224,12
wl 12
tra 224,248,0
tra 226,248,768
mvaa 164,228,8
s_lshl_b32 s90, s90, 7
ex 200
mvaa 172,228,12
wl 12
s_add_u32 s89, s90, 0
tra 228,248,32
buffer_load_dwordx4 v232, s[56:59], s89 offen lds
mvaa 176,232,8
tra 230,248,800
cv 195,198
mvaa 184,232,12
wl 12
tra 232,248,64
mvaa 180,236,8
tra 234,248,832
mvaa 188,236,12
wl 12
tra 236,248,96
buffer_load_dwordx4 v233, s[56:59], s89 offen offset:1024 lds
mvaa 160,208,16
tra 238,248,864
ex 201
mvaa 168,208,20
wl 12
tra 208,248,128
tra 210,248,896
mvaa 164,212,16
ex 202
mvaa 172,212,20
wl 12
tra 212,248,160
mvaa 176,216,16
tra 214,248,928
mvaa 184,216,20
wl 12
tra 216,248,192
buffer_load_dwordx4 v234, s[56:59], s89 offen offset:2048 lds
mvaa 180,220,16
tra 218,248,960
cv 200,200
mvaa 188,220,20
wl 12
tra 220,248,224
tra 222,248,992
mvaa 160,224,24
ex 203
mvaa 168,224,28
wl 12
s_add_u32 m0, s74, 0x9180
tra 224,248,256
mvaa 164,228,24
s_add_u32 s89, s90, 0x1e000
tra 226,248,1024
buffer_load_dwordx4 v232, s[56:59], s89 offen lds
mvaa 172,228,28
wl 12
ex 204
mvaa 176,232,24
tra 228,248,288
mvaa 184,232,28
wl 11
tra 230,248,1056
mvaa 180,236,24
tra 232,248,320
cv 201,202
mvaa 188,236,28
wl 11
buffer_load_dwordx4 v233, s[56:59], s89 offen offset:1024 lds
mvaa 160,208,32
tra 234,248,1088
mvaa 168,208,36
wl 10
ex 205
mvaa 164,212,32
tra 236,248,352
mvaa 172,212,36
wl 9
tra 238,248,1120
mvaa 176,216,32
buffer_load_dwordx4 v234, s[56:59], s89 offen offset:2048 lds
mvaa 184,216,36
wl 8
ex 206
mvaa 180,220,32
s_waitcnt vmcnt(18) lgkmcnt(0)
cv 202,204
mvaa 188,220,36
s_barrier
mvaa 160,224,40
tra 208,248,12416
tra 210,248,13184
mvaa 168,224,44
tra 212,248,12448
tra 214,248,13216
mvaa 164,228,40
s_add_u32 m0, s74, 0xc200
tra 216,248,12480
ex 207
mvaa 172,228,44
tra 218,248,13248
tra 220,248,12512
mvaa 176,232,40
buffer_load_dwordx4 v235, s[52:55], s76 offen nt lds
mvaa 184,232,44
tra 222,248,13280
cv 203,206
mvaa 180,236,40
tra 224,248,12544
mvaa 188,236,44
tra 226,248,13312
maav 240,248,192
tra 228,248,12576
maav 244,248,200
wl 9
tra 230,248,13344
mvav 0,208,192
tra 232,248,12608
mvav 8,208,200
wl 9
tra 234,248,13376
mvav 4,212,192
buffer_load_dwordx4 v236, s[52:55], s76 offen offset:1024 nt lds
mvav 12,212,200
wl 8
tra 236,248,12640
v_max3_f32 v251, v208, v209, v210
mvav 16,216,192
tra 238,248,13408
mvav 24,216,200
wl 8
tra 208,248,12672
v_max3_f32 v251, v251, v211, v212
mvav 20,220,192
tra 210,248,13440
mvav 28,220,200
wl 8
tra 212,248,12704
v_max3_f32 v251, v251, v213, v214
mvav 32,224,192
tra 214,248,13472
mvav 40,224,200
wl 8
tra 216,248,12736
v_max3_f32 v251, v251, v215, v216
mvav 36,228,192
buffer_load_dwordx4 v237, s[52:55], s76 offen offset:2048 nt lds
mvav 44,228,200
wl 7
s_add_u32 s76, s76, 0x3000
tra 218,248,13504
mvav 48,232,192
tra 220,248,12768
v_max3_f32 v251, v251, v217, v218
mvav 56,232,200
wl 7
tra 222,248,13536
v_max3_f32 v251, v251, v219, v220
mvav 52,236,192
L_k1_ps14:
s_cbranch_execz L_k1_pst2
mvav 60,236,200
wl 6
rqa 224,243,24832
mvav 64,208,192
rqa 228,243,26368
v_max3_f32 v251, v251, v221, v222
mvav 72,208,200
wl 6
rqa 232,244,24832
v_max_f32 v251, v251, v223
mvav 68,212,192
s_add_u32 m0, s74, 0xf280
rqa 236,244,26368
v_cmp_lt_f32 vcc, s43, v251
mvav 76,212,200
wl 6
s_add_u32 s89, s90, 0x3c000
rqa 208,243,24960
mvav 80,216,192
buffer_load_dwordx4 v232, s[56:59], s89 offen lds
mvav 88,216,200
wl 5
rqa 212,243,26496
mvav 84,220,192
wl 5
rqa 216,244,24960
mvav 92,220,200
s_cbranch_vccnz L_k1_rr_u426
L_k1_rb_u427:
rqa 220,244,26496
cvaa 192,224,160,224
wl 6
ex 208
cvaa 200,224,164,228
s_getpc_b64 s[84:85]
L_k1_pc_u428:
s_and_b32 s84, s84, 0xfffff000
s_lshl_b32 s88, s68, 9
s_add_u32 s88, s88, 0x1000
v_and_b32 v252, 0x3c0, v250
v_lshl_add_u32 v252, v252, 6, s88
v_and_b32 v253, 48, v250
v_lshl_add_u32 v252, v253, 3, v252
v_min_u32 v252, L_k1_codeend-L_k1_pc_u428-4, v252
global_load_dword a253, v252, s[84:85]
cvaa 196,228,160,224
rqa 224,243,25088
cvaa 204,228,164,228
wl 6
rqa 228,243,26624
mvaa 192,232,168
buffer_load_dwordx4 v233, s[56:59], s89 offen offset:1024 lds
mvaa 200,232,172
wl 6
ex 209
mvaa 196,236,168
ex 210
mvaa 204,236,172
wl 5
rqa 232,244,25088
cv 208,208
mvaa 192,208,176
ex 211
mvaa 200,208,180
wl 5
ex 212
mvaa 196,212,176
rqa 236,244,26624
cv 209,210
mvaa 204,212,180
wl 5
buffer_load_dwordx4 v234, s[56:59], s89 offen offset:2048 lds
mvaa 192,216,184
ex 213
mvaa 200,216,188
wl 4
ex 214
mvaa 196,220,184
s_waitcnt vmcnt(19) lgkmcnt(0)
mvaa 204,220,188
s_barrier
mvaa 192,224,192
tra 208,247,0
tra 210,247,768
mvaa 200,224,196
tra 212,247,32
tra 214,247,800
mvaa 196,228,192
s_add_u32 m0, s74, 0x12300
tra 216,247,64
tra 218,247,832
mvaa 204,228,196
tra 220,247,96
tra 222,247,864
mvaa 192,232,200
s_add_u32 s89, s90, 0x5a000
tra 224,247,128
buffer_load_dwordx4 v232, s[56:59], s89 offen lds
mvaa 200,232,204
tra 226,247,896
tra 228,247,160
mvaa 196,236,200
tra 230,247,928
tra 232,247,192
mvaa 204,236,204
wl 11
tra 234,247,960
tra 236,247,224
mvaa 160,208,48
tra 238,247,992
mvaa 168,208,52
wl 12
tra 208,247,256
mvaa 164,212,48
tra 210,247,1024
mvaa 172,212,52
wl 12
tra 212,247,288
cv 210,212
mvaa 176,216,48
tra 214,247,1056
buffer_load_dwordx4 v233, s[56:59], s89 offen offset:1024 lds
mvaa 184,216,52
wl 12
tra 216,247,320
mvaa 180,220,48
tra 218,247,1088
mvaa 188,220,52
wl 12
tra 220,247,352
ex 215
mvaa 160,224,56
tra 222,247,1120
mvaa 168,224,60
wl 12
tra 224,248,37248
tra 226,248,38016
mvaa 164,228,56
ex 216
mvaa 172,228,60
wl 12
tra 228,248,37280
tra 230,248,38048
mvaa 176,232,56
buffer_load_dwordx4 v234, s[56:59], s89 offen offset:2048 lds
mvaa 184,232,60
wl 12
tra 232,248,37312
cv 211,214
mvaa 180,236,56
tra 234,248,38080
mvaa 188,236,60
wl 12
tra 236,248,37344
ex 217
mvaa 160,208,64
tra 238,248,38112
mvaa 168,208,68
wl 12
tra 208,248,37376
tra 210,248,38144
mvaa 164,212,64
s_add_u32 m0, s74, 0x15380
ex 218
mvaa 172,212,68
wl 12
tra 212,248,37408
buffer_load_dwordx4 v235, s[52:55], s76 offen nt lds
mvaa 176,216,64
tra 214,248,38176
mvaa 184,216,68
wl 12
tra 216,248,37440
cv 216,216
mvaa 180,220,64
tra 218,248,38208
mvaa 188,220,68
wl 12
tra 220,248,37472
tra 222,248,38240
mvaa 160,224,72
ex 219
mvaa 168,224,76
wl 12
tra 224,248,37504
mvaa 164,228,72
tra 226,248,38272
mvaa 172,228,76
wl 12
buffer_load_dwordx4 v236, s[52:55], s76 offen offset:1024 nt lds
mvaa 176,232,72
ex 220
mvaa 184,232,76
wl 10
tra 228,248,37536
mvaa 180,236,72
tra 230,248,38304
cv 217,218
mvaa 188,236,76
wl 10
tra 232,248,37568
mvaa 160,208,80
tra 234,248,38336
mvaa 168,208,84
wl 10
ex 221
mvaa 164,212,80
tra 236,248,37600
mvaa 172,212,84
wl 9
tra 238,248,38368
mvaa 176,216,80
buffer_load_dwordx4 v237, s[52:55], s76 offen offset:2048 nt lds
mvaa 184,216,84
wl 8
ex 222
mvaa 180,220,80
s_waitcnt vmcnt(19) lgkmcnt(0)
cv 218,220
mvaa 188,220,84
s_barrier
mvaa 160,224,88
tra 208,248,49664
tra 210,248,50432
mvaa 168,224,92
tra 212,248,49696
tra 214,248,50464
mvaa 164,228,88
s_add_u32 s89, s90, 0x78000
tra 216,248,49728
ex 223
mvaa 172,228,92
s_add_u32 m0, s74, 0
tra 218,248,50496
mvaa 176,232,88
buffer_load_dwordx4 v232, s[56:59], s89 offen lds
mvaa 184,232,92
tra 220,248,49760
cv 219,222
mvaa 180,236,88
tra 222,248,50528
mvaa 188,236,92
tra 224,248,49792
maav 240,248,208
tra 226,248,50560
maav 244,248,216
wl 8
tra 228,248,49824
mvav 0,208,208
tra 230,248,50592
mvav 8,208,216
wl 8
tra 232,248,49856
mvav 4,212,208
buffer_load_dwordx4 v233, s[56:59], s89 offen offset:1024 lds
mvav 12,212,216
wl 7
tra 234,248,50624
v_max3_f32 v251, v192, v193, v194
mvav 16,216,208
tra 236,248,49888
mvav 24,216,216
wl 7
tra 238,248,50656
v_max3_f32 v251, v251, v195, v196
mvav 20,220,208
tra 208,248,49920
mvav 28,220,216
wl 7
tra 210,248,50688
v_max3_f32 v251, v251, v197, v198
mvav 32,224,208
tra 212,248,49952
mvav 40,224,216
wl 7
tra 214,248,50720
v_max3_f32 v251, v251, v199, v200
mvav 36,228,208
buffer_load_dwordx4 v234, s[56:59], s89 offen offset:2048 lds
mvav 44,228,216
wl 6
tra 216,248,49984
v_max3_f32 v251, v251, v201, v202
mvav 48,232,208
tra 218,248,50752
mvav 56,232,216
wl 6
tra 220,248,50016
mvav 52,236,208
tra 222,248,50784
v_max3_f32 v251, v251, v203, v204
mvav 60,236,216
wl 6
rqa 224,241,24832
mvav 64,208,208
rqa 228,241,26368
v_max3_f32 v251, v251, v205, v206
mvav 72,208,216
wl 6
rqa 232,242,24832
v_max_f32 v251, v251, v207
mvav 68,212,208
s_add_u32 m0, s74, 0x18400
rqa 236,242,26368
v_cmp_lt_f32 vcc, s43, v251
mvav 76,212,216
wl 6
s_add_u32 s89, s90, 0x96000
rqa 208,241,24960
mvav 80,216,208
buffer_load_dwordx4 v232, s[56:59], s89 offen lds
mvav 88,216,216
wl 5
rqa 212,241,26496
mvav 84,220,208
wl 5
rqa 216,242,24960
mvav 92,220,216
s_cbranch_vccnz L_k1_rr_u429
L_k1_rb_u430:
cvaa 208,224,160,224
ex 192
cvaa 216,224,164,228
wl 5
rqa 220,242,26496
cvaa 212,228,160,224
buffer_load_dwordx4 v233, s[56:59], s89 offen offset:1024 lds
cvaa 220,228,164,228
wl 5
rqa 224,241,25088
mvaa 208,232,168
ex 193
mvaa 216,232,172
wl 5
rqa 228,241,26624
mvaa 212,236,168
ex 194
mvaa 220,236,172
wl 5
rqa 232,242,25088
cv 192,192
mvaa 208,208,176
ex 195
mvaa 216,208,180
wl 5
ex 196
mvaa 212,212,176
rqa 236,242,26624
cv 193,194
mvaa 220,212,180
wl 5
buffer_load_dwordx4 v234, s[56:59], s89 offen offset:2048 lds
mvaa 208,216,184
ex 197
mvaa 216,216,188
wl 4
ex 198
mvaa 212,220,184
s_waitcnt vmcnt(19) lgkmcnt(0)
mvaa 220,220,188
s_barrier
mvaa 208,224,192
tra 208,247,12416
tra 210,247,13184
mvaa 216,224,196
tra 212,247,12448
tra 214,247,13216
mvaa 212,228,192
s_add_u32 m0, s74, 0x1b480
tra 216,247,12480
tra 218,247,13248
mvaa 220,228,196
tra 220,247,12512
tra 222,247,13280
mvaa 208,232,200
s_mov_b32 s89, 0xb4000
tra 224,247,12544
buffer_load_dwordx4 v238, s[56:59], s89 offen lds
mvaa 216,232,204
tra 226,247,13312
tra 228,247,12576
mvaa 212,236,200
tra 230,247,13344
tra 232,247,12608
mvaa 220,236,204
wl 11
tra 234,247,13376
tra 236,247,12640
zaaa 160,208,96
tra 238,247,13408
zaaa 168,208,100
wl 12
tra 208,247,12672
zaaa 164,212,96
tra 210,247,13440
zaaa 172,212,100
wl 12
tra 212,247,12704
cv 194,196
zaaa 176,216,96
tra 214,247,13472
buffer_load_dwordx4 v239, s[56:59], s89 offen offset:1024 lds
zaaa 184,216,100
wl 12
tra 216,247,12736
zaaa 180,220,96
tra 218,247,13504
zaaa 188,220,100
wl 12
tra 220,247,12768
ex 199
maaa 160,224,104
tra 222,247,13536
maaa 168,224,108
wl 12
tra 224,247,37248
tra 226,247,38016
maaa 164,228,104
ex 200
maaa 172,228,108
wl 12
tra 228,247,37280
tra 230,247,38048
maaa 176,232,104
buffer_load_dwordx4 v240, s[56:59], s89 offen offset:2048 lds
maaa 184,232,108
wl 12
tra 232,247,37312
cv 195,198
maaa 180,236,104
tra 234,247,38080
maaa 188,236,108
wl 12
tra 236,247,37344
ex 201
maaa 160,208,112
tra 238,247,38112
maaa 168,208,116
wl 12
tra 208,247,37376
ex 202
maaa 164,212,112
s_mov_b32 s89, 0xbe000
s_add_u32 m0, s74, 0x6100
tra 210,247,38144
maaa 172,212,116
wl 12
tra 212,247,37408
buffer_load_dwordx4 v238, s[56:59], s89 offen lds
maaa 176,216,112
tra 214,247,38176
maaa 184,216,116
wl 12
tra 216,247,37440
cv 200,200
maaa 180,220,112
tra 218,247,38208
maaa 188,220,116
wl 12
tra 220,247,37472
tra 222,247,38240
maaa 160,224,120
ex 203
maaa 168,224,124
wl 12
tra 224,247,37504
maaa 164,228,120
tra 226,247,38272
maaa 172,228,124
wl 12
buffer_load_dwordx4 v239, s[56:59], s89 offen offset:1024 lds
maaa 176,232,120
ex 204
maaa 184,232,124
wl 10
tra 228,247,37536
maaa 180,236,120
tra 230,247,38304
cv 201,202
maaa 188,236,124
wl 10
tra 232,247,37568
maaa 160,208,128
tra 234,247,38336
maaa 168,208,132
wl 10
ex 205
maaa 164,212,128
tra 236,247,37600
maaa 172,212,132
wl 9
tra 238,247,38368
maaa 176,216,128
buffer_load_dwordx4 v240, s[56:59], s89 offen offset:2048 lds
maaa 184,216,132
wl 8
ex 206
maaa 180,220,128
s_waitcnt vmcnt(15) lgkmcnt(0)
cv 202,204
maaa 188,220,132
s_barrier
maaa 160,224,136
tra 208,247,49664
tra 210,247,50432
maaa 168,224,140
tra 212,247,49696
tra 214,247,50464
maaa 164,228,136
tra 216,247,49728
ex 207
maaa 172,228,140
tra 218,247,50496
cv 203,206
maaa 176,232,136
s_mov_b32 s89, 0xc8000
s_add_u32 m0, s74, 0x3080
tra 220,247,49760
maaa 184,232,140
tra 222,247,50528
buffer_load_dwordx4 v238, s[56:59], s89 offen lds
maaa 180,236,136
tra 224,247,49792
tra 226,247,50560
maaa 188,236,140
tra 228,247,49824
tra 230,247,50592
maav 240,248,192
tra 232,247,49856
tra 234,247,50624
maav 244,248,200
wl 12
tra 236,247,49888
mvav 0,208,192
tra 238,247,50656
mvav 8,208,200
wl 12
tra 208,247,49920
mvav 4,212,192
tra 210,247,50688
mvav 12,212,200
wl 12
tra 212,247,49952
v_max3_f32 v251, v208, v209, v210
mvav 16,216,192
tra 214,247,50720
buffer_load_dwordx4 v239, s[56:59], s89 offen offset:1024 lds
mvav 24,216,200
wl 12
tra 216,247,49984
v_max3_f32 v251, v251, v211, v212
mvav 20,220,192
tra 218,247,50752
mvav 28,220,200
wl 12
tra 220,247,50016
v_max3_f32 v251, v251, v213, v214
mvav 32,224,192
tra 222,247,50784
mvav 40,224,200
wl 12
tra 224,248,0
v_max3_f32 v251, v251, v215, v216
mvav 36,228,192
tra 226,248,768
mvav 44,228,200
wl 12
tra 228,248,32
v_max3_f32 v251, v251, v217, v218
mvav 48,232,192
tra 230,248,800
mvav 56,232,200
wl 12
tra 232,248,64
buffer_load_dwordx4 v240, s[56:59], s89 offen offset:2048 lds
mvav 52,236,192
L_k1_ps15:
s_cbranch_execz L_k1_pst3
tra 234,248,832
mvav 60,236,200
wl 12
tra 236,248,96
v_max3_f32 v251, v251, v219, v220
mvav 64,208,192
tra 238,248,864
v_max3_f32 v251, v251, v221, v222
mvav 72,208,200
wl 12
tra 208,248,128
mvav 68,212,192
tra 210,248,896
v_max_f32 v251, v251, v223
mvav 76,212,200
wl 12
tra 212,248,160
mvav 80,216,192
s_add_u32 m0, s74, 0x9180
tra 214,248,928
v_cmp_lt_f32 vcc, s43, v251
mvav 88,216,200
wl 12
s_mov_b32 s89, 0xd2000
tra 216,248,192
mvav 84,220,192
wl 11
tra 218,248,960
buffer_load_dwordx4 v238, s[56:59], s89 offen lds
mvav 92,220,200
s_cbranch_vccnz L_k1_rr_u431
L_k1_rb_u432:
tra 220,248,224
maaa 160,224,0
tra 222,248,992
maaa 168,224,4
wl 12
tra 224,248,256
ex 208
maaa 164,228,0
tra 226,248,1024
maaa 172,228,4
wl 12
tra 228,248,288
ex 209
maaa 176,232,0
tra 230,248,1056
maaa 184,232,4
wl 12
tra 232,248,320
ex 210
maaa 180,236,0
tra 234,248,1088
cv 208,208
maaa 188,236,4
wl 12
tra 236,248,352
buffer_load_dwordx4 v239, s[56:59], s89 offen offset:1024 lds
maaa 160,208,8
rqv 192,246,0
maaa 168,208,12
wl 12
tra 238,248,1120
ex 211
maaa 164,212,8
tra 208,248,12416
tra 210,248,13184
maaa 172,212,12
wl 13
tra 212,248,12448
ex 212
maaa 176,216,8
tra 214,248,13216
cv 209,210
maaa 184,216,12
wl 13
tra 216,248,12480
tra 218,248,13248
maaa 180,220,8
ex 213
maaa 188,220,12
wl 13
tra 220,248,12512
tra 222,248,13280
maaa 160,224,16
buffer_load_dwordx4 v240, s[56:59], s89 offen offset:2048 lds
maaa 168,224,20
wl 13
tra 224,248,12544
ex 214
maaa 164,228,16
tra 226,248,13312
cv 210,212
maaa 172,228,20
wl 13
rqv 196,246,1024
maaa 176,232,16
tra 228,248,12576
ex 215
maaa 184,232,20
wl 12
tra 230,248,13344
tra 232,248,12608
maaa 180,236,16
tra 234,248,13376
ex 216
maaa 188,236,20
wl 13
tra 236,248,12640
maaa 160,208,24
tra 238,248,13408
cv 211,214
maaa 168,208,28
wl 13
tra 208,248,12672
s_lshl_b32 s88, s71, 2
s_add_u32 s88, s88, s68
s_mul_i32 s81, s88, 0x3c00
v_lshlrev_b32 v252, 3, v250
s_mov_b32 s58, 0xf0000
buffer_load_dword a254, v252, s[56:59], s81 offen
maaa 164,212,24
tra 210,248,13440
ex 217
maaa 172,212,28
wl 13
rqv 200,246,2048
maaa 176,216,24
tra 212,248,12704
ex 218
maaa 184,216,28
wl 13
tra 214,248,13472
cv 216,216
maaa 180,220,24
tra 216,248,12736
ex 219
maaa 188,220,28
wl 13
tra 218,248,13504
ex 220
maaa 160,224,32
tra 220,248,12768
cv 217,218
maaa 168,224,36
wl 12
ex 221
maaa 164,228,32
ex 222
maaa 172,228,36
wl 10
tra 222,248,13536
cv 218,220
maaa 176,232,32
s_add_u32 s81, s81, 0x1c00
v_lshlrev_b32 v252, 3, v250
buffer_load_dword a253, v252, s[56:59], s81 offen
maaa 184,232,36
wl 9
ex 223
maaa 180,236,32
s_mov_b64 exec, 0
s_cmp_eq_u32 s68, 1
s_cbranch_scc1 L_k1_ps17
s_cmp_eq_u32 s68, 2
s_cbranch_scc1 L_k1_ps18
s_cmp_eq_u32 s68, 3
s_cbranch_scc1 L_k1_ps19
s_branch L_k1_ps16
L_k1_pr2:
s_mov_b64 exec, -1
s_waitcnt vmcnt(14) lgkmcnt(0)
maaa 188,236,36
s_barrier
maaa 160,208,40
tra 224,248,24832
tra 226,248,25600
maaa 168,208,44
tra 228,248,24864
tra 230,248,25632
maaa 164,212,40
rqv 204,246,3072
maaa 172,212,44
s_add_u32 m0, s74, 0xc200
tra 232,248,24896
maaa 176,216,40
s_mov_b32 s89, 0xdc000
tra 234,248,25664
buffer_load_dwordx4 v238, s[56:59], s89 offen lds
maaa 184,216,44
tra 236,248,24928
cv 219,222
maaa 180,220,40
tra 238,248,25696
tra 208,248,24960
maaa 188,220,44
tra 210,248,25728
tra 212,248,24992
maav 240,248,208
tra 214,248,25760
tra 216,248,25024
maav 244,248,216
wl 12
tra 218,248,25792
tra 220,248,25056
mvav 0,224,208
tra 222,248,25824
mvav 8,224,216
wl 13
tra 224,248,25088
tra 226,248,25856
mvav 4,228,208
buffer_load_dwordx4 v239, s[56:59], s89 offen offset:1024 lds
mvav 12,228,216
wl 12
tra 228,248,25120
mvav 16,232,208
tra 230,248,25888
v_accvgpr_read_b32 v254, a240
mvav 24,232,216
wl 12
tra 232,248,25152
v_accvgpr_read_b32 v255, a244
mvav 20,236,208
tra 234,248,25920
v_rcp_f32 v254, v254
mvav 28,236,216
wl 12
tra 236,248,25184
v_rcp_f32 v255, v255
mvav 32,208,208
tra 238,248,25952
v_mul_f32 v0, v0, v254
mvav 40,208,216
wl 12
tra 208,247,0
v_mul_f32 v1, v1, v254
mvav 36,212,208
tra 210,247,768
buffer_load_dwordx4 v240, s[56:59], s89 offen offset:2048 lds
mvav 44,212,216
wl 12
tra 212,247,32
v_mul_f32 v2, v2, v254
mvav 48,216,208
tra 214,247,800
v_mul_f32 v3, v3, v254
mvav 56,216,216
wl 12
tra 216,247,64
v_mul_f32 v4, v4, v254
mvav 52,220,208
tra 218,247,832
v_mul_f32 v5, v5, v254
mvav 60,220,216
wl 12
tra 220,247,96
v_mul_f32 v6, v6, v254
mvav 64,224,208
tra 222,247,864
v_mul_f32 v7, v7, v254
mvav 72,224,216
wl 12
s_add_u32 m0, s74, 0xf280
tra 224,247,128
mvav 68,228,208
s_mov_b32 s89, 0xe6000
tra 226,247,896
buffer_load_dwordx4 v238, s[56:59], s89 offen lds
mvav 76,228,216
wl 12
tra 228,247,160
cv 0,0
mvav 80,232,208
tra 230,247,928
cv 1,2
mvav 88,232,216
wl 12
tra 232,247,192
cv 2,4
mvav 84,236,208
tra 234,247,960
cv 3,6
mvav 92,236,216
wl 12
tra 236,247,224
v_mul_f32 v8, v8, v255
maaa 160,208,48
tra 238,247,992
v_mul_f32 v9, v9, v255
maaa 168,208,52
wl 12
tra 208,247,256
v_lshrrev_b32 v252, 2, v250
v_min_u32 v252, 60, v252
v_mov_b32 v253, 0
buffer_store_dword v253, v252, s[60:63], s12 offen sc1
maaa 164,212,48
tra 210,247,1024
v_mul_f32 v10, v10, v255
maaa 172,212,52
wl 12
rqv 208,246,4096
v_mul_f32 v11, v11, v255
maaa 176,216,48
buffer_load_dwordx4 v239, s[56:59], s89 offen offset:1024 lds
rqv 212,246,5120
maaa 184,216,52
wl 12
tra 212,247,288
tra 214,247,1056
maaa 180,220,48
rqv 216,246,6144
v_mul_f32 v12, v12, v255
maaa 188,220,52
wl 13
rqv 220,246,7168
v_mul_f32 v13, v13, v255
maaa 160,224,56
tra 216,247,320
v_mul_f32 v14, v14, v255
maaa 168,224,60
wl 13
tra 218,247,1088
v_mul_f32 v15, v15, v255
maaa 164,228,56
tra 220,247,352
cv 8,8
maaa 172,228,60
wl 13
tra 222,247,1120
buffer_load_dwordx4 v240, s[56:59], s89 offen offset:2048 lds
maaa 176,232,56
tra 224,248,37248
cv 9,10
maaa 184,232,60
wl 13
tra 226,248,38016
cv 10,12
maaa 180,236,56
tra 228,248,37280
cv 11,14
maaa 188,236,60
wl 13
tra 230,248,38048
v_mul_f32 v16, v16, v254
maaa 160,208,64
tra 232,248,37312
v_mul_f32 v17, v17, v254
maaa 168,208,68
wl 11
tra 234,248,38080
v_mul_f32 v18, v18, v254
maaa 164,212,64
s_add_u32 s89, s90, 0xb4000
s_add_u32 m0, s74, 0x12300
tra 236,248,37344
maaa 172,212,68
wl 9
tra 238,248,38112
buffer_load_dwordx4 v232, s[56:59], s89 offen lds
maaa 176,216,64
tra 208,248,37376
v_mul_f32 v19, v19, v254
maaa 184,216,68
wl 9
tra 210,248,38144
v_mul_f32 v20, v20, v254
maaa 180,220,64
tra 212,248,37408
v_mul_f32 v21, v21, v254
maaa 188,220,68
wl 9
tra 214,248,38176
v_mul_f32 v22, v22, v254
maaa 160,224,72
tra 216,248,37440
v_mul_f32 v23, v23, v254
maaa 168,224,76
wl 9
tra 218,248,38208
cv 16,16
maaa 164,228,72
tra 220,248,37472
cv 17,18
maaa 172,228,76
wl 9
tra 222,248,38240
buffer_load_dwordx4 v233, s[56:59], s89 offen offset:1024 lds
maaa 176,232,72
tra 224,248,37504
cv 18,20
maaa 184,232,76
wl 9
tra 226,248,38272
cv 19,22
maaa 180,236,72
tra 228,248,37536
v_mul_f32 v24, v24, v255
maaa 188,236,76
wl 9
tra 230,248,38304
v_mul_f32 v25, v25, v255
maaa 160,208,80
tra 232,248,37568
v_mul_f32 v26, v26, v255
maaa 168,208,84
wl 9
tra 234,248,38336
v_mul_f32 v27, v27, v255
maaa 164,212,80
tra 236,248,37600
v_mul_f32 v28, v28, v255
maaa 172,212,84
wl 9
tra 238,248,38368
v_mul_f32 v29, v29, v255
maaa 176,216,80
buffer_load_dwordx4 v234, s[56:59], s89 offen offset:2048 lds
maaa 184,216,84
wl 8
v_mul_f32 v30, v30, v255
v_mul_f32 v31, v31, v255
maaa 180,220,80
s_waitcnt vmcnt(15) lgkmcnt(0)
cv 24,24
maaa 188,220,84
s_barrier
maaa 160,224,88
s_add_u32 s89, s90, 0xd2000
tra 208,248,49664
tra 210,248,50432
tra 212,248,49696
tra 214,248,50464
tra 216,248,49728
maaa 168,224,92
s_add_u32 m0, s74, 0x1e500
tra 218,248,50496
buffer_load_dwordx4 v232, s[56:59], s89 offen lds
maaa 164,228,88
s_add_u32 s90, s70, 3
tra 220,248,49760
cv 25,26
maaa 172,228,92
tra 222,248,50528
cv 26,28
maaa 176,232,88
s_and_b32 s90, s90, 7
tra 224,248,49792
buffer_load_dwordx4 v233, s[56:59], s89 offen offset:1024 lds
maaa 184,232,92
tra 226,248,50560
cv 27,30
maaa 180,236,88
s_add_u32 s90, s90, s97
tra 228,248,49824
v_mul_f32 v32, v32, v254
maaa 188,236,92
wl 9
tra 230,248,50592
v_mul_f32 v33, v33, v254
mvav 96,208,0
tra 232,248,49856
v_mul_f32 v34, v34, v254
mvav 104,208,8
wl 9
s_sub_u32 s25, s90, 10
tra 234,248,50624
mvav 100,212,0
s_min_u32 s90, s90, s25
tra 236,248,49888
buffer_load_dwordx4 v234, s[56:59], s89 offen offset:2048 lds
v_mul_f32 v35, v35, v254
mvav 108,212,8
wl 9
tra 238,248,50656
v_mul_f32 v36, v36, v254
mvav 112,216,0
s_lshl_b32 s90, s90, 7
tra 208,248,49920
v_mul_f32 v37, v37, v254
mvav 120,216,8
wl 9
s_add_u32 m0, s74, 0x21580
tra 210,248,50688
mvav 116,220,0
s_add_u32 s89, s90, 0xb4000
tra 212,248,49952
buffer_load_dwordx4 v232, s[56:59], s89 offen lds
v_mul_f32 v38, v38, v254
mvav 124,220,8
wl 9
tra 214,248,50720
v_mul_f32 v39, v39, v254
mvav 128,224,0
tra 216,248,49984
cv 32,32
mvav 136,224,8
wl 9
tra 218,248,50752
cv 33,34
mvav 132,228,0
tra 220,248,50016
buffer_load_dwordx4 v233, s[56:59], s89 offen offset:1024 lds
mvav 140,228,8
wl 9
tra 222,248,50784
cv 34,36
mvav 144,232,0
tra 224,247,24832
cv 35,38
mvav 152,232,8
wl 9
tra 226,247,25600
v_mul_f32 v40, v40, v255
mvav 148,236,0
tra 228,247,24864
buffer_load_dwordx4 v234, s[56:59], s89 offen offset:2048 lds
mvav 156,236,8
wl 9
tra 230,247,25632
v_mul_f32 v41, v41, v255
mvav 192,208,0
wl 8
tra 232,247,24896
v_mul_f32 v42, v42, v255
mvav 200,208,8
s_add_u32 m0, s74, 0x24600
tra 234,247,25664
v_mul_f32 v43, v43, v255
mvav 196,212,0
s_add_u32 s89, s90, 0xd2000
tra 236,247,24928
buffer_load_dwordx4 v232, s[56:59], s89 offen lds
v_mul_f32 v44, v44, v255
mvav 204,212,8
wl 9
tra 238,247,25696
v_mul_f32 v45, v45, v255
mvav 208,216,0
s_add_u32 s90, s70, 4
tra 208,247,24960
v_mul_f32 v46, v46, v255
mvav 216,216,8
wl 9
s_and_b32 s90, s90, 7
tra 210,247,25728
mvav 212,220,0
wl 8
tra 212,247,24992
buffer_load_dwordx4 v233, s[56:59], s89 offen offset:1024 lds
v_mul_f32 v47, v47, v255
mvav 220,220,8
s_add_u32 s90, s90, s97
tra 214,247,25760
cv 40,40
mvav 96,224,16
s_sub_u32 s25, s90, 10
tra 216,247,25024
cv 41,42
mvav 104,224,24
wl 9
s_min_u32 s90, s90, s25
tra 218,247,25792
mvav 100,228,16
wl 8
tra 220,247,25056
buffer_load_dwordx4 v234, s[56:59], s89 offen offset:2048 lds
cv 42,44
mvav 108,228,24
s_lshl_b32 s90, s90, 7
tra 222,247,25824
cv 43,46
mvav 112,232,16
s_add_u32 s89, s90, 0
tra 224,247,25088
v_mul_f32 v48, v48, v254
mvav 120,232,24
wl 9
s_add_u32 m0, s74, 0x15380
tra 226,247,25856
buffer_load_dwordx4 v232, s[56:59], s89 offen lds
mvav 116,236,16
tra 228,247,25120
v_mul_f32 v49, v49, v254
mvav 124,236,24
wl 9
tra 230,247,25888
v_mul_f32 v50, v50, v254
mvav 128,208,16
tra 232,247,25152
v_mul_f32 v51, v51, v254
mvav 136,208,24
wl 9
tra 234,247,25920
buffer_load_dwordx4 v233, s[56:59], s89 offen offset:1024 lds
v_mul_f32 v52, v52, v254
mvav 132,212,16
tra 236,247,25184
v_mul_f32 v53, v53, v254
mvav 140,212,24
wl 9
tra 238,247,25952
v_mul_f32 v54, v54, v254
mvav 144,216,16
L_k1_ps16:
s_cbranch_execz L_k1_ps20
tra 208,247,12416
mvav 152,216,24
wl 9
tra 210,247,13184
buffer_load_dwordx4 v234, s[56:59], s89 offen offset:2048 lds
v_mul_f32 v55, v55, v254
mvav 148,220,16
tra 212,247,12448
cv 48,48
mvav 156,220,24
wl 9
tra 214,247,13216
cv 49,50
mvav 192,224,16
s_add_u32 s89, s90, 0x1e000
s_add_u32 m0, s74, 0
tra 216,247,12480
mvav 200,224,24
wl 9
tra 218,247,13248
buffer_load_dwordx4 v232, s[56:59], s89 offen lds
cv 50,52
mvav 196,228,16
tra 220,247,12512
cv 51,54
mvav 204,228,24
wl 9
tra 222,247,13280
v_mul_f32 v56, v56, v255
mvav 208,232,16
tra 224,247,12544
v_mul_f32 v57, v57, v255
mvav 216,232,24
wl 9
tra 226,247,13312
buffer_load_dwordx4 v233, s[56:59], s89 offen offset:1024 lds
mvav 212,236,16
tra 228,247,12576
v_mul_f32 v58, v58, v255
mvav 220,236,24
wl 9
tra 230,247,13344
v_mul_f32 v59, v59, v255
mvav 96,208,32
tra 232,247,12608
v_mul_f32 v60, v60, v255
mvav 104,208,40
wl 9
tra 234,247,13376
buffer_load_dwordx4 v234, s[56:59], s89 offen offset:2048 lds
mvav 100,212,32
s_add_u32 s89, s90, 0x3c000
tra 236,247,12640
v_mul_f32 v61, v61, v255
mvav 108,212,40
wl 9
tra 238,247,13408
v_mul_f32 v62, v62, v255
mvav 112,216,32
s_add_u32 m0, s74, 0x18400
tra 208,247,12672
v_mul_f32 v63, v63, v255
mvav 120,216,40
wl 9
tra 210,247,13440
buffer_load_dwordx4 v232, s[56:59], s89 offen lds
mvav 116,220,32
tra 212,247,12704
cv 56,56
mvav 124,220,40
wl 9
tra 214,247,13472
cv 57,58
mvav 128,224,32
tra 216,247,12736
cv 58,60
mvav 136,224,40
wl 9
tra 218,247,13504
buffer_load_dwordx4 v233, s[56:59], s89 offen offset:1024 lds
mvav 132,228,32
tra 220,247,12768
cv 59,62
mvav 140,228,40
wl 9
tra 222,247,13536
v_mul_f32 v64, v64, v254
mvav 144,232,32
v_mul_f32 v65, v65, v254
v_mul_f32 v66, v66, v254
mvav 152,232,40
wl 8
buffer_load_dwordx4 v234, s[56:59], s89 offen offset:2048 lds
mvav 148,236,32
s_waitcnt vmcnt(21) lgkmcnt(0)
v_mul_f32 v67, v67, v254
mvav 156,236,40
s_barrier
v_mul_f32 v68, v68, v254
mvav 192,208,32
tra 224,247,37248
tra 226,247,38016
mvav 200,208,40
tra 228,247,37280
v_mul_f32 v69, v69, v254
mvav 196,212,32
s_add_u32 m0, s74, 0x1b480
tra 230,247,38048
v_mul_f32 v70, v70, v254
mvav 204,212,40
tra 232,247,37312
tra 234,247,38080
mvav 208,216,32
s_add_u32 s89, s90, 0x5a000
tra 236,247,37344
buffer_load_dwordx4 v232, s[56:59], s89 offen lds
mvav 216,216,40
tra 238,247,38112
v_mul_f32 v71, v71, v254
mvav 212,220,32
tra 208,247,37376
cv 64,64
mvav 220,220,40
wl 7
tra 210,247,38144
cv 65,66
mvav 96,224,48
tra 212,247,37408
cv 66,68
mvav 104,224,56
wl 7
tra 214,247,38176
cv 67,70
mvav 100,228,48
tra 216,247,37440
v_mul_f32 v72, v72, v255
mvav 108,228,56
wl 7
tra 218,247,38208
v_mul_f32 v73, v73, v255
mvav 112,232,48
tra 220,247,37472
buffer_load_dwordx4 v233, s[56:59], s89 offen offset:1024 lds
mvav 120,232,56
wl 7
tra 222,247,38240
v_mul_f32 v74, v74, v255
mvav 116,236,48
tra 224,247,37504
v_mul_f32 v75, v75, v255
mvav 124,236,56
wl 7
tra 226,247,38272
v_mul_f32 v76, v76, v255
mvav 128,208,48
tra 228,247,37536
v_mul_f32 v77, v77, v255
mvav 136,208,56
wl 7
tra 230,247,38304
v_mul_f32 v78, v78, v255
mvav 132,212,48
tra 232,247,37568
v_mul_f32 v79, v79, v255
mvav 140,212,56
wl 7
tra 234,247,38336
cv 72,72
mvav 144,216,48
tra 236,247,37600
buffer_load_dwordx4 v234, s[56:59], s89 offen offset:2048 lds
mvav 152,216,56
wl 7
tra 238,247,38368
cv 73,74
mvav 148,220,48
tra 208,247,49664
cv 74,76
mvav 156,220,56
wl 7
tra 210,247,50432
cv 75,78
mvav 192,224,48
tra 212,247,49696
v_mul_f32 v80, v80, v254
mvav 200,224,56
wl 7
tra 214,247,50464
v_mul_f32 v81, v81, v254
mvav 196,228,48
tra 216,247,49728
v_mul_f32 v82, v82, v254
mvav 204,228,56
wl 7
s_add_u32 m0, s74, 0x6100
tra 218,247,50496
mvav 208,232,48
s_add_u32 s89, s90, 0x78000
tra 220,247,49760
buffer_load_dwordx4 v232, s[56:59], s89 offen lds
mvav 216,232,56
wl 7
tra 222,247,50528
v_mul_f32 v83, v83, v254
mvav 212,236,48
tra 224,247,49792
v_mul_f32 v84, v84, v254
mvav 220,236,56
wl 7
tra 226,247,50560
v_mul_f32 v85, v85, v254
mvav 96,208,64
tra 228,247,49824
v_mul_f32 v86, v86, v254
mvav 104,208,72
wl 7
tra 230,247,50592
v_mul_f32 v87, v87, v254
mvav 100,212,64
tra 232,247,49856
cv 80,80
mvav 108,212,72
wl 7
tra 234,247,50624
buffer_load_dwordx4 v233, s[56:59], s89 offen offset:1024 lds
mvav 112,216,64
tra 236,247,49888
cv 81,82
mvav 120,216,72
wl 7
tra 238,247,50656
cv 82,84
mvav 116,220,64
tra 208,247,49920
cv 83,86
mvav 124,220,72
wl 7
tra 210,247,50688
v_mul_f32 v88, v88, v255
mvav 128,224,64
tra 212,247,49952
v_mul_f32 v89, v89, v255
mvav 136,224,72
wl 7
tra 214,247,50720
v_mul_f32 v90, v90, v255
mvav 132,228,64
tra 216,247,49984
v_mul_f32 v91, v91, v255
mvav 140,228,72
wl 7
tra 218,247,50752
buffer_load_dwordx4 v234, s[56:59], s89 offen offset:2048 lds
mvav 144,232,64
tra 220,247,50016
v_mul_f32 v92, v92, v255
mvav 152,232,72
wl 7
tra 222,247,50784
v_mul_f32 v93, v93, v255
mvav 148,236,64
tra 224,248,0
v_mul_f32 v94, v94, v255
mvav 156,236,72
wl 7
tra 226,248,768
v_mul_f32 v95, v95, v255
mvav 192,208,64
tra 228,248,32
cv 88,88
mvav 200,208,72
wl 7
tra 230,248,800
cv 89,90
mvav 196,212,64
s_add_u32 s89, s90, 0x96000
s_add_u32 m0, s74, 0x3080
tra 232,248,64
mvav 204,212,72
wl 7
tra 234,248,832
buffer_load_dwordx4 v232, s[56:59], s89 offen lds
mvav 208,216,64
tra 236,248,96
cv 90,92
mvav 216,216,72
wl 7
tra 238,248,864
cv 91,94
mvav 212,220,64
tra 208,248,128
tra 210,248,896
mvav 220,220,72
wl 8
tra 212,248,160
tra 214,248,928
mvav 96,224,80
tra 216,248,192
tra 218,248,960
mvav 104,224,88
wl 10
tra 220,248,224
mvav 100,228,80
tra 222,248,992
mvav 108,228,88
wl 10
buffer_load_dwordx4 v233, s[56:59], s89 offen offset:1024 lds
mvav 112,232,80
tra 224,248,256
mvav 120,232,88
wl 9
tra 226,248,1024
mvav 116,236,80
tra 228,248,288
mvav 124,236,88
wl 9
tra 230,248,1056
mvav 128,208,80
tra 232,248,320
mvav 136,208,88
wl 9
tra 234,248,1088
mvav 132,212,80
tra 236,248,352
mvav 140,212,88
wl 9
tra 238,248,1120
mvav 144,216,80
buffer_load_dwordx4 v234, s[56:59], s89 offen offset:2048 lds
mvav 152,216,88
wl 8
mvav 148,220,80
s_waitcnt vmcnt(21) lgkmcnt(0)
mvav 156,220,88
s_barrier
mvav 192,224,80
s_lshl_b32 s88, 1, s70
v_mov_b32 v253, s88
s_cmp_eq_u32 s68, 0
s_cselect_b64 exec, 1, 0
buffer_atomic_or v253, off, s[4:7], s14 sc1
s_mov_b64 exec, -1
mvav 200,224,88
tra 208,248,12416
tra 210,248,13184
mvav 196,228,80
s_add_u32 m0, s74, 0x9180
tra 212,248,12448
tra 214,248,13216
mvav 204,228,88
tra 216,248,12480
tra 218,248,13248
mvav 208,232,80
s_add_u32 s89, s90, 0xb4000
tra 220,248,12512
buffer_load_dwordx4 v232, s[56:59], s89 offen lds
mvav 216,232,88
tra 222,248,13280
tra 224,248,12544
mvav 212,236,80
tra 226,248,13312
tra 228,248,12576
mvav 220,236,88
wl 9
tra 230,248,13344
tra 232,248,12608
maav 160,208,0
tra 234,248,13376
tra 236,248,12640
maav 168,208,8
wl 11
tra 238,248,13408
tra 208,248,12672
maav 164,212,0
tra 210,248,13440
maav 172,212,8
wl 12
tra 212,248,12704
tra 214,248,13472
maav 176,216,0
buffer_load_dwordx4 v233, s[56:59], s89 offen offset:1024 lds
maav 184,216,8
wl 12
s_add_u32 s91, s10, 0
tra 216,248,12736
maav 180,220,0
tra 218,248,13504
maav 188,220,8
wl 12
tra 220,248,12768
maav 160,224,16
tra 222,248,13536
cv 96,96
maav 168,224,24
wl 12
tra 224,249,0
maav 164,228,16
tra 226,249,768
maav 172,228,24
wl 12
tra 228,249,32
cv 97,98
maav 176,232,16
tra 230,249,800
buffer_load_dwordx4 v234, s[56:59], s89 offen offset:2048 lds
maav 184,232,24
wl 12
tra 232,249,64
maav 180,236,16
tra 234,249,832
cv 98,104
maav 188,236,24
wl 12
tra 236,249,96
maav 160,208,32
tra 238,249,864
cv 99,106
maav 168,208,40
wl 12
tra 208,249,128
buffer_store_dwordx4 v[96:99], v250, s[60:63], s91 offen sc1
maav 164,212,32
tra 210,249,896
maav 172,212,40
wl 12
s_add_u32 m0, s74, 0xc200
tra 212,249,160
maav 176,216,32
s_add_u32 s89, s90, 0xd2000
tra 214,249,928
buffer_load_dwordx4 v232, s[56:59], s89 offen lds
maav 184,216,40
wl 12
tra 216,249,192
maav 180,220,32
s_add_u32 s91, s10, 0x25000
tra 218,249,960
maav 188,220,40
wl 12
tra 220,249,224
maav 160,224,48
tra 222,249,992
maav 168,224,56
wl 12
tra 224,249,256
cv 100,100
maav 164,228,48
tra 226,249,1024
v_bfe_u32 v252, v250, 8, 2
maav 172,228,56
wl 12
tra 228,249,288
buffer_load_dwordx4 v233, s[56:59], s89 offen offset:1024 lds
maav 176,232,48
tra 230,249,1056
cv 101,102
maav 184,232,56
wl 12
tra 232,249,320
maav 180,236,48
s_add_u32 s90, s70, 5
tra 234,249,1088
maav 188,236,56
wl 12
tra 236,249,352
cv 102,108
maav 160,208,64
tra 238,249,1120
v_bfe_u32 v251, v250, 6, 2
maav 168,208,72
wl 12
s_and_b32 s90, s90, 7
tra 208,249,12416
maav 164,212,64
tra 210,249,13184
cv 103,110
maav 172,212,72
wl 12
tra 212,249,12448
buffer_load_dwordx4 v234, s[56:59], s89 offen offset:2048 lds
maav 176,216,64
s_add_u32 s90, s90, s97
tra 214,249,13216
maav 184,216,72
wl 12
tra 216,249,12480
v_cmp_eq_u32 vcc, v252, v251
maav 180,220,64
s_sub_u32 s25, s90, 10
tra 218,249,13248
buffer_store_dwordx4 v[100:103], v250, s[60:63], s91 offen sc1
maav 188,220,72
wl 12
s_add_u32 s91, s10, 0x4a000
tra 220,249,12512
maav 160,224,80
s_min_u32 s90, s90, s25
tra 222,249,13280
v_and_b32 v252, 16, v250
maav 168,224,88
wl 12
s_add_u32 m0, s74, 0xf280
tra 224,249,12544
maav 164,228,80
s_lshl_b32 s90, s90, 7
s_add_u32 s89, s90, 0
tra 226,249,13312
maav 172,228,88
wl 12
buffer_load_dwordx4 v232, s[56:59], s89 offen lds
maav 176,232,80
tra 228,249,12576
cv 112,112
maav 184,232,88
wl 11
tra 230,249,13344
cv 113,114
maav 180,236,80
tra 232,249,12608
maav 188,236,88
wl 11
tra 234,249,13376
v_mov_b32 v251, 0x3f80
mvav 160,208,0
tra 236,249,12640
cv 114,120
mvav 168,208,8
wl 11
tra 238,249,13408
mvav 164,212,0
tra 208,249,12672
cv 115,122
mvav 172,212,8
wl 11
buffer_load_dwordx4 v233, s[56:59], s89 offen offset:1024 lds
mvav 176,216,0
tra 210,249,13440
v_lshlrev_b32 v252, v252, v251
mvav 184,216,8
wl 10
tra 212,249,12704
mvav 180,220,0
buffer_store_dwordx4 v[112:115], v250, s[60:63], s91 offen sc1
mvav 188,220,8
wl 9
tra 214,249,13472
v_cndmask_b32 v252, 0, v252, vcc
mvav 160,224,16
s_add_u32 s91, s10, 0x6f000
tra 216,249,12736
cv 116,116
mvav 168,224,24
wl 9
tra 218,249,13504
cv 117,118
mvav 164,228,16
tra 220,249,12768
cv 118,124
mvav 172,228,24
wl 9
tra 222,249,13536
cv 119,126
mvav 176,232,16
buffer_load_dwordx4 v234, s[56:59], s89 offen offset:2048 lds
mvav 184,232,24
wl 8
buffer_store_dwordx4 v[116:119], v250, s[60:63], s91 offen sc1
mvav 180,236,16
s_waitcnt vmcnt(25) lgkmcnt(0)
v_and_b32 v251, 32, v250
mvav 188,236,24
s_barrier
mvav 160,208,32
tra 224,249,24832
tra 226,249,25600
mvav 168,208,40
tra 228,249,24864
tra 230,249,25632
mvav 164,212,32
s_add_u32 m0, s74, 0x12300
tra 232,249,24896
tra 234,249,25664
mvav 172,212,40
L_k1_ps17:
s_cbranch_execz L_k1_ps21
tra 236,249,24928
mvav 176,216,32
s_add_u32 s89, s90, 0x1e000
tra 238,249,25696
buffer_load_dwordx4 v232, s[56:59], s89 offen lds
mvav 184,216,40
tra 208,249,24960
v_cmp_eq_u32 vcc, 0, v251
mvav 180,220,32
tra 210,249,25728
tra 212,249,24992
mvav 188,220,40
wl 9
tra 214,249,25760
tra 216,249,25024
mvav 160,224,48
tra 218,249,25792
v_cndmask_b32 v251, 0, v252, vcc
mvav 168,224,56
wl 10
tra 220,249,25056
tra 222,249,25824
mvav 164,228,48
s_add_u32 s91, s10, 0x94000
tra 224,249,25088
tra 226,249,25856
mvav 172,228,56
wl 12
tra 228,249,25120
tra 230,249,25888
mvav 176,232,48
buffer_load_dwordx4 v233, s[56:59], s89 offen offset:1024 lds
mvav 184,232,56
wl 12
tra 232,249,25152
cv 128,128
mvav 180,236,48
tra 234,249,25920
v_sub_u32 v252, v252, v251
mvav 188,236,56
wl 12
tra 236,249,25184
cv 129,130
mvav 160,208,64
tra 238,249,25952
mvav 168,208,72
wl 12
tra 208,248,24832
mvav 164,212,64
tra 210,248,25600
cv 130,136
mvav 172,212,72
wl 12
tra 212,248,24864
v_accvgpr_write_b32 a242, v251
mvav 176,216,64
tra 214,248,25632
buffer_load_dwordx4 v234, s[56:59], s89 offen offset:2048 lds
mvav 184,216,72
wl 12
tra 216,248,24896
cv 131,138
mvav 180,220,64
tra 218,248,25664
mvav 188,220,72
wl 12
tra 220,248,24928
v_accvgpr_write_b32 a243, v252
mvav 160,224,80
tra 222,248,25696
buffer_store_dwordx4 v[128:131], v250, s[60:63], s91 offen sc1
mvav 168,224,88
wl 12
tra 224,248,24960
mvav 164,228,80
s_add_u32 s91, s10, 0xb9000
tra 226,248,25728
mvav 172,228,88
wl 12
s_add_u32 m0, s74, 0x1e500
tra 228,248,24992
mvav 176,232,80
s_add_u32 s89, s90, 0x3c000
tra 230,248,25760
buffer_load_dwordx4 v232, s[56:59], s89 offen lds
mvav 184,232,88
wl 12
tra 232,248,25024
v_accvgpr_write_b32 a240, 0
mvav 180,236,80
tra 234,248,25792
cv 132,132
mvav 188,236,88
wl 12
tra 236,248,25056
zvaa 4,208,96
tra 238,248,25824
zvaa 20,208,100
wl 12
tra 208,248,25088
cv 133,134
zvaa 12,212,96
tra 210,248,25856
v_accvgpr_write_b32 a241, 0
zvaa 28,212,100
wl 12
tra 212,248,25120
buffer_load_dwordx4 v233, s[56:59], s89 offen offset:1024 lds
zvaa 36,216,96
tra 214,248,25888
cv 134,140
zvaa 52,216,100
wl 12
tra 216,248,25152
zvaa 44,220,96
tra 218,248,25920
v_accvgpr_write_b32 a244, 0
zvaa 60,220,100
wl 12
tra 220,248,25184
cv 135,142
mvaa 4,224,104
tra 222,248,25952
buffer_store_dwordx4 v[132:135], v250, s[60:63], s91 offen sc1
mvaa 20,224,108
wl 12
tra 224,247,0
mvaa 12,228,104
tra 226,247,768
mvaa 28,228,108
wl 12
tra 228,247,32
buffer_load_dwordx4 v234, s[56:59], s89 offen offset:2048 lds
mvaa 36,232,104
tra 230,247,800
v_accvgpr_write_b32 a245, 0
mvaa 52,232,108
wl 12
s_add_u32 s91, s10, 0xde000
tra 232,247,64
mvaa 44,236,104
tra 234,247,832
mvaa 60,236,108
wl 12
tra 236,247,96
mvaa 4,208,112
tra 238,247,864
cv 144,144
mvaa 20,208,116
wl 12
tra 208,247,128
v_bfe_u32 v252, v250, 6, 2
mvaa 12,212,112
s_add_u32 s89, s90, 0x5a000
s_add_u32 m0, s74, 0x21580
tra 210,247,896
mvaa 28,212,116
wl 12
buffer_load_dwordx4 v232, s[56:59], s89 offen lds
mvaa 36,216,112
tra 212,247,160
cv 145,146
mvaa 52,216,116
wl 11
tra 214,247,928
v_bfe_u32 v251, v250, 4, 2
mvaa 44,220,112
tra 216,247,192
cv 146,152
mvaa 60,220,116
wl 11
tra 218,247,960
mvaa 4,224,120
tra 220,247,224
mvaa 20,224,124
wl 11
tra 222,247,992
cv 147,154
mvaa 12,228,120
tra 224,247,256
v_lshl_add_u32 v252, v252, 3, v251
mvaa 28,228,124
wl 11
buffer_load_dwordx4 v233, s[56:59], s89 offen offset:1024 lds
mvaa 36,232,120
tra 226,247,1024
mvaa 52,232,124
wl 10
tra 228,247,288
mvaa 44,236,120
buffer_store_dwordx4 v[144:147], v250, s[60:63], s91 offen sc1
mvaa 60,236,124
wl 9
tra 230,247,1056
v_bfe_u32 v251, v250, 9, 1
mvaa 4,208,128
s_add_u32 s91, s10, 0x103000
tra 232,247,320
cv 148,148
mvaa 20,208,132
wl 9
tra 234,247,1088
cv 149,150
mvaa 12,212,128
tra 236,247,352
cv 150,156
mvaa 28,212,132
wl 9
tra 238,247,1120
cv 151,158
mvaa 36,216,128
buffer_load_dwordx4 v234, s[56:59], s89 offen offset:2048 lds
mvaa 52,216,132
wl 8
buffer_store_dwordx4 v[148:151], v250, s[60:63], s91 offen sc1
mvaa 44,220,128
s_waitcnt vmcnt(29) lgkmcnt(0)
v_lshl_add_u32 v252, v251, 2, v252
mvaa 60,220,132
s_barrier
mvaa 4,224,136
tra 208,248,37248
tra 210,248,38016
mvaa 20,224,140
tra 212,248,37280
tra 214,248,38048
mvaa 12,228,136
s_add_u32 m0, s74, 0x24600
tra 216,248,37312
tra 218,248,38080
mvaa 28,228,140
tra 220,248,37344
tra 222,248,38112
mvaa 36,232,136
s_add_u32 s89, s90, 0x78000
tra 224,248,37376
buffer_load_dwordx4 v232, s[56:59], s89 offen lds
mvaa 52,232,140
tra 226,248,38144
v_mul_u32_u24 v252, 0xa00, v252
mvaa 44,236,136
tra 228,248,37408
tra 230,248,38176
mvaa 60,236,140
wl 10
tra 232,248,37440
v_bfe_u32 v251, v250, 8, 1
mvaa 4,208,0
tra 234,248,38208
tra 236,248,37472
mvaa 20,208,4
wl 11
tra 238,248,38240
tra 208,248,37504
mvaa 12,212,0
s_add_u32 s91, s70, 1
tra 210,248,38272
mvaa 28,212,4
wl 12
tra 212,248,37536
v_lshl_add_u32 v241, v251, 4, v252
mvaa 36,216,0
s_and_b32 s91, s91, 7
tra 214,248,38304
buffer_load_dwordx4 v233, s[56:59], s89 offen offset:1024 lds
mvaa 52,216,4
wl 12
tra 216,248,37568
mvaa 44,220,0
tra 218,248,38336
mvaa 60,220,4
wl 12
s_mul_i32 s91, s91, 0x25000
tra 220,248,37600
mvaa 4,224,8
tra 222,248,38368
mvaa 20,224,12
wl 12
tra 224,248,49664
v_lshrrev_b32 v242, 2, v250
mvaa 12,228,8
s_add_u32 s91, s91, 0x2000
tra 226,248,50432
mvaa 28,228,12
wl 12
tra 228,248,49696
tra 230,248,50464
mvaa 36,232,8
buffer_load_dwordx4 v234, s[56:59], s89 offen offset:2048 lds
mvaa 52,232,12
wl 12
tra 232,248,49728
cv 192,192
mvaa 44,236,8
tra 234,248,50496
v_min_u32 v242, 60, v242
mvaa 60,236,12
wl 12
tra 236,248,49760
mvaa 4,208,16
tra 238,248,50528
cv 193,194
mvaa 20,208,20
wl 12
tra 208,248,49792
v_lshrrev_b32 v252, 4, v250
mvaa 12,212,16
tra 210,248,50560
cv 194,196
mvaa 28,212,20
wl 12
s_add_u32 m0, s74, 0x15380
tra 212,248,49824
mvaa 36,216,16
s_add_u32 s89, s90, 0x96000
tra 214,248,50592
buffer_load_dwordx4 v232, s[56:59], s89 offen lds
mvaa 52,216,20
wl 12
tra 216,248,49856
mvaa 44,220,16
tra 218,248,50624
cv 195,198
mvaa 60,220,20
wl 12
tra 220,248,49888
v_cmp_gt_u32 vcc, 8, v252
mvaa 4,224,24
tra 222,248,50656
buffer_store_dwordx4 v[192:195], v250, s[60:63], s91 offen offset:0 sc1
mvaa 20,224,28
wl 12
tra 224,248,49920
mvaa 12,228,24
tra 226,248,50688
mvaa 28,228,28
wl 12
tra 228,248,49952
buffer_load_dwordx4 v233, s[56:59], s89 offen offset:1024 lds
mvaa 36,232,24
tra 230,248,50720
cv 200,200
mvaa 52,232,28
wl 12
tra 232,248,49984
v_add_u32 v251, s8, v252
mvaa 44,236,24
tra 234,248,50752
mvaa 60,236,28
wl 12
tra 236,248,50016
cv 201,202
mvaa 4,208,32
tra 238,248,50784
mvaa 20,208,36
wl 12
tra 208,247,24832
v_add_u32 v251, 2, v251
mvaa 12,212,32
tra 210,247,25600
cv 202,204
mvaa 28,212,36
wl 12
tra 212,247,24864
buffer_load_dwordx4 v234, s[56:59], s89 offen offset:2048 lds
mvaa 36,216,32
tra 214,247,25632
mvaa 52,216,36
wl 12
tra 216,247,24896
cv 203,206
mvaa 44,220,32
tra 218,247,25664
mvaa 60,220,36
wl 12
tra 220,247,24928
v_cndmask_b32 v252, v251, v252, vcc
mvaa 4,224,40
tra 222,247,25696
buffer_store_dwordx4 v[200:203], v250, s[60:63], s91 offen offset:1024 sc1
mvaa 20,224,44
wl 12
tra 224,247,24960
mvaa 12,228,40
s_add_u32 s89, s90, 0xb4000
s_add_u32 m0, s74, 0
tra 226,247,25728
mvaa 28,228,44
wl 12
buffer_load_dwordx4 v232, s[56:59], s89 offen lds
mvaa 36,232,40
tra 228,247,24992
cv 208,208
mvaa 52,232,44
wl 11
tra 230,247,25760
v_and_b32 v252, 7, v252
mvaa 44,236,40
tra 232,247,25024
cv 209,210
mvaa 60,236,44
wl 11
tra 234,247,25792
mvaa 4,208,48
tra 236,247,25056
mvaa 20,208,52
wl 11
tra 238,247,25824
cv 210,212
mvaa 12,212,48
tra 208,247,25088
v_mul_u32_u24 v252, 0x25000, v252
mvaa 28,212,52
wl 11
buffer_load_dwordx4 v233, s[56:59], s89 offen offset:1024 lds
mvaa 36,216,48
tra 210,247,25856
cv 211,214
mvaa 52,216,52
wl 10
tra 212,247,25120
mvaa 44,220,48
tra 214,247,25888
v_lshrrev_b32 v251, 8, s10
mvaa 60,220,52
wl 10
buffer_store_dwordx4 v[208:211], v250, s[60:63], s91 offen offset:2048 sc1
mvaa 4,224,56
tra 216,247,25152
cv 216,216
mvaa 20,224,60
wl 9
tra 218,247,25920
cv 217,218
mvaa 12,228,56
tra 220,247,25184
cv 218,220
mvaa 28,228,60
wl 9
tra 222,247,25952
cv 219,222
mvaa 36,232,56
buffer_load_dwordx4 v234, s[56:59], s89 offen offset:2048 lds
mvaa 52,232,60
wl 8
buffer_store_dwordx4 v[216:219], v250, s[60:63], s91 offen offset:3072 sc1
mvaa 44,236,56
s_waitcnt vmcnt(32) lgkmcnt(0)
v_cndmask_b32 v251, v242, v251, vcc
mvaa 60,236,60
s_barrier
mvaa 4,208,64
tra 224,247,12416
tra 226,247,13184
mvaa 20,208,68
tra 228,247,12448
tra 230,247,13216
mvaa 12,212,64
s_add_u32 m0, s74, 0x18400
tra 232,247,12480
tra 234,247,13248
mvaa 28,212,68
tra 236,247,12512
tra 238,247,13280
mvaa 36,216,64
s_add_u32 s89, s90, 0xd2000
tra 208,247,12544
buffer_load_dwordx4 v232, s[56:59], s89 offen lds
mvaa 52,216,68
tra 210,247,13312
v_add_u32 v252, v252, v251
mvaa 44,220,64
tra 212,247,12576
v_add_u32 v243, 0x9000, v252
mvaa 60,220,68
wl 9
tra 214,247,13344
tra 216,247,12608
mvaa 4,224,72
tra 218,247,13376
buffer_load_dword v251, off, s[4:7], s14 sc1
mvaa 20,224,76
wl 10
s_add_u32 s91, s70, 2
tra 220,247,12640
mvaa 12,228,72
s_and_b32 s91, s91, 7
tra 222,247,13408
tra 224,247,12672
mvaa 28,228,76
wl 11
s_mul_i32 s91, s91, 0x25000
tra 226,247,13440
mvaa 36,232,72
s_add_u32 s91, s91, 0x3000
tra 228,247,12704
buffer_load_dwordx4 v233, s[56:59], s89 offen offset:1024 lds
mvaa 52,232,76
wl 11
tra 230,247,13472
v_accvgpr_read_b32 v224, a160
mvaa 44,236,72
s_add_u32 s90, s70, 6
tra 232,247,12736
v_accvgpr_read_b32 v228, a164
mvaa 60,236,76
wl 11
tra 234,247,13504
v_accvgpr_read_b32 v225, a161
mvaa 4,208,80
s_and_b32 s90, s90, 7
tra 236,247,12768
v_accvgpr_read_b32 v229, a165
mvaa 20,208,84
wl 11
tra 238,247,13536
v_accvgpr_read_b32 v226, a162
mvaa 12,212,80
s_add_u32 s90, s90, s97
tra 208,247,37248
v_accvgpr_read_b32 v230, a166
mvaa 28,212,84
wl 11
tra 210,247,38016
v_accvgpr_read_b32 v227, a163
mvaa 36,216,80
s_sub_u32 s25, s90, 10
tra 212,247,37280
buffer_load_dwordx4 v234, s[56:59], s89 offen offset:2048 lds
mvaa 52,216,84
wl 11
tra 214,247,38048
v_accvgpr_read_b32 v231, a167
mvaa 44,220,80
tra 216,247,37312
cv 224,224
mvaa 60,220,84
wl 11
s_min_u32 s90, s90, s25
tra 218,247,38080
mvaa 4,224,88
s_lshl_b32 s90, s90, 7
tra 220,247,37344
cv 225,226
mvaa 20,224,92
wl 11
s_add_u32 m0, s74, 0x1b480
tra 222,247,38112
mvaa 12,228,88
s_add_u32 s89, s90, 0
tra 224,247,37376
buffer_load_dwordx4 v232, s[56:59], s89 offen lds
mvaa 28,228,92
wl 11
tra 226,247,38144
cv 226,228
mvaa 36,232,88
tra 228,247,37408
cv 227,230
mvaa 52,232,92
wl 11
tra 230,247,38176
buffer_store_dwordx4 v[224:227], v250, s[60:63], s91 offen offset:0 sc1
mvaa 44,236,88
L_k1_ps18:
s_cbranch_execz L_k1_ps22
tra 232,247,37440
mvaa 60,236,92
wl 11
tra 234,247,38208
v_accvgpr_read_b32 v224, a168
mvav 4,208,0
tra 236,247,37472
v_accvgpr_read_b32 v228, a172
mvav 20,208,8
wl 11
tra 238,247,38240
v_accvgpr_read_b32 v225, a169
mvav 12,212,0
tra 208,247,37504
v_accvgpr_read_b32 v229, a173
mvav 28,212,8
wl 11
tra 210,247,38272
buffer_load_dwordx4 v233, s[56:59], s89 offen offset:1024 lds
mvav 36,216,0
tra 212,247,37536
v_accvgpr_read_b32 v226, a170
mvav 52,216,8
wl 11
tra 214,247,38304
v_accvgpr_read_b32 v230, a174
mvav 44,220,0
tra 216,247,37568
v_accvgpr_read_b32 v227, a171
mvav 60,220,8
wl 11
tra 218,247,38336
v_accvgpr_read_b32 v231, a175
mvav 4,224,16
tra 220,247,37600
cv 224,224
mvav 20,224,24
wl 11
tra 222,247,38368
cv 225,226
mvav 12,228,16
tra 224,247,49664
cv 226,228
mvav 28,228,24
wl 11
tra 226,247,50432
buffer_load_dwordx4 v234, s[56:59], s89 offen offset:2048 lds
mvav 36,232,16
tra 228,247,49696
cv 227,230
mvav 52,232,24
wl 11
tra 230,247,50464
buffer_store_dwordx4 v[224:227], v250, s[60:63], s91 offen offset:1024 sc1
mvav 44,236,16
tra 232,247,49728
v_accvgpr_read_b32 v224, a176
mvav 60,236,24
wl 11
tra 234,247,50496
v_accvgpr_read_b32 v228, a180
mvav 4,208,32
tra 236,247,49760
v_accvgpr_read_b32 v225, a177
mvav 20,208,40
wl 11
tra 238,247,50528
v_accvgpr_read_b32 v229, a181
mvav 12,212,32
s_add_u32 s89, s90, 0x1e000
s_add_u32 m0, s74, 0x6100
tra 208,247,49792
mvav 28,212,40
wl 11
tra 210,247,50560
buffer_load_dwordx4 v232, s[56:59], s89 offen lds
mvav 36,216,32
tra 212,247,49824
v_accvgpr_read_b32 v226, a178
mvav 52,216,40
wl 11
tra 214,247,50592
v_accvgpr_read_b32 v230, a182
mvav 44,220,32
tra 216,247,49856
v_accvgpr_read_b32 v227, a179
mvav 60,220,40
wl 11
tra 218,247,50624
v_accvgpr_read_b32 v231, a183
mvav 4,224,48
tra 220,247,49888
cv 224,224
mvav 20,224,56
wl 11
tra 222,247,50656
cv 225,226
mvav 12,228,48
tra 224,247,49920
cv 226,228
mvav 28,228,56
wl 11
buffer_load_dwordx4 v233, s[56:59], s89 offen offset:1024 lds
cv 227,230
mvav 36,232,48
buffer_store_dwordx4 v[224:227], v250, s[60:63], s91 offen offset:2048 sc1
mvav 52,232,56
wl 9
tra 226,247,50688
v_accvgpr_read_b32 v224, a184
mvav 44,236,48
tra 228,247,49952
v_accvgpr_read_b32 v228, a188
mvav 60,236,56
wl 9
tra 230,247,50720
v_accvgpr_read_b32 v225, a185
mvav 4,208,64
tra 232,247,49984
v_accvgpr_read_b32 v229, a189
mvav 20,208,72
wl 9
tra 234,247,50752
v_accvgpr_read_b32 v226, a186
mvav 12,212,64
tra 236,247,50016
v_accvgpr_read_b32 v230, a190
mvav 28,212,72
wl 9
tra 238,247,50784
v_accvgpr_read_b32 v227, a187
mvav 36,216,64
buffer_load_dwordx4 v234, s[56:59], s89 offen offset:2048 lds
mvav 52,216,72
wl 8
v_accvgpr_read_b32 v231, a191
cv 224,224
mvav 44,220,64
s_waitcnt vmcnt(31) lgkmcnt(0)
cv 225,226
mvav 60,220,72
s_barrier
mvav 4,224,80
tra 208,248,0
tra 210,248,768
mvav 20,224,88
tra 212,248,32
tra 214,248,800
mvav 12,228,80
s_add_u32 m0, s74, 0x3080
tra 216,248,64
tra 218,248,832
mvav 28,228,88
tra 220,248,96
tra 222,248,864
mvav 36,232,80
s_add_u32 s89, s90, 0x3c000
tra 224,248,128
buffer_load_dwordx4 v232, s[56:59], s89 offen lds
mvav 52,232,88
tra 226,248,896
cv 226,228
mvav 44,236,80
tra 228,248,160
cv 227,230
mvav 60,236,88
wl 9
tra 230,248,928
buffer_store_dwordx4 v[224:227], v250, s[60:63], s91 offen offset:3072 sc1
zvaa 96,208,96
tra 232,248,192
tra 234,248,960
zvaa 104,208,100
wl 10
tra 236,248,224
tra 238,248,992
zvaa 100,212,96
s_add_u32 s91, s70, 3
tra 208,248,256
tra 210,248,1024
zvaa 108,212,100
wl 12
tra 212,248,288
tra 214,248,1056
zvaa 112,216,96
buffer_load_dwordx4 v233, s[56:59], s89 offen offset:1024 lds
zvaa 120,216,100
wl 12
s_and_b32 s91, s91, 7
tra 216,248,320
zvaa 116,220,96
tra 218,248,1088
zvaa 124,220,100
wl 12
s_mul_i32 s91, s91, 0x25000
tra 220,248,352
mvaa 96,224,104
tra 222,248,1120
mvaa 104,224,108
wl 12
tra 224,248,12416
mvaa 100,228,104
s_add_u32 s91, s91, 0x4000
tra 226,248,13184
mvaa 108,228,108
wl 12
tra 228,248,12448
tra 230,248,13216
mvaa 112,232,104
buffer_load_dwordx4 v234, s[56:59], s89 offen offset:2048 lds
mvaa 120,232,108
wl 12
tra 232,248,12480
cv 160,160
mvaa 116,236,104
tra 234,248,13248
mvaa 124,236,108
wl 12
tra 236,248,12512
mvaa 96,208,112
tra 238,248,13280
cv 161,162
mvaa 104,208,116
wl 12
tra 208,248,12544
mvaa 100,212,112
tra 210,248,13312
cv 162,164
mvaa 108,212,116
wl 12
s_add_u32 m0, s74, 0x9180
tra 212,248,12576
mvaa 112,216,112
s_add_u32 s89, s90, 0x5a000
tra 214,248,13344
buffer_load_dwordx4 v232, s[56:59], s89 offen lds
mvaa 120,216,116
wl 12
tra 216,248,12608
mvaa 116,220,112
tra 218,248,13376
cv 163,166
mvaa 124,220,116
wl 12
tra 220,248,12640
tra 222,248,13408
mvaa 96,224,120
s_waitcnt vmcnt(16)
v_readfirstlane_b32 s88, v251
s_nop 0
s_cmp_lg_u32 s88, 0xff
s_cbranch_scc1 L_k1_sp_u433
L_k1_sb_u434:
mvaa 104,224,124
wl 12
tra 224,248,12672
mvaa 100,228,120
tra 226,248,13440
mvaa 108,228,124
wl 12
tra 228,248,12704
buffer_load_dwordx4 v233, s[56:59], s89 offen offset:1024 lds
mvaa 112,232,120
tra 230,248,13472
mvaa 120,232,124
wl 12
tra 232,248,12736
tra 234,248,13504
mvaa 116,236,120
buffer_store_dwordx4 v[160:163], v250, s[60:63], s91 offen offset:0 sc1
mvaa 124,236,124
wl 12
tra 236,248,12768
cv 168,168
mvaa 96,208,128
tra 238,248,13536
cv 169,170
mvaa 104,208,132
wl 12
tra 208,249,0
mvaa 100,212,128
tra 210,249,768
cv 170,172
mvaa 108,212,132
wl 12
tra 212,249,32
buffer_load_dwordx4 v234, s[56:59], s89 offen offset:2048 lds
mvaa 112,216,128
tra 214,249,800
mvaa 120,216,132
wl 12
tra 216,249,64
cv 171,174
mvaa 116,220,128
tra 218,249,832
mvaa 124,220,132
wl 12
tra 220,249,96
tra 222,249,864
mvaa 96,224,136
buffer_store_dwordx4 v[168:171], v250, s[60:63], s91 offen offset:1024 sc1
mvaa 104,224,140
wl 12
tra 224,249,128
mvaa 100,228,136
s_add_u32 s89, s90, 0x78000
s_add_u32 m0, s74, 0xc200
tra 226,249,896
mvaa 108,228,140
wl 12
tra 228,249,160
buffer_load_dwordx4 v232, s[56:59], s89 offen lds
mvaa 112,232,136
tra 230,249,928
cv 176,176
mvaa 120,232,140
wl 12
tra 232,249,192
mvaa 116,236,136
tra 234,249,960
cv 177,178
mvaa 124,236,140
wl 12
tra 236,249,224
mvaa 96,208,0
s_mov_b64 exec, 0xff
buffer_store_dword v243, v243, s[60:63], 0 offen sc1
s_mov_b64 exec, -1
mvaa 104,208,4
wl 11
tra 238,249,992
cv 178,180
mvaa 100,212,0
tra 208,249,256
mvaa 108,212,4
wl 11
buffer_load_dwordx4 v233, s[56:59], s89 offen offset:1024 lds
mvaa 112,216,0
tra 210,249,1024
cv 179,182
mvaa 120,216,4
wl 10
tra 212,249,288
mvaa 116,220,0
tra 214,249,1056
mvaa 124,220,4
wl 10
buffer_store_dwordx4 v[176:179], v250, s[60:63], s91 offen offset:2048 sc1
mvaa 96,224,8
tra 216,249,320
cv 184,184
mvaa 104,224,12
wl 9
tra 218,249,1088
cv 185,186
mvaa 100,228,8
tra 220,249,352
cv 186,188
mvaa 108,228,12
wl 9
tra 222,249,1120
cv 187,190
mvaa 112,232,8
buffer_load_dwordx4 v234, s[56:59], s89 offen offset:2048 lds
mvaa 120,232,12
wl 8
buffer_store_dwordx4 v[184:187], v250, s[60:63], s91 offen offset:3072 sc1
mvaa 116,236,8
wl 0
mvaa 124,236,12
s_barrier
mvaa 96,208,16
tra 224,249,12416
tra 226,249,13184
mvaa 104,208,20
tra 228,249,12448
tra 230,249,13216
mvaa 100,212,16
s_add_u32 m0, s74, 0xf280
tra 232,249,12480
tra 234,249,13248
mvaa 108,212,20
tra 236,249,12512
tra 238,249,13280
mvaa 112,216,16
s_add_u32 s89, s90, 0x96000
tra 208,249,12544
buffer_load_dwordx4 v232, s[56:59], s89 offen lds
mvaa 120,216,20
tra 210,249,13312
tra 212,249,12576
mvaa 116,220,16
tra 214,249,13344
tra 216,249,12608
mvaa 124,220,20
wl 11
tra 218,249,13376
tra 220,249,12640
mvaa 96,224,24
tra 222,249,13408
mvaa 104,224,28
wl 12
tra 224,249,12672
mvaa 100,228,24
s_add_u32 s91, s70, 4
tra 226,249,13440
mvaa 108,228,28
wl 12
tra 228,249,12704
tra 230,249,13472
mvaa 112,232,24
buffer_load_dwordx4 v233, s[56:59], s89 offen offset:1024 lds
mvaa 120,232,28
wl 12
tra 232,249,12736
mvaa 116,236,24
tra 234,249,13504
mvaa 124,236,28
wl 12
s_and_b32 s91, s91, 7
tra 236,249,12768
mvaa 96,208,32
tra 238,249,13536
mvaa 104,208,36
wl 12
tra 208,249,24832
mvaa 100,212,32
tra 210,249,25600
mvaa 108,212,36
wl 12
tra 212,249,24864
tra 214,249,25632
mvaa 112,216,32
buffer_load_dwordx4 v234, s[56:59], s89 offen offset:2048 lds
mvaa 120,216,36
wl 12
s_mul_i32 s91, s91, 0x25000
tra 216,249,24896
mvaa 116,220,32
tra 218,249,25664
mvaa 124,220,36
wl 12
tra 220,249,24928
mvaa 96,224,40
tra 222,249,25696
mvaa 104,224,44
wl 12
s_add_u32 s91, s91, 0x5000
tra 224,249,24960
mvaa 100,228,40
tra 226,249,25728
mvaa 108,228,44
wl 12
s_add_u32 m0, s74, 0x12300
tra 228,249,24992
mvaa 112,232,40
s_add_u32 s89, s90, 0xb4000
tra 230,249,25760
buffer_load_dwordx4 v232, s[56:59], s89 offen lds
mvaa 120,232,44
wl 12
tra 232,249,25024
mvaa 116,236,40
tra 234,249,25792
cv 4,4
mvaa 124,236,44
wl 12
tra 236,249,25056
mvaa 96,208,48
tra 238,249,25824
mvaa 104,208,52
wl 12
tra 208,249,25088
mvaa 100,212,48
tra 210,249,25856
mvaa 108,212,52
wl 12
tra 212,249,25120
buffer_load_dwordx4 v233, s[56:59], s89 offen offset:1024 lds
mvaa 112,216,48
tra 214,249,25888
cv 5,6
mvaa 120,216,52
wl 12
tra 216,249,25152
mvaa 116,220,48
tra 218,249,25920
mvaa 124,220,52
wl 12
tra 220,249,25184
mvaa 96,224,56
tra 222,249,25952
cv 6,12
mvaa 104,224,60
wl 12
tra 224,248,24832
mvaa 100,228,56
tra 226,248,25600
mvaa 108,228,60
wl 12
tra 228,248,24864
buffer_load_dwordx4 v234, s[56:59], s89 offen offset:2048 lds
mvaa 112,232,56
tra 230,248,25632
mvaa 120,232,60
wl 12
tra 232,248,24896
cv 7,14
mvaa 116,236,56
tra 234,248,25664
mvaa 124,236,60
wl 12
tra 236,248,24928
tra 238,248,25696
mvaa 96,208,64
buffer_store_dwordx4 v[4:7], v250, s[60:63], s91 offen offset:0 sc1
mvaa 104,208,68
wl 12
tra 208,248,24960
mvaa 100,212,64
s_add_u32 s89, s90, 0xd2000
s_add_u32 m0, s74, 0x1e500
tra 210,248,25728
mvaa 108,212,68
wl 12
tra 212,248,24992
buffer_load_dwordx4 v232, s[56:59], s89 offen lds
mvaa 112,216,64
tra 214,248,25760
mvaa 120,216,68
wl 12
tra 216,248,25024
mvaa 116,220,64
tra 218,248,25792
mvaa 124,220,68
wl 12
tra 220,248,25056
cv 20,20
mvaa 96,224,72
s_mov_b64 exec, 0x100
buffer_store_dword v243, v243, s[60:63], 0 offen sc1
s_mov_b64 exec, -1
mvaa 104,224,76
wl 11
tra 222,248,25824
mvaa 100,228,72
tra 224,248,25088
mvaa 108,228,76
wl 11
buffer_load_dwordx4 v233, s[56:59], s89 offen offset:1024 lds
mvaa 112,232,72
tra 226,248,25856
cv 21,22
mvaa 120,232,76
wl 10
tra 228,248,25120
mvaa 116,236,72
tra 230,248,25888
mvaa 124,236,76
wl 10
s_add_u32 s90, s70, 7
tra 232,248,25152
mvaa 96,208,80
L_k1_ps19:
s_cbranch_execz L_k1_psc0
mvaa 104,208,84
wl 9
tra 234,248,25920
cv 22,28
mvaa 100,212,80
s_and_b32 s90, s90, 7
tra 236,248,25184
mvaa 108,212,84
wl 9
s_add_u32 s90, s90, s97
tra 238,248,25952
mvaa 112,216,80
buffer_load_dwordx4 v234, s[56:59], s89 offen offset:2048 lds
mvaa 120,216,84
wl 8
s_sub_u32 s25, s90, 10
cv 23,30
mvaa 116,220,80
s_waitcnt vmcnt(31) lgkmcnt(0)
s_min_u32 s90, s90, s25
mvaa 124,220,84
s_barrier
mvaa 96,224,88
s_add_u32 m0, s74, 0x21580
tra 208,247,0
tra 210,247,768
mvaa 104,224,92
tra 212,247,32
tra 214,247,800
mvaa 100,228,88
s_lshl_b32 s90, s90, 7
tra 216,247,64
tra 218,247,832
mvaa 108,228,92
tra 220,247,96
tra 222,247,864
mvaa 112,232,88
s_add_u32 s89, s90, 0
tra 224,247,128
buffer_load_dwordx4 v232, s[56:59], s89 offen lds
mvaa 120,232,92
tra 226,247,896
tra 228,247,160
mvaa 116,236,88
tra 230,247,928
tra 232,247,192
mvaa 124,236,92
wl 11
tra 234,247,960
buffer_store_dwordx4 v[20:23], v250, s[60:63], s91 offen offset:1024 sc1
mvav 96,208,0
tra 236,247,224
cv 36,36
mvav 104,208,8
wl 11
tra 238,247,992
tra 208,247,256
mvav 100,212,0
tra 210,247,1024
mvav 108,212,8
wl 12
tra 212,247,288
tra 214,247,1056
mvav 112,216,0
buffer_load_dwordx4 v233, s[56:59], s89 offen offset:1024 lds
mvav 120,216,8
wl 12
tra 216,247,320
cv 37,38
mvav 116,220,0
tra 218,247,1088
mvav 124,220,8
wl 12
tra 220,247,352
mvav 96,224,16
tra 222,247,1120
mvav 104,224,24
wl 12
tra 224,248,37248
mvav 100,228,16
tra 226,248,38016
cv 38,44
mvav 108,228,24
wl 12
tra 228,248,37280
tra 230,248,38048
mvav 112,232,16
buffer_load_dwordx4 v234, s[56:59], s89 offen offset:2048 lds
mvav 120,232,24
wl 12
tra 232,248,37312
mvav 116,236,16
tra 234,248,38080
mvav 124,236,24
wl 12
tra 236,248,37344
cv 39,46
mvav 96,208,32
tra 238,248,38112
mvav 104,208,40
wl 12
tra 208,248,37376
mvav 100,212,32
tra 210,248,38144
mvav 108,212,40
wl 12
s_add_u32 m0, s74, 0x24600
tra 212,248,37408
mvav 112,216,32
s_add_u32 s89, s90, 0x1e000
tra 214,248,38176
buffer_load_dwordx4 v232, s[56:59], s89 offen lds
mvav 120,216,40
wl 12
tra 216,248,37440
mvav 116,220,32
tra 218,248,38208
mvav 124,220,40
wl 12
tra 220,248,37472
buffer_store_dwordx4 v[36:39], v250, s[60:63], s91 offen offset:2048 sc1
mvav 96,224,48
tra 222,248,38240
mvav 104,224,56
wl 12
tra 224,248,37504
cv 52,52
mvav 100,228,48
tra 226,248,38272
mvav 108,228,56
wl 12
tra 228,248,37536
buffer_load_dwordx4 v233, s[56:59], s89 offen offset:1024 lds
mvav 112,232,48
tra 230,248,38304
mvav 120,232,56
wl 12
tra 232,248,37568
mvav 116,236,48
tra 234,248,38336
cv 53,54
mvav 124,236,56
wl 12
tra 236,248,37600
mvav 96,208,64
tra 238,248,38368
mvav 104,208,72
wl 12
tra 208,248,49664
mvav 100,212,64
tra 210,248,50432
mvav 108,212,72
wl 12
tra 212,248,49696
buffer_load_dwordx4 v234, s[56:59], s89 offen offset:2048 lds
mvav 112,216,64
tra 214,248,50464
cv 54,60
mvav 120,216,72
wl 12
tra 216,248,49728
mvav 116,220,64
tra 218,248,50496
mvav 124,220,72
wl 12
tra 220,248,49760
mvav 96,224,80
tra 222,248,50528
cv 55,62
mvav 104,224,88
wl 12
tra 224,248,49792
mvav 100,228,80
s_add_u32 s89, s90, 0x3c000
s_add_u32 m0, s74, 0x15380
tra 226,248,50560
mvav 108,228,88
wl 12
tra 228,248,49824
buffer_load_dwordx4 v232, s[56:59], s89 offen lds
mvav 112,232,80
tra 230,248,50592
mvav 120,232,88
wl 12
tra 232,248,49856
mvav 116,236,80
buffer_store_dwordx4 v[52:55], v250, s[60:63], s91 offen offset:3072 sc1
mvav 124,236,88
wl 11
tra 234,248,50624
zvaa 128,208,96
s_waitcnt vmcnt(34)
s_mov_b64 exec, 0x200
buffer_store_dword v243, v243, s[60:63], 0 offen sc1
s_mov_b64 exec, -1
zvaa 136,208,100
wl 10
tra 236,248,49888
zvaa 132,212,96
tra 238,248,50656
zvaa 140,212,100
wl 10
buffer_load_dwordx4 v233, s[56:59], s89 offen offset:1024 lds
zvaa 144,216,96
tra 208,248,49920
zvaa 152,216,100
wl 9
tra 210,248,50688
zvaa 148,220,96
tra 212,248,49952
zvaa 156,220,100
wl 9
tra 214,248,50720
mvaa 128,224,104
s_add_u32 s91, s70, 5
tra 216,248,49984
mvaa 136,224,108
wl 9
tra 218,248,50752
mvaa 132,228,104
tra 220,248,50016
mvaa 140,228,108
wl 9
tra 222,248,50784
mvaa 144,232,104
buffer_load_dwordx4 v234, s[56:59], s89 offen offset:2048 lds
mvaa 152,232,108
wl 8
mvaa 148,236,104
s_waitcnt vmcnt(31) lgkmcnt(0)
mvaa 156,236,108
s_barrier
mvaa 128,208,112
s_and_b32 s91, s91, 7
tra 224,247,24832
tra 226,247,25600
mvaa 136,208,116
tra 228,247,24864
tra 230,247,25632
mvaa 132,212,112
s_add_u32 m0, s74, 0
tra 232,247,24896
tra 234,247,25664
mvaa 140,212,116
tra 236,247,24928
tra 238,247,25696
mvaa 144,216,112
s_add_u32 s89, s90, 0x5a000
tra 208,247,24960
buffer_load_dwordx4 v232, s[56:59], s89 offen lds
mvaa 152,216,116
tra 210,247,25728
tra 212,247,24992
mvaa 148,220,112
tra 214,247,25760
tra 216,247,25024
mvaa 156,220,116
wl 11
tra 218,247,25792
tra 220,247,25056
mvaa 128,224,120
s_mul_i32 s91, s91, 0x25000
tra 222,247,25824
mvaa 136,224,124
wl 12
tra 224,247,25088
mvaa 132,228,120
tra 226,247,25856
mvaa 140,228,124
wl 12
tra 228,247,25120
tra 230,247,25888
mvaa 144,232,120
buffer_load_dwordx4 v233, s[56:59], s89 offen offset:1024 lds
mvaa 152,232,124
wl 12
tra 232,247,25152
mvaa 148,236,120
tra 234,247,25920
mvaa 156,236,124
wl 12
s_add_u32 s91, s91, 0x6000
tra 236,247,25184
mvaa 128,208,128
tra 238,247,25952
mvaa 136,208,132
wl 12
tra 208,247,12416
mvaa 132,212,128
tra 210,247,13184
mvaa 140,212,132
wl 12
tra 212,247,12448
tra 214,247,13216
mvaa 144,216,128
buffer_load_dwordx4 v234, s[56:59], s89 offen offset:2048 lds
mvaa 152,216,132
wl 12
tra 216,247,12480
mvaa 148,220,128
tra 218,247,13248
mvaa 156,220,132
wl 12
tra 220,247,12512
cv 96,96
mvaa 128,224,136
tra 222,247,13280
mvaa 136,224,140
wl 12
tra 224,247,12544
mvaa 132,228,136
tra 226,247,13312
mvaa 140,228,140
wl 12
s_add_u32 m0, s74, 0x18400
tra 228,247,12576
mvaa 144,232,136
s_add_u32 s89, s90, 0x78000
tra 230,247,13344
buffer_load_dwordx4 v232, s[56:59], s89 offen lds
mvaa 152,232,140
wl 12
tra 232,247,12608
mvaa 148,236,136
tra 234,247,13376
mvaa 156,236,140
wl 12
tra 236,247,12640
cv 97,98
mvaa 128,208,0
tra 238,247,13408
buffer_load_dword v251, v242, s[60:63], s12 offen sc1
mvaa 136,208,4
wl 12
tra 208,247,12672
mvaa 132,212,0
tra 210,247,13440
mvaa 140,212,4
wl 12
tra 212,247,12704
buffer_load_dwordx4 v233, s[56:59], s89 offen offset:1024 lds
mvaa 144,216,0
tra 214,247,13472
mvaa 152,216,4
wl 12
tra 216,247,12736
mvaa 148,220,0
tra 218,247,13504
mvaa 156,220,4
wl 12
tra 220,247,12768
cv 98,100
mvaa 128,224,8
tra 222,247,13536
mvaa 136,224,12
wl 12
tra 224,247,37248
mvaa 132,228,8
tra 226,247,38016
mvaa 140,228,12
wl 12
tra 228,247,37280
buffer_load_dwordx4 v234, s[56:59], s89 offen offset:2048 lds
mvaa 144,232,8
tra 230,247,38048
mvaa 152,232,12
wl 12
tra 232,247,37312
mvaa 148,236,8
tra 234,247,38080
mvaa 156,236,12
wl 12
tra 236,247,37344
cv 99,102
mvaa 128,208,16
tra 238,247,38112
mvaa 136,208,20
wl 12
tra 208,247,37376
mvaa 132,212,16
s_add_u32 s89, s90, 0x96000
s_add_u32 m0, s74, 0x1b480
tra 210,247,38144
mvaa 140,212,20
wl 12
buffer_load_dwordx4 v232, s[56:59], s89 offen lds
mvaa 144,216,16
tra 212,247,37408
mvaa 152,216,20
wl 11
tra 214,247,38176
mvaa 148,220,16
tra 216,247,37440
mvaa 156,220,20
wl 11
tra 218,247,38208
mvaa 128,224,24
s_waitcnt vmcnt(32)
s_mov_b64 exec, 0x400
buffer_store_dword v243, v243, s[60:63], 0 offen sc1
s_mov_b64 exec, -1
mvaa 136,224,28
wl 10
tra 220,247,37472
mvaa 132,228,24
tra 222,247,38240
mvaa 140,228,28
wl 10
buffer_load_dwordx4 v233, s[56:59], s89 offen offset:1024 lds
mvaa 144,232,24
tra 224,247,37504
mvaa 152,232,28
wl 9
tra 226,247,38272
mvaa 148,236,24
tra 228,247,37536
mvaa 156,236,28
wl 9
tra 230,247,38304
mvaa 128,208,32
tra 232,247,37568
mvaa 136,208,36
wl 9
tra 234,247,38336
mvaa 132,212,32
tra 236,247,37600
mvaa 140,212,36
wl 9
tra 238,247,38368
mvaa 144,216,32
buffer_load_dwordx4 v234, s[56:59], s89 offen offset:2048 lds
mvaa 152,216,36
wl 8
buffer_store_dwordx4 v[96:99], v250, s[60:63], s91 offen offset:0 sc1
mvaa 148,220,32
s_waitcnt vmcnt(30) lgkmcnt(0)
cv 104,104
mvaa 156,220,36
s_barrier
mvaa 128,224,40
tra 208,247,49664
tra 210,247,50432
mvaa 136,224,44
tra 212,247,49696
tra 214,247,50464
mvaa 132,228,40
s_add_u32 m0, s74, 0x6100
tra 216,247,49728
tra 218,247,50496
mvaa 140,228,44
tra 220,247,49760
tra 222,247,50528
mvaa 144,232,40
s_add_u32 s89, s90, 0xb4000
tra 224,247,49792
buffer_load_dwordx4 v232, s[56:59], s89 offen lds
mvaa 152,232,44
tra 226,247,50560
cv 105,106
mvaa 148,236,40
tra 228,247,49824
cv 106,108
mvaa 156,236,44
wl 9
tra 230,247,50592
tra 232,247,49856
mvaa 128,208,48
tra 234,247,50624
tra 236,247,49888
mvaa 136,208,52
wl 11
tra 238,247,50656
tra 208,247,49920
mvaa 132,212,48
tra 210,247,50688
mvaa 140,212,52
wl 12
tra 212,247,49952
tra 214,247,50720
mvaa 144,216,48
buffer_load_dwordx4 v233, s[56:59], s89 offen offset:1024 lds
mvaa 152,216,52
wl 12
tra 216,247,49984
mvaa 148,220,48
tra 218,247,50752
cv 107,110
mvaa 156,220,52
wl 12
tra 220,247,50016
mvaa 128,224,56
tra 222,247,50784
mvaa 136,224,60
wl 12
tra 224,248,0
mvaa 132,228,56
tra 226,248,768
mvaa 140,228,60
wl 12
tra 228,248,32
tra 230,248,800
mvaa 144,232,56
buffer_load_dwordx4 v234, s[56:59], s89 offen offset:2048 lds
mvaa 152,232,60
wl 12
tra 232,248,64
mvaa 148,236,56
tra 234,248,832
mvaa 156,236,60
wl 12
tra 236,248,96
buffer_store_dwordx4 v[104:107], v250, s[60:63], s91 offen offset:1024 sc1
mvaa 128,208,64
tra 238,248,864
mvaa 136,208,68
wl 12
tra 208,248,128
mvaa 132,212,64
tra 210,248,896
mvaa 140,212,68
wl 12
s_add_u32 m0, s74, 0x3080
tra 212,248,160
mvaa 144,216,64
s_add_u32 s89, s90, 0xd2000
tra 214,248,928
buffer_load_dwordx4 v232, s[56:59], s89 offen lds
mvaa 152,216,68
wl 12
tra 216,248,192
mvaa 148,220,64
tra 218,248,960
cv 112,112
mvaa 156,220,68
wl 12
tra 220,248,224
tra 222,248,992
mvaa 128,224,72
s_waitcnt vmcnt(12)
v_cmp_ne_u32 vcc, 0, v251
s_nop 0
s_and_b32 s88, vcc_lo, 0x1ff
s_cmp_lg_u32 s88, 0x1ff
s_cbranch_scc1 L_k1_sp_u435
L_k1_sb_u436:
mvaa 136,224,76
wl 12
tra 224,248,256
mvaa 132,228,72
tra 226,248,1024
mvaa 140,228,76
wl 12
tra 228,248,288
buffer_load_dwordx4 v233, s[56:59], s89 offen offset:1024 lds
mvaa 144,232,72
tra 230,248,1056
mvaa 152,232,76
wl 12
tra 232,248,320
cv 113,114
mvaa 148,236,72
s_add_u32 s90, s70, 8
tra 234,248,1088
mvaa 156,236,76
wl 12
s_add_u32 s75, s11, 0
tra 236,248,352
mvaa 128,208,80
L_k1_ps20:
s_cbranch_execz L_k1_pr2
tra 238,248,1120
mvaa 136,208,84
wl 12
s_and_b32 s90, s90, 7
tra 208,248,12416
mvaa 132,212,80
tra 210,248,13184
mvaa 140,212,84
wl 12
tra 212,248,12448
buffer_load_dwordx4 v234, s[56:59], s89 offen offset:2048 lds
mvaa 144,216,80
s_add_u32 s90, s90, s97
tra 214,248,13216
mvaa 152,216,84
wl 12
tra 216,248,12480
cv 114,116
mvaa 148,220,80
s_sub_u32 s25, s90, 10
tra 218,248,13248
mvaa 156,220,84
wl 12
tra 220,248,12512
mvaa 128,224,88
s_min_u32 s90, s90, s25
tra 222,248,13280
mvaa 136,224,92
wl 12
s_add_u32 m0, s74, 0x9180
tra 224,248,12544
mvaa 132,228,88
s_lshl_b32 s90, s90, 7
s_add_u32 s89, s90, 0
tra 226,248,13312
mvaa 140,228,92
wl 12
tra 228,248,12576
buffer_load_dwordx4 v232, s[56:59], s89 offen lds
mvaa 144,232,88
tra 230,248,13344
mvaa 152,232,92
wl 12
tra 232,248,12608
cv 115,118
mvaa 148,236,88
buffer_load_dwordx4 a[160:163], v250, s[60:63], s75 offen offset:0 sc1
mvaa 156,236,92
wl 11
tra 234,248,13376
mvav 128,208,0
tra 236,248,12640
mvav 136,208,8
wl 11
tra 238,248,13408
mvav 132,212,0
tra 208,248,12672
mvav 140,212,8
wl 11
buffer_load_dwordx4 v233, s[56:59], s89 offen offset:1024 lds
mvav 144,216,0
tra 210,248,13440
mvav 152,216,8
wl 10
tra 212,248,12704
mvav 148,220,0
tra 214,248,13472
mvav 156,220,8
wl 10
tra 216,248,12736
mvav 128,224,16
tra 218,248,13504
mvav 136,224,24
wl 10
buffer_load_dwordx4 a[164:167], v250, s[60:63], s75 offen offset:1024 sc1
mvav 132,228,16
tra 220,248,12768
mvav 140,228,24
wl 9
tra 222,248,13536
mvav 144,232,16
buffer_load_dwordx4 v234, s[56:59], s89 offen offset:2048 lds
mvav 152,232,24
wl 8
buffer_store_dwordx4 v[112:115], v250, s[60:63], s91 offen offset:2048 sc1
mvav 148,236,16
wl 0
cv 120,120
mvav 156,236,24
s_barrier
mvav 128,208,32
tra 224,249,0
tra 226,249,768
mvav 136,208,40
tra 228,249,32
tra 230,249,800
mvav 132,212,32
s_add_u32 m0, s74, 0xc200
tra 232,249,64
tra 234,249,832
mvav 140,212,40
tra 236,249,96
tra 238,249,864
mvav 144,216,32
s_add_u32 s89, s90, 0x1e000
tra 208,249,128
buffer_load_dwordx4 v232, s[56:59], s89 offen lds
mvav 152,216,40
tra 210,249,896
cv 121,122
mvav 148,220,32
tra 212,249,160
tra 214,249,928
mvav 156,220,40
wl 10
tra 216,249,192
tra 218,249,960
mvav 128,224,48
s_mov_b64 exec, 0x800
buffer_store_dword v243, v243, s[60:63], 0 offen sc1
s_mov_b64 exec, -1
mvav 136,224,56
wl 10
tra 220,249,224
tra 222,249,992
mvav 132,228,48
tra 224,249,256
tra 226,249,1024
mvav 140,228,56
wl 12
tra 228,249,288
tra 230,249,1056
mvav 144,232,48
buffer_load_dwordx4 v233, s[56:59], s89 offen offset:1024 lds
mvav 152,232,56
wl 12
tra 232,249,320
cv 122,124
mvav 148,236,48
tra 234,249,1088
mvav 156,236,56
wl 12
tra 236,249,352
buffer_load_dwordx4 a[168:171], v250, s[60:63], s75 offen offset:2048 sc1
mvav 128,208,64
tra 238,249,1120
mvav 136,208,72
wl 12
tra 208,249,12416
buffer_load_dwordx4 a[172:175], v250, s[60:63], s75 offen offset:3072 sc1
mvav 132,212,64
tra 210,249,13184
mvav 140,212,72
wl 12
tra 212,249,12448
tra 214,249,13216
mvav 144,216,64
buffer_load_dwordx4 v234, s[56:59], s89 offen offset:2048 lds
mvav 152,216,72
wl 12
tra 216,249,12480
cv 123,126
mvav 148,220,64
tra 218,249,13248
mvav 156,220,72
wl 12
tra 220,249,12512
mvav 128,224,80
tra 222,249,13280
mvav 136,224,88
wl 12
tra 224,249,12544
mvav 132,228,80
tra 226,249,13312
mvav 140,228,88
wl 12
s_add_u32 m0, s74, 0xf280
tra 228,249,12576
mvav 144,232,80
s_add_u32 s89, s90, 0x3c000
tra 230,249,13344
buffer_load_dwordx4 v232, s[56:59], s89 offen lds
mvav 152,232,88
wl 12
tra 232,249,12608
mvav 148,236,80
tra 234,249,13376
mvav 156,236,88
wl 12
tra 236,249,12640
buffer_store_dwordx4 v[120:123], v250, s[60:63], s91 offen offset:3072 sc1
zvaa 160,208,96
s_add_u32 s75, s11, 0x1000
tra 238,249,13408
zvaa 168,208,100
wl 12
tra 208,249,12672
zvaa 164,212,96
tra 210,249,13440
zvaa 172,212,100
wl 12
tra 212,249,12704
buffer_load_dwordx4 v233, s[56:59], s89 offen offset:1024 lds
zvaa 176,216,96
tra 214,249,13472
zvaa 184,216,100
wl 12
s_add_u32 s91, s70, 6
tra 216,249,12736
zvaa 180,220,96
tra 218,249,13504
zvaa 188,220,100
wl 12
tra 220,249,12768
mvaa 160,224,104
s_and_b32 s91, s91, 7
tra 222,249,13536
mvaa 168,224,108
wl 12
tra 224,249,24832
mvaa 164,228,104
tra 226,249,25600
mvaa 172,228,108
wl 12
tra 228,249,24864
buffer_load_dwordx4 v234, s[56:59], s89 offen offset:2048 lds
mvaa 176,232,104
s_mul_i32 s91, s91, 0x25000
tra 230,249,25632
mvaa 184,232,108
wl 12
tra 232,249,24896
tra 234,249,25664
mvaa 180,236,104
buffer_load_dwordx4 a[176:179], v250, s[60:63], s75 offen offset:0 sc1
mvaa 188,236,108
wl 12
s_add_u32 s91, s91, 0x7000
tra 236,249,24928
mvaa 160,208,112
tra 238,249,25696
mvaa 168,208,116
wl 12
tra 208,249,24960
cv 128,128
mvaa 164,212,112
s_add_u32 s89, s90, 0x5a000
s_add_u32 m0, s74, 0x12300
tra 210,249,25728
mvaa 172,212,116
wl 12
tra 212,249,24992
buffer_load_dwordx4 v232, s[56:59], s89 offen lds
mvaa 176,216,112
tra 214,249,25760
cv 129,130
mvaa 184,216,116
wl 12
tra 216,249,25024
mvaa 180,220,112
tra 218,249,25792
cv 130,132
mvaa 188,220,116
wl 12
tra 220,249,25056
mvaa 160,224,120
buffer_load_dwordx4 a[180:183], v250, s[60:63], s75 offen offset:1024 sc1
mvaa 168,224,124
wl 11
tra 222,249,25824
cv 131,134
mvaa 164,228,120
tra 224,249,25088
mvaa 172,228,124
wl 11
buffer_load_dwordx4 v233, s[56:59], s89 offen offset:1024 lds
mvaa 176,232,120
tra 226,249,25856
mvaa 184,232,124
wl 10
tra 228,249,25120
mvaa 180,236,120
buffer_store_dwordx4 v[128:131], v250, s[60:63], s91 offen offset:0 sc1
mvaa 188,236,124
wl 9
tra 230,249,25888
cv 136,136
mvaa 160,208,128
tra 232,249,25152
mvaa 168,208,132
wl 9
tra 234,249,25920
cv 137,138
mvaa 164,212,128
tra 236,249,25184
cv 138,140
mvaa 172,212,132
wl 9
tra 238,249,25952
cv 139,142
mvaa 176,216,128
buffer_load_dwordx4 v234, s[56:59], s89 offen offset:2048 lds
mvaa 184,216,132
wl 8
buffer_store_dwordx4 v[136:139], v250, s[60:63], s91 offen offset:1024 sc1
mvaa 180,220,128
s_waitcnt vmcnt(35) lgkmcnt(0)
mvaa 188,220,132
s_barrier
mvaa 160,224,136
tra 208,248,24832
tra 210,248,25600
mvaa 168,224,140
tra 212,248,24864
tra 214,248,25632
mvaa 164,228,136
s_add_u32 m0, s74, 0x1e500
tra 216,248,24896
tra 218,248,25664
mvaa 172,228,140
tra 220,248,24928
tra 222,248,25696
mvaa 176,232,136
s_add_u32 s89, s90, 0x78000
tra 224,248,24960
buffer_load_dwordx4 v232, s[56:59], s89 offen lds
mvaa 184,232,140
tra 226,248,25728
cv 144,144
mvaa 180,236,136
tra 228,248,24992
tra 230,248,25760
mvaa 188,236,140
wl 10
tra 232,248,25024
buffer_load_dwordx4 a[184:187], v250, s[60:63], s75 offen offset:2048 sc1
mvaa 160,208,0
tra 234,248,25792
cv 145,146
mvaa 168,208,4
wl 10
tra 236,248,25056
buffer_load_dwordx4 a[188:191], v250, s[60:63], s75 offen offset:3072 sc1
mvaa 164,212,0
tra 238,248,25824
tra 208,248,25088
mvaa 172,212,4
wl 11
tra 210,248,25856
cv 146,148
mvaa 176,216,0
tra 212,248,25120
buffer_load_dwordx4 v233, s[56:59], s89 offen offset:1024 lds
mvaa 184,216,4
wl 11
tra 214,248,25888
tra 216,248,25152
mvaa 180,220,0
tra 218,248,25920
cv 147,150
mvaa 188,220,4
wl 12
tra 220,248,25184
tra 222,248,25952
mvaa 160,224,8
buffer_store_dwordx4 v[144:147], v250, s[60:63], s91 offen offset:2048 sc1
mvaa 168,224,12
wl 12
tra 224,247,0
mvaa 164,228,8
tra 226,247,768
mvaa 172,228,12
wl 12
tra 228,247,32
cv 152,152
mvaa 176,232,8
tra 230,247,800
buffer_load_dwordx4 v234, s[56:59], s89 offen offset:2048 lds
mvaa 184,232,12
wl 12
tra 232,247,64
mvaa 180,236,8
tra 234,247,832
cv 153,154
mvaa 188,236,12
wl 12
s_add_u32 s75, s11, 0x2000
tra 236,247,96
mvaa 160,208,16
tra 238,247,864
mvaa 168,208,20
wl 12
tra 208,247,128
cv 154,156
mvaa 164,212,16
tra 210,247,896
mvaa 172,212,20
wl 12
s_add_u32 m0, s74, 0x21580
tra 212,247,160
mvaa 176,216,16
s_add_u32 s89, s90, 0x96000
tra 214,247,928
buffer_load_dwordx4 v232, s[56:59], s89 offen lds
mvaa 184,216,20
wl 12
tra 216,247,192
cv 155,158
mvaa 180,220,16
tra 218,247,960
mvaa 188,220,20
wl 12
tra 220,247,224
buffer_store_dwordx4 v[152:155], v250, s[60:63], s91 offen offset:3072 sc1
mvaa 160,224,24
tra 222,247,992
mvaa 168,224,28
wl 12
tra 224,247,256
mvaa 164,228,24
tra 226,247,1024
mvaa 172,228,28
wl 12
tra 228,247,288
buffer_load_dwordx4 v233, s[56:59], s89 offen offset:1024 lds
mvaa 176,232,24
tra 230,247,1056
mvaa 184,232,28
wl 12
tra 232,247,320
tra 234,247,1088
mvaa 180,236,24
buffer_load_dwordx4 a[192:195], v250, s[60:63], s75 offen offset:0 sc1
mvaa 188,236,28
wl 12
tra 236,247,352
mvaa 160,208,32
tra 238,247,1120
mvaa 168,208,36
wl 12
tra 208,248,37248
mvaa 164,212,32
tra 210,248,38016
mvaa 172,212,36
wl 12
tra 212,248,37280
buffer_load_dwordx4 v234, s[56:59], s89 offen offset:2048 lds
mvaa 176,216,32
tra 214,248,38048
mvaa 184,216,36
wl 12
tra 216,248,37312
mvaa 180,220,32
tra 218,248,38080
mvaa 188,220,36
wl 12
tra 220,248,37344
tra 222,248,38112
mvaa 160,224,40
buffer_load_dwordx4 a[196:199], v250, s[60:63], s75 offen offset:1024 sc1
mvaa 168,224,44
wl 12
tra 224,248,37376
mvaa 164,228,40
s_add_u32 s89, s90, 0xb4000
s_add_u32 m0, s74, 0x24600
tra 226,248,38144
mvaa 172,228,44
wl 12
tra 228,248,37408
buffer_load_dwordx4 v232, s[56:59], s89 offen lds
mvaa 176,232,40
tra 230,248,38176
mvaa 184,232,44
wl 12
tra 232,248,37440
mvaa 180,236,40
tra 234,248,38208
mvaa 188,236,44
wl 12
tra 236,248,37472
mvaa 160,208,48
buffer_load_dword v251, v242, s[60:63], s12 offen sc1
mvaa 168,208,52
wl 11
tra 238,248,38240
mvaa 164,212,48
tra 208,248,37504
mvaa 172,212,52
wl 11
buffer_load_dwordx4 v233, s[56:59], s89 offen offset:1024 lds
mvaa 176,216,48
tra 210,248,38272
mvaa 184,216,52
wl 10
tra 212,248,37536
mvaa 180,220,48
buffer_load_dwordx4 a[200:203], v250, s[60:63], s75 offen offset:2048 sc1
mvaa 188,220,52
wl 9
tra 214,248,38304
mvaa 160,224,56
tra 216,248,37568
mvaa 168,224,60
wl 9
tra 218,248,38336
mvaa 164,228,56
tra 220,248,37600
mvaa 172,228,60
wl 9
tra 222,248,38368
mvaa 176,232,56
buffer_load_dwordx4 v234, s[56:59], s89 offen offset:2048 lds
mvaa 184,232,60
wl 8
buffer_load_dwordx4 a[204:207], v250, s[60:63], s75 offen offset:3072 sc1
mvaa 180,236,56
s_waitcnt vmcnt(41) lgkmcnt(0)
mvaa 188,236,60
s_barrier
mvaa 160,208,64
tra 224,248,49664
tra 226,248,50432
mvaa 168,208,68
tra 228,248,49696
tra 230,248,50464
mvaa 164,212,64
tra 232,248,49728
tra 234,248,50496
mvaa 172,212,68
tra 236,248,49760
tra 238,248,50528
mvaa 176,216,64
tra 208,248,49792
tra 210,248,50560
mvaa 184,216,68
tra 212,248,49824
tra 214,248,50592
mvaa 180,220,64
tra 216,248,49856
tra 218,248,50624
mvaa 188,220,68
wl 12
tra 220,248,49888
tra 222,248,50656
mvaa 160,224,72
s_waitcnt vmcnt(27)
s_mov_b64 exec, 0x1000
buffer_store_dword v243, v243, s[60:63], 0 offen sc1
s_mov_b64 exec, -1
mvaa 168,224,76
wl 12
tra 224,248,49920
mvaa 164,228,72
s_add_u32 s89, s90, 0xd2000
tra 226,248,50688
mvaa 172,228,76
wl 12
s_add_u32 m0, s74, 0x15380
tra 228,248,49952
mvaa 176,232,72
L_k1_ps21:
s_cbranch_execz L_k1_pr2
tra 230,248,50720
mvaa 184,232,76
wl 12
tra 232,248,49984
buffer_load_dwordx4 v232, s[56:59], s89 offen lds
mvaa 180,236,72
tra 234,248,50752
mvaa 188,236,76
wl 12
tra 236,248,50016
mvaa 160,208,80
tra 238,248,50784
mvaa 168,208,84
wl 12
tra 208,247,24832
mvaa 164,212,80
tra 210,247,25600
mvaa 172,212,84
wl 12
tra 212,247,24864
mvaa 176,216,80
tra 214,247,25632
mvaa 184,216,84
wl 12
tra 216,247,24896
mvaa 180,220,80
tra 218,247,25664
mvaa 188,220,84
wl 12
tra 220,247,24928
mvaa 160,224,88
tra 222,247,25696
mvaa 168,224,92
wl 12
tra 224,247,24960
mvaa 164,228,88
tra 226,247,25728
mvaa 172,228,92
wl 12
tra 228,247,24992
mvaa 176,232,88
tra 230,247,25760
mvaa 184,232,92
wl 12
tra 232,247,25024
mvaa 180,236,88
tra 234,247,25792
mvaa 188,236,92
wl 12
tra 236,247,25056
mvav 160,208,0
tra 238,247,25824
mvav 168,208,8
wl 12
tra 208,247,25088
mvav 164,212,0
tra 210,247,25856
mvav 172,212,8
wl 12
buffer_load_dwordx4 v233, s[56:59], s89 offen offset:1024 lds
mvav 176,216,0
tra 212,247,25120
mvav 184,216,8
wl 11
tra 214,247,25888
mvav 180,220,0
tra 216,247,25152
mvav 188,220,8
wl 11
tra 218,247,25920
mvav 160,224,16
tra 220,247,25184
mvav 168,224,24
wl 11
tra 222,247,25952
mvav 164,228,16
tra 224,247,12416
mvav 172,228,24
wl 11
tra 226,247,13184
mvav 176,232,16
tra 228,247,12448
mvav 184,232,24
wl 11
tra 230,247,13216
mvav 180,236,16
tra 232,247,12480
mvav 188,236,24
wl 11
tra 234,247,13248
mvav 160,208,32
tra 236,247,12512
mvav 168,208,40
wl 11
tra 238,247,13280
mvav 164,212,32
tra 208,247,12544
mvav 172,212,40
wl 11
tra 210,247,13312
mvav 176,216,32
tra 212,247,12576
mvav 184,216,40
wl 11
tra 214,247,13344
mvav 180,220,32
tra 216,247,12608
mvav 188,220,40
wl 11
tra 218,247,13376
mvav 160,224,48
s_waitcnt vmcnt(7)
v_cmp_ne_u32 vcc, 0, v251
s_nop 0
s_and_b32 s88, vcc_lo, 0xe00
s_cmp_lg_u32 s88, 0xe00
s_cbranch_scc1 L_k1_sp_u437
L_k1_sb_u438:
mvav 168,224,56
wl 10
tra 220,247,12640
mvav 164,228,48
tra 222,247,13408
mvav 172,228,56
wl 10
buffer_load_dwordx4 v234, s[56:59], s89 offen offset:2048 lds
mvav 176,232,48
tra 224,247,12672
mvav 184,232,56
wl 9
tra 226,247,13440
mvav 180,236,48
tra 228,247,12704
mvav 188,236,56
wl 9
s_add_u32 s75, s11, 0x3000
tra 230,247,13472
mvav 160,208,64
tra 232,247,12736
mvav 168,208,72
wl 9
tra 234,247,13504
mvav 164,212,64
tra 236,247,12768
mvav 172,212,72
wl 9
tra 238,247,13536
mvav 176,216,64
buffer_load_dwordx4 a[144:147], v250, s[60:63], s75 offen offset:0 sc1
mvav 184,216,72
wl 8
buffer_load_dwordx4 a[148:151], v250, s[60:63], s75 offen offset:1024 sc1
mvav 180,220,64
wl 0
mvav 188,220,72
s_barrier
mvav 160,224,80
tra 208,247,37248
tra 210,247,38016
mvav 168,224,88
tra 212,247,37280
tra 214,247,38048
mvav 164,228,80
tra 216,247,37312
tra 218,247,38080
mvav 172,228,88
tra 220,247,37344
tra 222,247,38112
mvav 176,232,80
tra 224,247,37376
tra 226,247,38144
mvav 184,232,88
tra 228,247,37408
tra 230,247,38176
mvav 180,236,80
tra 232,247,37440
tra 234,247,38208
mvav 188,236,88
wl 12
tra 236,247,37472
zvaa 192,208,96
tra 238,247,38240
zvaa 200,208,100
wl 12
tra 208,247,37504
zvaa 196,212,96
tra 210,247,38272
zvaa 204,212,100
wl 12
tra 212,247,37536
zvaa 208,216,96
s_add_u32 s91, s70, 7
s_and_b32 s91, s91, 7
tra 214,247,38304
zvaa 216,216,100
wl 12
s_mul_i32 s91, s91, 0x25000
tra 216,247,37568
zvaa 212,220,96
s_add_u32 s91, s91, 0x8000
tra 218,247,38336
cv 160,160
zvaa 220,220,100
wl 12
tra 220,247,37600
cv 161,162
mvaa 192,224,104
tra 222,247,38368
cv 162,164
mvaa 200,224,108
wl 12
tra 224,247,49664
cv 163,166
mvaa 196,228,104
tra 226,247,50432
buffer_store_dwordx4 v[160:163], v250, s[60:63], s91 offen offset:0 sc1
mvaa 204,228,108
wl 12
tra 228,247,49696
cv 168,168
mvaa 208,232,104
tra 230,247,50464
cv 169,170
mvaa 216,232,108
wl 12
tra 232,247,49728
cv 170,172
mvaa 212,236,104
tra 234,247,50496
cv 171,174
mvaa 220,236,108
wl 12
tra 236,247,49760
buffer_store_dwordx4 v[168:171], v250, s[60:63], s91 offen offset:1024 sc1
mvaa 192,208,112
tra 238,247,50528
cv 176,176
mvaa 200,208,116
wl 12
tra 208,247,49792
cv 177,178
mvaa 196,212,112
tra 210,247,50560
cv 178,180
mvaa 204,212,116
wl 12
tra 212,247,49824
cv 179,182
mvaa 208,216,112
tra 214,247,50592
buffer_store_dwordx4 v[176:179], v250, s[60:63], s91 offen offset:2048 sc1
cv 184,184
mvaa 216,216,116
wl 12
tra 216,247,49856
cv 185,186
mvaa 212,220,112
tra 218,247,50624
cv 186,188
cv 187,190
mvaa 220,220,116
wl 12
tra 220,247,49888
buffer_store_dwordx4 v[184:187], v250, s[60:63], s91 offen offset:3072 sc1
mvaa 192,224,120
s_mov_b64 exec, 0x2000
buffer_store_dword v243, v243, s[60:63], 0 offen sc1
s_mov_b64 exec, -1
mvaa 200,224,124
wl 11
tra 222,247,50656
tra 224,247,49920
mvaa 196,228,120
tra 226,247,50688
mvaa 204,228,124
wl 12
buffer_load_dwordx4 a[152:155], v250, s[60:63], s75 offen offset:2048 sc1
mvaa 208,232,120
buffer_load_dwordx4 a[156:159], v250, s[60:63], s75 offen offset:3072 sc1
mvaa 216,232,124
wl 10
tra 228,247,49952
mvaa 212,236,120
tra 230,247,50720
mvaa 220,236,124
wl 10
tra 232,247,49984
mvaa 192,208,128
tra 234,247,50752
mvaa 200,208,132
wl 10
tra 236,247,50016
mvaa 196,212,128
tra 238,247,50784
mvaa 204,212,132
wl 10
tra 208,248,0
mvaa 208,216,128
tra 210,248,768
mvaa 216,216,132
wl 10
tra 212,248,32
mvaa 212,220,128
s_add_u32 s75, s11, 0x4000
tra 214,248,800
mvaa 220,220,132
wl 10
tra 216,248,64
mvaa 192,224,136
tra 218,248,832
mvaa 200,224,140
wl 10
tra 220,248,96
mvaa 196,228,136
tra 222,248,864
mvaa 204,228,140
wl 10
tra 224,248,128
mvaa 208,232,136
tra 226,248,896
mvaa 216,232,140
wl 10
tra 228,248,160
mvaa 212,236,136
tra 230,248,928
mvaa 220,236,140
wl 10
tra 232,248,192
mvaa 192,208,0
tra 234,248,960
mvaa 200,208,4
wl 10
buffer_load_dwordx4 v[68:71], v250, s[60:63], s75 offen offset:0 sc1
mvaa 196,212,0
tra 236,248,224
mvaa 204,212,4
wl 9
tra 238,248,992
mvaa 208,216,0
tra 208,248,256
mvaa 216,216,4
wl 9
tra 210,248,1024
mvaa 212,220,0
tra 212,248,288
mvaa 220,220,4
wl 9
tra 214,248,1056
mvaa 192,224,8
tra 216,248,320
mvaa 200,224,12
wl 9
tra 218,248,1088
mvaa 196,228,8
tra 220,248,352
mvaa 204,228,12
wl 9
tra 222,248,1120
mvaa 208,232,8
buffer_load_dwordx4 v[76:79], v250, s[60:63], s75 offen offset:1024 sc1
mvaa 216,232,12
wl 8
buffer_load_dwordx4 v[84:87], v250, s[60:63], s75 offen offset:2048 sc1
mvaa 212,236,8
wl 0
mvaa 220,236,12
s_barrier
mvaa 192,208,16
tra 224,248,12416
tra 226,248,13184
mvaa 200,208,20
tra 228,248,12448
tra 230,248,13216
mvaa 196,212,16
tra 232,248,12480
tra 234,248,13248
mvaa 204,212,20
tra 236,248,12512
tra 238,248,13280
mvaa 208,216,16
tra 208,248,12544
tra 210,248,13312
mvaa 216,216,20
tra 212,248,12576
tra 214,248,13344
mvaa 212,220,16
tra 216,248,12608
tra 218,248,13376
mvaa 220,220,20
wl 12
tra 220,248,12640
mvaa 192,224,24
tra 222,248,13408
mvaa 200,224,28
wl 12
tra 224,248,12672
mvaa 196,228,24
tra 226,248,13440
mvaa 204,228,28
wl 12
tra 228,248,12704
mvaa 208,232,24
tra 230,248,13472
mvaa 216,232,28
wl 12
tra 232,248,12736
mvaa 212,236,24
tra 234,248,13504
mvaa 220,236,28
wl 12
tra 236,248,12768
mvaa 192,208,32
tra 238,248,13536
mvaa 200,208,36
wl 12
tra 208,249,0
mvaa 196,212,32
tra 210,249,768
mvaa 204,212,36
wl 12
tra 212,249,32
buffer_load_dwordx4 v[92:95], v250, s[60:63], s75 offen offset:3072 sc1
mvaa 208,216,32
tra 214,249,800
mvaa 216,216,36
wl 12
tra 216,249,64
mvaa 212,220,32
tra 218,249,832
mvaa 220,220,36
wl 12
tra 220,249,96
mvaa 192,224,40
tra 222,249,864
mvaa 200,224,44
wl 12
tra 224,249,128
mvaa 196,228,40
tra 226,249,896
mvaa 204,228,44
wl 12
tra 228,249,160
mvaa 208,232,40
tra 230,249,928
mvaa 216,232,44
wl 12
tra 232,249,192
mvaa 212,236,40
s_add_u32 s75, s11, 0x5000
tra 234,249,960
mvaa 220,236,44
wl 12
tra 236,249,224
mvaa 192,208,48
tra 238,249,992
mvaa 200,208,52
wl 12
tra 208,249,256
mvaa 196,212,48
tra 210,249,1024
mvaa 204,212,52
wl 12
tra 212,249,288
mvaa 208,216,48
tra 214,249,1056
mvaa 216,216,52
wl 12
tra 216,249,320
mvaa 212,220,48
tra 218,249,1088
mvaa 220,220,52
wl 12
tra 220,249,352
mvaa 192,224,56
tra 222,249,1120
mvaa 200,224,60
wl 12
buffer_load_dwordx4 v[4:7], v250, s[60:63], s75 offen offset:0 sc1
mvaa 196,228,56
tra 224,249,12416
mvaa 204,228,60
wl 11
tra 226,249,13184
mvaa 208,232,56
tra 228,249,12448
mvaa 216,232,60
wl 11
tra 230,249,13216
mvaa 212,236,56
tra 232,249,12480
mvaa 220,236,60
wl 11
tra 234,249,13248
mvaa 192,208,64
tra 236,249,12512
mvaa 200,208,68
wl 11
tra 238,249,13280
mvaa 196,212,64
tra 208,249,12544
mvaa 204,212,68
wl 11
tra 210,249,13312
mvaa 208,216,64
buffer_load_dwordx4 v[12:15], v250, s[60:63], s75 offen offset:1024 sc1
mvaa 216,216,68
wl 10
tra 212,249,12576
mvaa 212,220,64
tra 214,249,13344
mvaa 220,220,68
wl 10
tra 216,249,12608
mvaa 192,224,72
tra 218,249,13376
mvaa 200,224,76
wl 10
tra 220,249,12640
mvaa 196,228,72
tra 222,249,13408
mvaa 204,228,76
wl 10
tra 224,249,12672
mvaa 208,232,72
tra 226,249,13440
mvaa 216,232,76
wl 10
tra 228,249,12704
mvaa 212,236,72
tra 230,249,13472
mvaa 220,236,76
wl 10
buffer_load_dwordx4 v[20:23], v250, s[60:63], s75 offen offset:2048 sc1
mvaa 192,208,80
tra 232,249,12736
mvaa 200,208,84
wl 9
tra 234,249,13504
mvaa 196,212,80
tra 236,249,12768
mvaa 204,212,84
wl 9
tra 238,249,13536
mvaa 208,216,80
s_waitcnt vmcnt(10)
s_mov_b64 exec, 0x4000
buffer_store_dword v243, v243, s[60:63], 0 offen sc1
s_mov_b64 exec, -1
mvaa 216,216,84
wl 8
buffer_load_dwordx4 v[28:31], v250, s[60:63], s75 offen offset:3072 sc1
mvaa 212,220,80
wl 0
mvaa 220,220,84
s_barrier
mvaa 192,224,88
tra 208,249,24832
mvaa 200,224,92
tra 210,249,25600
mvaa 196,228,88
tra 212,249,24864
mvaa 204,228,92
tra 214,249,25632
mvaa 208,232,88
L_k1_ps22:
s_cbranch_execz L_k1_pr2
mvaa 216,232,92
tra 216,249,24896
mvaa 212,236,88
tra 218,249,25664
mvaa 220,236,92
wl 4
tra 220,249,24928
mvav 192,208,0
tra 222,249,25696
mvav 200,208,8
wl 4
tra 224,249,24960
mvav 196,212,0
tra 226,249,25728
mvav 204,212,8
wl 4
tra 228,249,24992
mvav 208,216,0
tra 230,249,25760
mvav 216,216,8
wl 4
tra 232,249,25024
mvav 212,220,0
tra 234,249,25792
mvav 220,220,8
wl 4
tra 236,249,25056
mvav 192,224,16
tra 238,249,25824
mvav 200,224,24
wl 4
tra 208,249,25088
mvav 196,228,16
tra 210,249,25856
mvav 204,228,24
wl 4
tra 212,249,25120
mvav 208,232,16
tra 214,249,25888
mvav 216,232,24
wl 4
tra 216,249,25152
mvav 212,236,16
tra 218,249,25920
mvav 220,236,24
wl 4
tra 220,249,25184
mvav 192,208,32
tra 222,249,25952
mvav 200,208,40
wl 4
tra 224,248,24832
mvav 196,212,32
tra 226,248,25600
mvav 204,212,40
wl 4
tra 228,248,24864
mvav 208,216,32
tra 230,248,25632
mvav 216,216,40
wl 4
tra 232,248,24896
mvav 212,220,32
tra 234,248,25664
mvav 220,220,40
wl 4
tra 236,248,24928
mvav 192,224,48
tra 238,248,25696
mvav 200,224,56
wl 4
tra 208,248,24960
mvav 196,228,48
tra 210,248,25728
mvav 204,228,56
wl 4
tra 212,248,24992
mvav 208,232,48
tra 214,248,25760
mvav 216,232,56
wl 4
tra 216,248,25024
mvav 212,236,48
tra 218,248,25792
mvav 220,236,56
wl 4
tra 220,248,25056
mvav 192,208,64
tra 222,248,25824
mvav 200,208,72
wl 4
tra 224,248,25088
mvav 196,212,64
tra 226,248,25856
mvav 204,212,72
wl 4
tra 228,248,25120
mvav 208,216,64
buffer_load_dword v251, v242, s[60:63], s12 offen sc1
mvav 216,216,72
wl 3
tra 230,248,25888
mvav 212,220,64
tra 232,248,25152
mvav 220,220,72
wl 3
tra 234,248,25920
mvav 192,224,80
tra 236,248,25184
mvav 200,224,88
wl 3
tra 238,248,25952
mvav 196,228,80
mvav 204,228,88
wl 2
mvav 208,232,80
mvav 216,232,88
wl 0
mvav 212,236,80
mvav 220,236,88
zvaa 224,242,160
zvaa 228,240,160
s_lshr_b32 s91, s70, 2
mvaa 224,242,164
mvaa 228,240,164
mvaa 224,242,168
s_add_u32 s91, s91, s9
mvaa 228,240,168
mvaa 224,242,172
s_sub_u32 s25, s91, 10
mvaa 228,240,172
mvaa 224,242,176
mvaa 228,240,176
s_min_u32 s91, s91, s25
mvaa 224,242,180
mvaa 228,240,180
s_lshl_b32 s91, s91, 7
mvaa 224,242,184
mvaa 228,240,184
mvaa 224,242,188
s_and_b32 s25, s70, 3
mvaa 228,240,188
mvaa 192,242,192
s_lshl_b32 s25, s25, 5
mvaa 196,240,192
mvaa 200,242,196
mvaa 204,240,196
s_add_u32 s91, s91, s25
mvaa 208,242,200
mvaa 212,240,200
cv 224,224
mvaa 216,242,204
mvaa 220,240,204
mvaa 192,242,144
cv 225,226
mvaa 196,240,144
mvaa 200,242,148
mvaa 204,240,148
cv 226,228
s_waitcnt vmcnt(11)
mvaa 208,242,152
mvaa 212,240,152
s_waitcnt vmcnt(10)
mvaa 216,242,156
cv 227,230
mvaa 220,240,156
s_waitcnt vmcnt(9)
mvav 192,242,68
mvav 196,240,68
v_permlane32_swap_b32 v224, v226
s_waitcnt vmcnt(8)
mvav 200,242,76
mvav 204,240,76
s_waitcnt vmcnt(7)
mvav 208,242,84
v_permlane32_swap_b32 v225, v227
mvav 212,240,84
s_waitcnt vmcnt(6)
mvav 216,242,92
mvav 220,240,92
buffer_store_dwordx4 v[224:227], v241, s[64:67], s91 offen offset:0 nt
s_waitcnt vmcnt(6)
mvav 192,242,4
mvav 196,240,4
s_waitcnt vmcnt(5)
mvav 200,242,12
mvav 204,240,12
s_waitcnt vmcnt(4)
mvav 208,242,20
mvav 212,240,20
s_waitcnt vmcnt(2)
mvav 216,242,28
s_waitcnt vmcnt(1)
v_cmp_ne_u32 vcc, 0, v251
s_nop 0
s_and_b32 s88, vcc_lo, 0x7000
s_cmp_lg_u32 s88, 0x7000
s_cbranch_scc1 L_k1_sp_u439
L_k1_sb_u440:
s_add_u32 s75, s11, 0x6000
buffer_load_dwordx4 v[36:39], v250, s[60:63], s75 offen offset:0 sc1
buffer_load_dwordx4 v[44:47], v250, s[60:63], s75 offen offset:1024 sc1
buffer_load_dwordx4 v[52:55], v250, s[60:63], s75 offen offset:2048 sc1
buffer_load_dwordx4 v[60:63], v250, s[60:63], s75 offen offset:3072 sc1
s_add_u32 s75, s11, 0x7000
buffer_load_dwordx4 v[96:99], v250, s[60:63], s75 offen offset:0 sc1
buffer_load_dwordx4 v[100:103], v250, s[60:63], s75 offen offset:1024 sc1
buffer_load_dwordx4 v[104:107], v250, s[60:63], s75 offen offset:2048 sc1
buffer_load_dwordx4 v[108:111], v250, s[60:63], s75 offen offset:3072 sc1
s_add_u32 s75, s11, 0x8000
buffer_load_dwordx4 v[112:115], v250, s[60:63], s75 offen offset:0 sc1
buffer_load_dwordx4 v[116:119], v250, s[60:63], s75 offen offset:1024 sc1
buffer_load_dwordx4 v[120:123], v250, s[60:63], s75 offen offset:2048 sc1
buffer_load_dwordx4 v[124:127], v250, s[60:63], s75 offen offset:3072 sc1
mvav 220,240,28
s_waitcnt vmcnt(11)
mvav 192,242,36
mvav 196,240,36
s_waitcnt vmcnt(10)
mvav 200,242,44
mvav 204,240,44
s_waitcnt vmcnt(9)
mvav 208,242,52
mvav 212,240,52
s_waitcnt vmcnt(8)
mvav 216,242,60
mvav 220,240,60
s_waitcnt vmcnt(7)
mvav 192,242,96
mvav 196,240,96
s_waitcnt vmcnt(6)
mvav 200,242,100
mvav 204,240,100
s_waitcnt vmcnt(5)
mvav 208,242,104
mvav 212,240,104
s_waitcnt vmcnt(4)
mvav 216,242,108
mvav 220,240,108
s_waitcnt vmcnt(3)
mvav 192,242,112
mvav 196,240,112
s_waitcnt vmcnt(2)
mvav 200,242,116
mvav 204,240,116
s_waitcnt vmcnt(1)
mvav 208,242,120
mvav 212,240,120
s_waitcnt vmcnt(0)
mvav 216,242,124
mvav 220,240,124
cv 192,192
cv 196,196
s_nop 1
cv 208,208
cv 212,212
cv 193,194
cv 197,198
cv 209,210
cv 213,214
cv 194,200
cv 198,204
cv 210,216
cv 214,220
cv 195,202
cv 199,206
cv 211,218
cv 215,222
v_permlane32_swap_b32 v192, v194
v_permlane32_swap_b32 v196, v198
v_permlane32_swap_b32 v208, v210
v_permlane32_swap_b32 v212, v214
v_permlane32_swap_b32 v193, v195
v_permlane32_swap_b32 v197, v199
v_permlane32_swap_b32 v209, v211
v_permlane32_swap_b32 v213, v215
buffer_store_dwordx4 v[192:195], v241, s[64:67], s90 offen offset:0 nt
buffer_store_dwordx4 v[196:199], v241, s[64:67], s90 offen offset:32 nt
buffer_store_dwordx4 v[208:211], v241, s[64:67], s90 offen offset:64 nt
buffer_store_dwordx4 v[212:215], v241, s[64:67], s90 offen offset:96 nt
L_k1_done:
s_endpgm
L_k1_psc0:
s_branch L_k1_pr2
L_k1_sp_u433:
s_add_u32 s15, s15, 1
s_cmp_gt_u32 s15, 0x400000
s_cbranch_scc1 L_k1_sb_u434
buffer_load_dword v251, off, s[4:7], s14 sc1
s_waitcnt vmcnt(0)
v_readfirstlane_b32 s88, v251
s_nop 0
s_cmp_lg_u32 s88, 0xff
s_cbranch_scc1 L_k1_sp_u433
s_branch L_k1_sb_u434
L_k1_sp_u435:
s_add_u32 s15, s15, 1
s_cmp_gt_u32 s15, 0x400000
s_cbranch_scc1 L_k1_sb_u436
buffer_load_dword v251, v242, s[60:63], s12 offen sc1
s_waitcnt vmcnt(0)
v_cmp_ne_u32 vcc, 0, v251
s_nop 0
s_and_b32 s88, vcc_lo, 0x1ff
s_cmp_lg_u32 s88, 0x1ff
s_cbranch_scc1 L_k1_sp_u435
s_branch L_k1_sb_u436
L_k1_sp_u437:
s_add_u32 s15, s15, 1
s_cmp_gt_u32 s15, 0x400000
s_cbranch_scc1 L_k1_sb_u438
buffer_load_dword v251, v242, s[60:63], s12 offen sc1
s_waitcnt vmcnt(0)
v_cmp_ne_u32 vcc, 0, v251
s_nop 0
s_and_b32 s88, vcc_lo, 0xe00
s_cmp_lg_u32 s88, 0xe00
s_cbranch_scc1 L_k1_sp_u437
s_branch L_k1_sb_u438
L_k1_sp_u439:
s_add_u32 s15, s15, 1
s_cmp_gt_u32 s15, 0x400000
s_cbranch_scc1 L_k1_sb_u440
buffer_load_dword v251, v242, s[60:63], s12 offen sc1
s_waitcnt vmcnt(0)
v_cmp_ne_u32 vcc, 0, v251
s_nop 0
s_and_b32 s88, vcc_lo, 0x7000
s_cmp_lg_u32 s88, 0x7000
s_cbranch_scc1 L_k1_sp_u439
s_branch L_k1_sb_u440
L_k1_hk_u14:
s_mul_i32 s88, s68, 0x3c00
s_add_u32 s88, s88, 0x18400
v_add_u32 v252, s88, v250
rqa 32,252,12288
rqa 36,252,13312
rqa 40,252,14336
v_accvgpr_write_b32 a44, v254
v_accvgpr_write_b32 a45, v255
v_accvgpr_write_b32 a46, v245
v_accvgpr_write_b32 a47, v246
v_add_u32 v245, 0x1e500, v241
v_add_u32 v246, 0x1e500, v242
s_branch L_k1_hb_u15
L_k1_hk_u58:
s_mul_i32 s88, s68, 0x3c00
s_add_u32 s88, s88, 0x18400
v_add_u32 v252, s88, v250
rqa 96,252,0
rqa 100,252,1024
rqa 104,252,2048
rqa 108,252,3072
s_branch L_k1_hb_u59
L_k1_hk_u73:
s_mul_i32 s88, s68, 0x3c00
s_add_u32 s88, s88, 0x18400
v_add_u32 v252, s88, v250
rqa 112,252,4096
rqa 116,252,5120
rqa 120,252,6144
rqa 124,252,7168
s_branch L_k1_hb_u74
L_k1_hk_u83:
s_mul_i32 s88, s68, 0x3c00
s_add_u32 s88, s88, 0x18400
v_add_u32 v252, s88, v250
rqa 128,252,8192
rqa 132,252,9216
rqa 136,252,10240
rqa 140,252,11264
s_branch L_k1_hb_u84
L_k1_hk_u92:
s_mov_b32 s56, s92
s_mov_b32 s57, s93
s_mov_b32 s58, 0xb4000
s_mov_b32 s77, 0x3c000
s_mov_b32 s79, 0xb4000
s_mov_b32 s80, 0xa000
s_mov_b32 s16, 0xa000
s_mov_b32 s17, 0xa000
s_mov_b32 s18, 0xa000
v_accvgpr_read_b32 v238, a252
v_accvgpr_read_b32 v239, a253
v_accvgpr_read_b32 v240, a254
s_branch L_k1_hb_u93
L_k1_hk_u119:
s_mul_i32 s88, s68, 0x3c00
s_add_u32 s88, s88, 0x18400
v_add_u32 v252, s88, v250
ds_write_b128 v252, v[0:3] offset:0
ds_write_b128 v252, v[8:11] offset:1024
ds_write_b128 v252, v[16:19] offset:2048
ds_write_b128 v252, v[24:27] offset:3072
ds_write_b128 v252, v[32:35] offset:4096
ds_write_b128 v252, v[40:43] offset:5120
ds_write_b128 v252, v[48:51] offset:6144
ds_write_b128 v252, v[56:59] offset:7168
ds_write_b128 v252, v[64:67] offset:8192
ds_write_b128 v252, v[72:75] offset:9216
ds_write_b128 v252, v[80:83] offset:10240
ds_write_b128 v252, v[88:91] offset:11264
wl 0
s_branch L_k1_hb_u120
L_k1_hk_u121:
s_mul_i32 s88, s68, 0x3c00
s_add_u32 s88, s88, 0x18400
v_add_u32 v252, s88, v250
ds_write_b128 v252, v[64:67] offset:12288
ds_write_b128 v252, v[72:75] offset:13312
ds_write_b128 v252, v[80:83] offset:14336
v_mov_b32 v254, v88
v_mov_b32 v255, v89
v_mov_b32 v245, v90
v_mov_b32 v246, v91
v_accvgpr_write_b32 a0, v0
v_accvgpr_write_b32 a1, v1
v_accvgpr_write_b32 a2, v2
v_accvgpr_write_b32 a3, v3
v_accvgpr_write_b32 a4, v8
v_accvgpr_write_b32 a5, v9
v_accvgpr_write_b32 a6, v10
v_accvgpr_write_b32 a7, v11
v_accvgpr_write_b32 a8, v16
v_accvgpr_write_b32 a9, v17
v_accvgpr_write_b32 a10, v18
v_accvgpr_write_b32 a11, v19
v_accvgpr_write_b32 a12, v24
v_accvgpr_write_b32 a13, v25
v_accvgpr_write_b32 a14, v26
v_accvgpr_write_b32 a15, v27
v_accvgpr_write_b32 a16, v32
v_accvgpr_write_b32 a17, v33
v_accvgpr_write_b32 a18, v34
v_accvgpr_write_b32 a19, v35
v_accvgpr_write_b32 a20, v40
v_accvgpr_write_b32 a21, v41
v_accvgpr_write_b32 a22, v42
v_accvgpr_write_b32 a23, v43
v_accvgpr_write_b32 a24, v48
v_accvgpr_write_b32 a25, v49
v_accvgpr_write_b32 a26, v50
v_accvgpr_write_b32 a27, v51
v_accvgpr_write_b32 a28, v56
v_accvgpr_write_b32 a29, v57
v_accvgpr_write_b32 a30, v58
v_accvgpr_write_b32 a31, v59
wl 0
s_branch L_k1_hb_u122
L_k1_hk_u123:
v_accvgpr_write_b32 a48, v0
v_accvgpr_write_b32 a49, v1
v_accvgpr_write_b32 a50, v2
v_accvgpr_write_b32 a51, v3
v_accvgpr_write_b32 a52, v8
v_accvgpr_write_b32 a53, v9
v_accvgpr_write_b32 a54, v10
v_accvgpr_write_b32 a55, v11
v_accvgpr_write_b32 a56, v16
v_accvgpr_write_b32 a57, v17
v_accvgpr_write_b32 a58, v18
v_accvgpr_write_b32 a59, v19
v_accvgpr_write_b32 a60, v24
v_accvgpr_write_b32 a61, v25
v_accvgpr_write_b32 a62, v26
v_accvgpr_write_b32 a63, v27
v_accvgpr_write_b32 a64, v32
v_accvgpr_write_b32 a65, v33
v_accvgpr_write_b32 a66, v34
v_accvgpr_write_b32 a67, v35
v_accvgpr_write_b32 a68, v40
v_accvgpr_write_b32 a69, v41
v_accvgpr_write_b32 a70, v42
v_accvgpr_write_b32 a71, v43
v_accvgpr_write_b32 a72, v48
v_accvgpr_write_b32 a73, v49
v_accvgpr_write_b32 a74, v50
v_accvgpr_write_b32 a75, v51
v_accvgpr_write_b32 a76, v56
v_accvgpr_write_b32 a77, v57
v_accvgpr_write_b32 a78, v58
v_accvgpr_write_b32 a79, v59
v_accvgpr_write_b32 a80, v64
v_accvgpr_write_b32 a81, v65
v_accvgpr_write_b32 a82, v66
v_accvgpr_write_b32 a83, v67
v_accvgpr_write_b32 a84, v72
v_accvgpr_write_b32 a85, v73
v_accvgpr_write_b32 a86, v74
v_accvgpr_write_b32 a87, v75
v_accvgpr_write_b32 a88, v80
v_accvgpr_write_b32 a89, v81
v_accvgpr_write_b32 a90, v82
v_accvgpr_write_b32 a91, v83
v_accvgpr_write_b32 a92, v88
v_accvgpr_write_b32 a93, v89
v_accvgpr_write_b32 a94, v90
v_accvgpr_write_b32 a95, v91
s_branch L_k1_hb_u124
L_k1_pst0:
s_branch L_k1_pst4
L_k1_tw_u3:
s_cmp_lg_u32 s83, 0
s_cbranch_scc0 L_k1_te_u5
s_waitcnt vmcnt(6)
s_cmp_eq_u32 s83, 1
s_cbranch_scc0 L_k1_te_u5
s_waitcnt vmcnt(5)
L_k1_te_u5:
s_branch L_k1_hb_u4
L_k1_tw_u8:
s_cmp_lg_u32 s83, 0
s_cbranch_scc0 L_k1_te_u10
s_waitcnt vmcnt(6)
s_cmp_eq_u32 s83, 1
s_cbranch_scc0 L_k1_te_u10
s_waitcnt vmcnt(5)
L_k1_te_u10:
s_branch L_k1_hb_u9
L_k1_pst1:
s_branch L_k1_pst5
L_k1_tw_u11:
s_cmp_lg_u32 s83, 0
s_cbranch_scc0 L_k1_te_u13
s_waitcnt vmcnt(6)
s_cmp_eq_u32 s83, 1
s_cbranch_scc0 L_k1_te_u13
s_waitcnt vmcnt(5)
L_k1_te_u13:
s_branch L_k1_hb_u12
L_k1_tw_u18:
s_cmp_lg_u32 s83, 0
s_cbranch_scc0 L_k1_te_u20
s_waitcnt vmcnt(6)
s_cmp_eq_u32 s83, 1
s_cbranch_scc0 L_k1_te_u20
s_waitcnt vmcnt(5)
L_k1_te_u20:
s_branch L_k1_hb_u19
L_k1_pst2:
s_branch L_k1_pst6
L_k1_tw_u23:
s_cmp_lg_u32 s83, 0
s_cbranch_scc0 L_k1_te_u25
s_waitcnt vmcnt(6)
s_cmp_eq_u32 s83, 1
s_cbranch_scc0 L_k1_te_u25
s_waitcnt vmcnt(5)
L_k1_te_u25:
s_branch L_k1_hb_u24
L_k1_tw_u26:
s_cmp_lg_u32 s83, 0
s_cbranch_scc0 L_k1_te_u28
s_waitcnt vmcnt(6)
s_cmp_eq_u32 s83, 1
s_cbranch_scc0 L_k1_te_u28
s_waitcnt vmcnt(5)
L_k1_te_u28:
s_branch L_k1_hb_u27
L_k1_pst3:
s_branch L_k1_pst7
L_k1_tw_u31:
s_waitcnt vmcnt(6)
s_cmp_eq_u32 s83, 1
s_cbranch_scc0 L_k1_te_u33
s_waitcnt vmcnt(5)
L_k1_te_u33:
s_branch L_k1_hb_u32
L_k1_tw_u34:
s_waitcnt vmcnt(6)
s_cmp_eq_u32 s83, 1
s_cbranch_scc0 L_k1_te_u36
s_waitcnt vmcnt(5)
L_k1_te_u36:
s_branch L_k1_hb_u35
L_k1_pst4:
s_branch L_k1_pst8
L_k1_tw_u39:
s_waitcnt vmcnt(6)
s_cmp_eq_u32 s83, 1
s_cbranch_scc0 L_k1_te_u41
s_waitcnt vmcnt(5)
L_k1_te_u41:
s_branch L_k1_hb_u40
L_k1_tw_u44:
s_waitcnt vmcnt(6)
s_cmp_eq_u32 s83, 1
s_cbranch_scc0 L_k1_te_u46
s_waitcnt vmcnt(5)
L_k1_te_u46:
s_branch L_k1_hb_u45
L_k1_tw_u47:
s_waitcnt vmcnt(6)
s_cmp_eq_u32 s83, 1
s_cbranch_scc0 L_k1_te_u49
s_waitcnt vmcnt(5)
L_k1_te_u49:
s_branch L_k1_hb_u48
L_k1_pst5:
s_branch L_k1_pst9
L_k1_tw_u52:
s_waitcnt vmcnt(6)
s_cmp_eq_u32 s83, 1
s_cbranch_scc0 L_k1_te_u54
s_waitcnt vmcnt(5)
L_k1_te_u54:
s_branch L_k1_hb_u53
L_k1_tw_u55:
s_waitcnt vmcnt(6)
s_cmp_eq_u32 s83, 1
s_cbranch_scc0 L_k1_te_u57
s_waitcnt vmcnt(5)
L_k1_te_u57:
s_branch L_k1_hb_u56
L_k1_tw_u62:
s_waitcnt vmcnt(5)
L_k1_te_u64:
s_branch L_k1_hb_u63
L_k1_pst6:
s_branch L_k1_pr1
L_k1_tw_u67:
s_waitcnt vmcnt(5)
L_k1_te_u69:
s_branch L_k1_hb_u68
L_k1_tw_u70:
s_waitcnt vmcnt(5)
L_k1_te_u72:
s_branch L_k1_hb_u71
L_k1_tw_u77:
s_waitcnt vmcnt(5)
L_k1_te_u79:
s_branch L_k1_hb_u78
L_k1_tw_u80:
s_waitcnt vmcnt(5)
L_k1_te_u82:
s_branch L_k1_hb_u81
L_k1_tw_u87:
s_waitcnt vmcnt(5)
L_k1_te_u89:
s_branch L_k1_hb_u88
L_k1_tw_u94:
s_waitcnt vmcnt(6)
s_cmp_eq_u32 s83, 0
s_cbranch_scc0 L_k1_te_u96
s_waitcnt vmcnt(5)
L_k1_te_u96:
s_branch L_k1_hb_u95
L_k1_pst7:
s_branch L_k1_pr1
L_k1_tw_u97:
s_waitcnt vmcnt(6)
s_cmp_eq_u32 s83, 0
s_cbranch_scc0 L_k1_te_u99
s_waitcnt vmcnt(5)
L_k1_te_u99:
s_branch L_k1_hb_u98
L_k1_tw_u102:
s_waitcnt vmcnt(6)
s_cmp_eq_u32 s83, 0
s_cbranch_scc0 L_k1_te_u104
s_waitcnt vmcnt(5)
L_k1_te_u104:
s_branch L_k1_hb_u103
L_k1_pst8:
s_branch L_k1_pr1
L_k1_tw_u107:
s_waitcnt vmcnt(6)
s_cmp_eq_u32 s83, 0
s_cbranch_scc0 L_k1_te_u109
s_waitcnt vmcnt(5)
L_k1_te_u109:
s_branch L_k1_hb_u108
L_k1_tw_u110:
s_waitcnt vmcnt(6)
s_cmp_eq_u32 s83, 0
s_cbranch_scc0 L_k1_te_u112
s_waitcnt vmcnt(5)
L_k1_te_u112:
s_branch L_k1_hb_u111
L_k1_tw_u113:
s_waitcnt vmcnt(6)
s_cmp_eq_u32 s83, 0
s_cbranch_scc0 L_k1_te_u115
s_waitcnt vmcnt(5)
L_k1_te_u115:
s_branch L_k1_hb_u114
L_k1_pst9:
s_branch L_k1_pr1
L_k1_tw_u116:
s_waitcnt vmcnt(6)
s_cmp_eq_u32 s83, 0
s_cbranch_scc0 L_k1_te_u118
s_waitcnt vmcnt(5)
L_k1_te_u118:
s_branch L_k1_hb_u117
L_k1_rr_u1:
s_call_b64 s[94:95], L_k1_rare1
s_branch L_k1_rb_u2
L_k1_rr_u6:
s_call_b64 s[94:95], L_k1_rare0
s_branch L_k1_rb_u7
L_k1_rr_u16:
s_call_b64 s[94:95], L_k1_rare1
s_branch L_k1_rb_u17
L_k1_rr_u21:
s_call_b64 s[94:95], L_k1_rare0
s_branch L_k1_rb_u22
L_k1_rr_u29:
s_call_b64 s[94:95], L_k1_rare1
s_branch L_k1_rb_u30
L_k1_rr_u37:
s_call_b64 s[94:95], L_k1_rare0
s_branch L_k1_rb_u38
L_k1_rr_u42:
s_call_b64 s[94:95], L_k1_rare1
s_branch L_k1_rb_u43
L_k1_rr_u50:
s_call_b64 s[94:95], L_k1_rare0
s_branch L_k1_rb_u51
L_k1_rr_u60:
s_call_b64 s[94:95], L_k1_rare1
s_branch L_k1_rb_u61
L_k1_rr_u65:
s_call_b64 s[94:95], L_k1_rare0
s_branch L_k1_rb_u66
L_k1_rr_u75:
s_call_b64 s[94:95], L_k1_rare1
s_branch L_k1_rb_u76
L_k1_rr_u85:
s_call_b64 s[94:95], L_k1_rare0
s_branch L_k1_rb_u86
L_k1_rr_u90:
s_call_b64 s[94:95], L_k1_rare1
s_branch L_k1_rb_u91
L_k1_rr_u100:
s_call_b64 s[94:95], L_k1_rare0
s_branch L_k1_rb_u101
L_k1_rr_u105:
s_call_b64 s[94:95], L_k1_rare1
s_branch L_k1_rb_u106
L_k1_rr_u416:
s_call_b64 s[94:95], L_k1_rare0
s_branch L_k1_rb_u417
L_k1_rr_u418:
s_call_b64 s[94:95], L_k1_rare1
s_branch L_k1_rb_u419
L_k1_rr_u420:
s_call_b64 s[94:95], L_k1_rare0
s_branch L_k1_rb_u421
L_k1_rr_u422:
s_call_b64 s[94:95], L_k1_rare1
s_branch L_k1_rb_u423
L_k1_rr_u424:
s_call_b64 s[94:95], L_k1_rare0
s_branch L_k1_rb_u425
L_k1_rr_u426:
s_call_b64 s[94:95], L_k1_rare1
s_branch L_k1_rb_u427
L_k1_rr_u429:
s_call_b64 s[94:95], L_k1_rare0
s_branch L_k1_rb_u430
L_k1_rr_u431:
s_call_b64 s[94:95], L_k1_rare1
s_branch L_k1_rb_u432
L_k1_rare0:
s_nop 15
v_max3_f32 v252, v192, v193, v194
v_max3_f32 v253, v200, v201, v202
v_max3_f32 v252, v252, v195, v196
v_max3_f32 v253, v253, v203, v204
v_max3_f32 v252, v252, v197, v198
v_max3_f32 v253, v253, v205, v206
v_max_f32 v252, v252, v199
v_max_f32 v253, v253, v207
s_nop 1
v_permlane32_swap_b32 v252, v253
v_max_f32 v252, v252, v253
v_mov_b32 v253, v252
s_nop 1
v_permlane16_swap_b32 v252, v253
v_max_f32 v252, v252, v253
v_mov_b32 v253, v252
s_nop 1
v_permlane32_swap_b32 v252, v253
v_max_f32 v252, 0, v252
v_max_f32 v253, 0, v253
v_sub_f32 v192, v192, v252
v_sub_f32 v193, v193, v252
v_sub_f32 v194, v194, v252
v_sub_f32 v195, v195, v252
v_sub_f32 v196, v196, v252
v_sub_f32 v197, v197, v252
v_sub_f32 v198, v198, v252
v_sub_f32 v199, v199, v252
v_sub_f32 v200, v200, v253
v_sub_f32 v201, v201, v253
v_sub_f32 v202, v202, v253
v_sub_f32 v203, v203, v253
v_sub_f32 v204, v204, v253
v_sub_f32 v205, v205, v253
v_sub_f32 v206, v206, v253
v_sub_f32 v207, v207, v253
v_sub_f32 v224, v224, v252
v_sub_f32 v225, v225, v252
v_sub_f32 v226, v226, v252
v_sub_f32 v227, v227, v252
v_sub_f32 v228, v228, v253
v_sub_f32 v229, v229, v253
v_sub_f32 v230, v230, v253
v_sub_f32 v231, v231, v253
v_exp_f32 v252, -v252
v_exp_f32 v253, -v253
v_mul_f32 v0, v0, v252
v_mul_f32 v1, v1, v252
v_mul_f32 v2, v2, v252
v_mul_f32 v3, v3, v252
v_mul_f32 v4, v4, v252
v_mul_f32 v5, v5, v252
v_mul_f32 v6, v6, v252
v_mul_f32 v7, v7, v252
v_mul_f32 v8, v8, v253
v_mul_f32 v9, v9, v253
v_mul_f32 v10, v10, v253
v_mul_f32 v11, v11, v253
v_mul_f32 v12, v12, v253
v_mul_f32 v13, v13, v253
v_mul_f32 v14, v14, v253
v_mul_f32 v15, v15, v253
v_mul_f32 v16, v16, v252
v_mul_f32 v17, v17, v252
v_mul_f32 v18, v18, v252
v_mul_f32 v19, v19, v252
v_mul_f32 v20, v20, v252
v_mul_f32 v21, v21, v252
v_mul_f32 v22, v22, v252
v_mul_f32 v23, v23, v252
v_mul_f32 v24, v24, v253
v_mul_f32 v25, v25, v253
v_mul_f32 v26, v26, v253
v_mul_f32 v27, v27, v253
v_mul_f32 v28, v28, v253
v_mul_f32 v29, v29, v253
v_mul_f32 v30, v30, v253
v_mul_f32 v31, v31, v253
v_mul_f32 v32, v32, v252
v_mul_f32 v33, v33, v252
v_mul_f32 v34, v34, v252
v_mul_f32 v35, v35, v252
v_mul_f32 v36, v36, v252
v_mul_f32 v37, v37, v252
v_mul_f32 v38, v38, v252
v_mul_f32 v39, v39, v252
v_mul_f32 v40, v40, v253
v_mul_f32 v41, v41, v253
v_mul_f32 v42, v42, v253
v_mul_f32 v43, v43, v253
v_mul_f32 v44, v44, v253
v_mul_f32 v45, v45, v253
v_mul_f32 v46, v46, v253
v_mul_f32 v47, v47, v253
v_mul_f32 v48, v48, v252
v_mul_f32 v49, v49, v252
v_mul_f32 v50, v50, v252
v_mul_f32 v51, v51, v252
v_mul_f32 v52, v52, v252
v_mul_f32 v53, v53, v252
v_mul_f32 v54, v54, v252
v_mul_f32 v55, v55, v252
v_mul_f32 v56, v56, v253
v_mul_f32 v57, v57, v253
v_mul_f32 v58, v58, v253
v_mul_f32 v59, v59, v253
v_mul_f32 v60, v60, v253
v_mul_f32 v61, v61, v253
v_mul_f32 v62, v62, v253
v_mul_f32 v63, v63, v253
v_mul_f32 v64, v64, v252
v_mul_f32 v65, v65, v252
v_mul_f32 v66, v66, v252
v_mul_f32 v67, v67, v252
v_mul_f32 v68, v68, v252
v_mul_f32 v69, v69, v252
v_mul_f32 v70, v70, v252
v_mul_f32 v71, v71, v252
v_mul_f32 v72, v72, v253
v_mul_f32 v73, v73, v253
v_mul_f32 v74, v74, v253
v_mul_f32 v75, v75, v253
v_mul_f32 v76, v76, v253
v_mul_f32 v77, v77, v253
v_mul_f32 v78, v78, v253
v_mul_f32 v79, v79, v253
v_mul_f32 v80, v80, v252
v_mul_f32 v81, v81, v252
v_mul_f32 v82, v82, v252
v_mul_f32 v83, v83, v252
v_mul_f32 v84, v84, v252
v_mul_f32 v85, v85, v252
v_mul_f32 v86, v86, v252
v_mul_f32 v87, v87, v252
v_mul_f32 v88, v88, v253
v_mul_f32 v89, v89, v253
v_mul_f32 v90, v90, v253
v_mul_f32 v91, v91, v253
v_mul_f32 v92, v92, v253
v_mul_f32 v93, v93, v253
v_mul_f32 v94, v94, v253
v_mul_f32 v95, v95, v253
v_accvgpr_read_b32 v251, a240
v_mul_f32 v251, v251, v252
v_accvgpr_write_b32 a240, v251
v_accvgpr_read_b32 v251, a241
v_mul_f32 v251, v251, v252
v_accvgpr_write_b32 a241, v251
v_accvgpr_read_b32 v251, a242
v_mul_f32 v251, v251, v252
v_accvgpr_write_b32 a242, v251
v_accvgpr_read_b32 v251, a243
v_mul_f32 v251, v251, v252
v_accvgpr_write_b32 a243, v251
v_accvgpr_read_b32 v251, a244
v_mul_f32 v251, v251, v253
v_accvgpr_write_b32 a244, v251
v_accvgpr_read_b32 v251, a245
v_mul_f32 v251, v251, v253
v_accvgpr_write_b32 a245, v251
v_accvgpr_read_b32 v251, a246
v_mul_f32 v251, v251, v253
v_accvgpr_write_b32 a246, v251
v_accvgpr_read_b32 v251, a247
v_mul_f32 v251, v251, v253
v_accvgpr_write_b32 a247, v251
s_nop 3
s_setpc_b64 s[94:95]
L_k1_rare1:
s_nop 15
v_max3_f32 v252, v208, v209, v210
v_max3_f32 v253, v216, v217, v218
v_max3_f32 v252, v252, v211, v212
v_max3_f32 v253, v253, v219, v220
v_max3_f32 v252, v252, v213, v214
v_max3_f32 v253, v253, v221, v222
v_max_f32 v252, v252, v215
v_max_f32 v253, v253, v223
s_nop 1
v_permlane32_swap_b32 v252, v253
v_max_f32 v252, v252, v253
v_mov_b32 v253, v252
s_nop 1
v_permlane16_swap_b32 v252, v253
v_max_f32 v252, v252, v253
v_mov_b32 v253, v252
s_nop 1
v_permlane32_swap_b32 v252, v253
v_max_f32 v252, 0, v252
v_max_f32 v253, 0, v253
v_sub_f32 v208, v208, v252
v_sub_f32 v209, v209, v252
v_sub_f32 v210, v210, v252
v_sub_f32 v211, v211, v252
v_sub_f32 v212, v212, v252
v_sub_f32 v213, v213, v252
v_sub_f32 v214, v214, v252
v_sub_f32 v215, v215, v252
v_sub_f32 v216, v216, v253
v_sub_f32 v217, v217, v253
v_sub_f32 v218, v218, v253
v_sub_f32 v219, v219, v253
v_sub_f32 v220, v220, v253
v_sub_f32 v221, v221, v253
v_sub_f32 v222, v222, v253
v_sub_f32 v223, v223, v253
v_sub_f32 v224, v224, v252
v_sub_f32 v225, v225, v252
v_sub_f32 v226, v226, v252
v_sub_f32 v227, v227, v252
v_sub_f32 v228, v228, v253
v_sub_f32 v229, v229, v253
v_sub_f32 v230, v230, v253
v_sub_f32 v231, v231, v253
v_exp_f32 v252, -v252
v_exp_f32 v253, -v253
v_mul_f32 v0, v0, v252
v_mul_f32 v1, v1, v252
v_mul_f32 v2, v2, v252
v_mul_f32 v3, v3, v252
v_mul_f32 v4, v4, v252
v_mul_f32 v5, v5, v252
v_mul_f32 v6, v6, v252
v_mul_f32 v7, v7, v252
v_mul_f32 v8, v8, v253
v_mul_f32 v9, v9, v253
v_mul_f32 v10, v10, v253
v_mul_f32 v11, v11, v253
v_mul_f32 v12, v12, v253
v_mul_f32 v13, v13, v253
v_mul_f32 v14, v14, v253
v_mul_f32 v15, v15, v253
v_mul_f32 v16, v16, v252
v_mul_f32 v17, v17, v252
v_mul_f32 v18, v18, v252
v_mul_f32 v19, v19, v252
v_mul_f32 v20, v20, v252
v_mul_f32 v21, v21, v252
v_mul_f32 v22, v22, v252
v_mul_f32 v23, v23, v252
v_mul_f32 v24, v24, v253
v_mul_f32 v25, v25, v253
v_mul_f32 v26, v26, v253
v_mul_f32 v27, v27, v253
v_mul_f32 v28, v28, v253
v_mul_f32 v29, v29, v253
v_mul_f32 v30, v30, v253
v_mul_f32 v31, v31, v253
v_mul_f32 v32, v32, v252
v_mul_f32 v33, v33, v252
v_mul_f32 v34, v34, v252
v_mul_f32 v35, v35, v252
v_mul_f32 v36, v36, v252
v_mul_f32 v37, v37, v252
v_mul_f32 v38, v38, v252
v_mul_f32 v39, v39, v252
v_mul_f32 v40, v40, v253
v_mul_f32 v41, v41, v253
v_mul_f32 v42, v42, v253
v_mul_f32 v43, v43, v253
v_mul_f32 v44, v44, v253
v_mul_f32 v45, v45, v253
v_mul_f32 v46, v46, v253
v_mul_f32 v47, v47, v253
v_mul_f32 v48, v48, v252
v_mul_f32 v49, v49, v252
v_mul_f32 v50, v50, v252
v_mul_f32 v51, v51, v252
v_mul_f32 v52, v52, v252
v_mul_f32 v53, v53, v252
v_mul_f32 v54, v54, v252
v_mul_f32 v55, v55, v252
v_mul_f32 v56, v56, v253
v_mul_f32 v57, v57, v253
v_mul_f32 v58, v58, v253
v_mul_f32 v59, v59, v253
v_mul_f32 v60, v60, v253
v_mul_f32 v61, v61, v253
v_mul_f32 v62, v62, v253
v_mul_f32 v63, v63, v253
v_mul_f32 v64, v64, v252
v_mul_f32 v65, v65, v252
v_mul_f32 v66, v66, v252
v_mul_f32 v67, v67, v252
v_mul_f32 v68, v68, v252
v_mul_f32 v69, v69, v252
v_mul_f32 v70, v70, v252
v_mul_f32 v71, v71, v252
v_mul_f32 v72, v72, v253
v_mul_f32 v73, v73, v253
v_mul_f32 v74, v74, v253
v_mul_f32 v75, v75, v253
v_mul_f32 v76, v76, v253
v_mul_f32 v77, v77, v253
v_mul_f32 v78, v78, v253
v_mul_f32 v79, v79, v253
v_mul_f32 v80, v80, v252
v_mul_f32 v81, v81, v252
v_mul_f32 v82, v82, v252
v_mul_f32 v83, v83, v252
v_mul_f32 v84, v84, v252
v_mul_f32 v85, v85, v252
v_mul_f32 v86, v86, v252
v_mul_f32 v87, v87, v252
v_mul_f32 v88, v88, v253
v_mul_f32 v89, v89, v253
v_mul_f32 v90, v90, v253
v_mul_f32 v91, v91, v253
v_mul_f32 v92, v92, v253
v_mul_f32 v93, v93, v253
v_mul_f32 v94, v94, v253
v_mul_f32 v95, v95, v253
v_accvgpr_read_b32 v251, a240
v_mul_f32 v251, v251, v252
v_accvgpr_write_b32 a240, v251
v_accvgpr_read_b32 v251, a241
v_mul_f32 v251, v251, v252
v_accvgpr_write_b32 a241, v251
v_accvgpr_read_b32 v251, a242
v_mul_f32 v251, v251, v252
v_accvgpr_write_b32 a242, v251
v_accvgpr_read_b32 v251, a243
v_mul_f32 v251, v251, v252
v_accvgpr_write_b32 a243, v251
v_accvgpr_read_b32 v251, a244
v_mul_f32 v251, v251, v253
v_accvgpr_write_b32 a244, v251
v_accvgpr_read_b32 v251, a245
v_mul_f32 v251, v251, v253
v_accvgpr_write_b32 a245, v251
v_accvgpr_read_b32 v251, a246
v_mul_f32 v251, v251, v253
v_accvgpr_write_b32 a246, v251
v_accvgpr_read_b32 v251, a247
v_mul_f32 v251, v251, v253
v_accvgpr_write_b32 a247, v251
s_nop 3
s_setpc_b64 s[94:95]
L_k1_codeend:

.section .rodata,"a"
.p2align 6
.amdhsa_kernel concat_heads__gqa_block_cached__mha_block_cached__near_ridge_kernel
  .amdhsa_next_free_vgpr 512
  .amdhsa_next_free_sgpr 100
  .amdhsa_accum_offset 256
  .amdhsa_group_segment_fixed_size 0
  .amdhsa_kernarg_size 104
  .amdhsa_user_sgpr_count 2
  .amdhsa_user_sgpr_kernarg_segment_ptr 1
  .amdhsa_system_sgpr_workgroup_id_x 1
.end_amdhsa_kernel
```
